```python
import torch

def _softmax(x, axis=-1):
    return torch.softmax(x, dim=axis)
def _gelu(x):
    return torch.nn.functional.gelu(x, approximate="tanh")
def _silu(x):
    return torch.nn.functional.silu(x)
def _sigmoid(x):
    return torch.sigmoid(x)
def _layernorm(x, axis=-1, eps=1e-5):
    m = x.mean(dim=axis, keepdim=True)
    v = x.var(dim=axis, keepdim=True, unbiased=False)
    return (x - m) / torch.sqrt(v + eps)
def _scatter_add(tgt, idx, src, axis=0):
    return tgt.clone().index_add_(axis, idx, src)
def _segment_sum(src, seg, n):
    out = torch.zeros((n,) + src.shape[1:], dtype=src.dtype)
    return out.index_add_(0, seg, src)
def _pad(x, pw):
    flat = tuple(v for pair in reversed(pw) for v in pair)
    return torch.nn.functional.pad(x, flat)

kernel_name = 'parallel_sum__ssm_conv_s5__swiglu_ffn__prompt'

def setup_inputs():

    _w = (lambda a: (lambda t: t.to(torch.bfloat16) if t.is_floating_point() else t)(torch.as_tensor(a)))
    def _A_setup():
        B, S, D = 1, 2048, 1024
        P = D
        Lambda_re = -0.5 * (lambda _x: torch.exp(torch.as_tensor(_x)))((lambda *s: torch.randn(*s, dtype=torch.bfloat16) * 0.8)(P))
        Lambda_im = (lambda *s: torch.randn(*s, dtype=torch.bfloat16) * 0.8)(P) * 1.0
        B_re = (lambda *s: torch.randn(*s, dtype=torch.bfloat16) * 1.6)(P, D) * (D ** -0.5)
        B_im = (lambda *s: torch.randn(*s, dtype=torch.bfloat16) * 1.6)(P, D) * (D ** -0.5)
        C_re = (lambda *s: torch.randn(*s, dtype=torch.bfloat16) * 1.6)(D, P) * (P ** -0.5)
        C_im = (lambda *s: torch.randn(*s, dtype=torch.bfloat16) * 1.6)(D, P) * (P ** -0.5)
        log_dt = (lambda *s: torch.randn(*s, dtype=torch.bfloat16) * 0.8)(P) * 0.3 - 2.0
        Dskip = (lambda *s: torch.randn(*s, dtype=torch.bfloat16) * 0.4)(D)
        return {
            "x": _w((lambda *s: torch.randn(*s, dtype=torch.bfloat16) * 0.05)(B, S, D)),
            "Lambda_re": _w(Lambda_re),
            "Lambda_im": _w(Lambda_im),
            "B_re": _w(B_re),
            "B_im": _w(B_im),
            "C_re": _w(C_re),
            "C_im": _w(C_im),
            "log_dt": _w(log_dt),
            "Dskip": _w(Dskip),
        }
    _A_in = _A_setup()

    def _B_setup():
        B, S, D, F = 1, 2048, 1024, 3584
        return {
            "x": _w((lambda *s: torch.randn(*s, dtype=torch.bfloat16) * 0.05)(B, S, D)),
            "w_gate": _w((lambda *s: torch.randn(*s, dtype=torch.bfloat16) * 0.05)(D, F)),
            "w_up": _w((lambda *s: torch.randn(*s, dtype=torch.bfloat16) * 0.05)(D, F)),
            "w_down": _w((lambda *s: torch.randn(*s, dtype=torch.bfloat16) * 0.05)(F, D)),
        }
    _B_in = _B_setup()

    return {
        "A_x": _A_in["x"],
        "A_Lambda_re": _A_in["Lambda_re"],
        "A_Lambda_im": _A_in["Lambda_im"],
        "A_B_re": _A_in["B_re"],
        "A_B_im": _A_in["B_im"],
        "A_C_re": _A_in["C_re"],
        "A_C_im": _A_in["C_im"],
        "A_log_dt": _A_in["log_dt"],
        "A_Dskip": _A_in["Dskip"],
        "B_x": _B_in["x"],
        "B_w_gate": _B_in["w_gate"],
        "B_w_up": _B_in["w_up"],
        "B_w_down": _B_in["w_down"],
    }

def reference(A_x, A_Lambda_re, A_Lambda_im, A_B_re, A_B_im, A_C_re, A_C_im, A_log_dt, A_Dskip, B_x, B_w_gate, B_w_up, B_w_down):
    def _A_ref(x, Lambda_re, Lambda_im, B_re, B_im, C_re, C_im, log_dt, Dskip):
        Bsz, L, H = x.shape
        Lam = Lambda_re + 1j * Lambda_im
        Bmat = B_re + 1j * B_im
        Cmat = C_re + 1j * C_im
        dt = torch.exp(log_dt)
        Lam_bar = torch.exp(dt * Lam)
        B_bar = ((Lam_bar - 1.0) / Lam)[:, None] * Bmat
        Bu = torch.einsum("bld,pd->blp", x + 0j, B_bar)
        h = torch.zeros_like(Bu[:, 0, :])
        hs = []
        for t in range(L):
            h = Lam_bar[None, :] * h + Bu[:, t, :]
            hs.append(h)
        hseq = torch.stack(hs, 1)
        y = 2.0 * torch.einsum("blp,dp->bld", hseq, Cmat).real + x * Dskip[None, None, :]
        return y

    def _B_ref(x, w_gate, w_up, w_down):
        g = _silu(x @ w_gate)
        u = x @ w_up
        return (g * u) @ w_down

    x = A_x
    xn = _layernorm(x, axis=-1)
    return x + _A_ref(xn, A_Lambda_re, A_Lambda_im, A_B_re, A_B_im, A_C_re, A_C_im, A_log_dt, A_Dskip) + _B_ref(xn, B_w_gate, B_w_up, B_w_down)
```

```asm
; @launch grid=(256,1,1) block=(256,1,1) lds=163840
.amdgcn_target "amdgcn-amd-amdhsa--gfx950"
.text
.globl parallel_sum__ssm_conv_s5__swiglu_ffn__prompt_kernel
.p2align 12
.p2align 8
.type parallel_sum__ssm_conv_s5__swiglu_ffn__prompt_kernel,@function
parallel_sum__ssm_conv_s5__swiglu_ffn__prompt_kernel:
    s_load_dwordx2 s[20:21], s[0:1], 0
    s_load_dwordx2 s[4:5], s[0:1], 120
    s_load_dwordx4 s[8:11], s[0:1], 80
    s_load_dwordx4 s[12:15], s[0:1], 24
    s_cmp_ge_u32 s2, 256
    s_cbranch_scc1 L_done
    s_getpc_b64 s[66:67]
L_pc:
    s_lshr_b32 s65, s2, 3
    v_lshrrev_b32 v2, 4, v0
    s_lshl_b32 s65, s65, 11
    v_lshl_add_u32 v2, v2, 7, s65
    v_min_u32 v2, L_done-L_pc, v2
    v_mov_b32 v3, 0
    v_lshl_add_u64 v[2:3], v[2:3], 0, s[66:67]
    global_load_dword v31, v[2:3], off
    v_lshrrev_b32 v1, 6, v0
    v_and_b32 v0, 63, v0
    v_readfirstlane_b32 s3, v1
    v_lshlrev_b32 v1, 4, v0
    s_bfe_u32 s58, s2, 0x20001
    s_and_b32 s56, s2, 1
    s_lshr_b32 s65, s2, 6
    s_lshl2_add_u32 s56, s56, s65
    s_bfe_u32 s59, s2, 0x30003
    s_lshr_b32 s82, s3, 1
    s_and_b32 s83, s3, 1
    s_lshl2_add_u32 s61, s56, s58
    s_and_b32 s62, s59, 1
    s_lshr_b32 s64, s59, 1
    s_lshl1_add_u32 s38, s61, s62
    s_lshl1_add_u32 s38, s38, s82
    s_lshl2_add_u32 s38, s38, s64
    s_lshl1_add_u32 s38, s38, s83
    s_lshl_b32 s38, s38, 12
    s_mov_b32 s22, 4194304
    s_mov_b32 s23, 0x20000
    s_brev_b32 s6, 8
    s_mov_b32 s7, 0x20000
    v_mov_b64 v[200:201], 0
    s_mov_b32 s39, 29425664
    s_or_b32 s34, s2, s3
    s_waitcnt lgkmcnt(0)
    s_cbranch_scc1 L_noclr
    v_lshrrev_b32 v220, 1, v0
    v_and_b32 v221, 16, v1
    v_lshl_add_u32 v204, v220, 7, v221
    v_mov_b64 v[202:203], 0
    buffer_store_dwordx4 v[200:203], v204, s[4:7], s39 offen sc1
L_noclr:
    buffer_load_dwordx4 v[32:35], v1, s[20:23], s38 offen offset:0
    buffer_load_dwordx4 v[36:39], v1, s[20:23], s38 offen offset:1024
    buffer_load_dwordx4 v[40:43], v1, s[20:23], s38 offen offset:2048
    buffer_load_dwordx4 v[44:47], v1, s[20:23], s38 offen offset:3072
    s_cmp_eq_u32 s82, 0
    s_cselect_b64 s[8:9], s[8:9], s[10:11]
    s_cselect_b64 s[12:13], s[12:13], s[14:15]
    s_mov_b32 s10, 7340032
    s_mov_b32 s11, 0x20000
    s_mov_b32 s14, 2097152
    s_mov_b32 s15, 0x20000
    s_load_dwordx2 s[40:41], s[0:1], 112
    s_load_dwordx2 s[44:45], s[0:1], 8
    s_load_dwordx2 s[48:49], s[0:1], 16
    s_load_dwordx2 s[52:53], s[0:1], 56
    s_load_dwordx2 s[24:25], s[0:1], 96
    s_load_dwordx2 s[28:29], s[0:1], 40
    s_load_dwordx2 s[32:33], s[0:1], 48
    s_load_dwordx2 s[36:37], s[0:1], 104
    s_load_dwordx2 s[80:81], s[0:1], 64
    s_lshl3_add_u32 s57, s58, s59
    s_mul_i32 s70, s61, 135168
    s_lshl_b32 s65, s3, 5
    s_add_u32 s65, s65, s64
    s_lshl3_add_u32 s65, s65, s62
    s_lshl_b32 s65, s65, 7
    s_add_u32 s70, s70, s65
    s_lshl_b32 s79, s61, 5
    s_add_u32 s79, s79, s59
    s_lshl2_add_u32 s79, s79, s39
    s_lshl2_add_u32 s72, s56, s3
    s_lshl_b32 s65, s62, 1
    v_add_u32 v220, 0, v0
    v_mul_u32_u24 v221, 4682, v220
    v_lshrrev_b32 v221, 16, v221
    v_mad_i32_i24 v220, v221, -14, v220
    v_add_u32 v220, s65, v220
    v_subrev_u32 v222, 14, v220
    v_min_u32 v220, v220, v222
    v_lshrrev_b32 v222, 1, v221
    v_xor_b32 v222, v222, v221
    v_and_b32 v222, 4, v222
    v_mul_u32_u24 v222, 3, v222
    v_xor_b32 v221, v221, v222
    v_mul_u32_u24 v221, 7168, v221
    v_lshl_add_u32 v2, v220, 4, v221
    v_add_u32 v220, 64, v0
    v_mul_u32_u24 v221, 4682, v220
    v_lshrrev_b32 v221, 16, v221
    v_mad_i32_i24 v220, v221, -14, v220
    v_add_u32 v220, s65, v220
    v_subrev_u32 v222, 14, v220
    v_min_u32 v220, v220, v222
    v_lshrrev_b32 v222, 1, v221
    v_xor_b32 v222, v222, v221
    v_and_b32 v222, 4, v222
    v_mul_u32_u24 v222, 3, v222
    v_xor_b32 v221, v221, v222
    v_mul_u32_u24 v221, 7168, v221
    v_lshl_add_u32 v3, v220, 4, v221
    v_subrev_u32 v3, 1024, v3
    v_add_u32 v220, 128, v0
    v_mul_u32_u24 v221, 4682, v220
    v_lshrrev_b32 v221, 16, v221
    v_mad_i32_i24 v220, v221, -14, v220
    v_add_u32 v220, s65, v220
    v_subrev_u32 v222, 14, v220
    v_min_u32 v220, v220, v222
    v_lshrrev_b32 v222, 1, v221
    v_xor_b32 v222, v222, v221
    v_and_b32 v222, 4, v222
    v_mul_u32_u24 v222, 3, v222
    v_xor_b32 v221, v221, v222
    v_mul_u32_u24 v221, 7168, v221
    v_lshl_add_u32 v4, v220, 4, v221
    v_subrev_u32 v4, 2048, v4
    v_add_u32 v220, 192, v0
    v_mul_u32_u24 v221, 4682, v220
    v_lshrrev_b32 v221, 16, v221
    v_mad_i32_i24 v220, v221, -14, v220
    v_add_u32 v220, s65, v220
    v_subrev_u32 v222, 14, v220
    v_min_u32 v220, v220, v222
    v_lshrrev_b32 v222, 1, v221
    v_xor_b32 v222, v222, v221
    v_and_b32 v222, 4, v222
    v_mul_u32_u24 v222, 3, v222
    v_xor_b32 v221, v221, v222
    v_mul_u32_u24 v221, 7168, v221
    v_lshl_add_u32 v5, v220, 4, v221
    v_subrev_u32 v5, 3072, v5
    v_add_u32 v220, 256, v0
    v_mul_u32_u24 v221, 4682, v220
    v_lshrrev_b32 v221, 16, v221
    v_mad_i32_i24 v220, v221, -14, v220
    v_add_u32 v220, s65, v220
    v_subrev_u32 v222, 14, v220
    v_min_u32 v220, v220, v222
    v_lshrrev_b32 v222, 1, v221
    v_xor_b32 v222, v222, v221
    v_and_b32 v222, 4, v222
    v_mul_u32_u24 v222, 3, v222
    v_xor_b32 v221, v221, v222
    v_mul_u32_u24 v221, 7168, v221
    v_lshl_add_u32 v6, v220, 4, v221
    v_add_u32 v220, 320, v0
    v_mul_u32_u24 v221, 4682, v220
    v_lshrrev_b32 v221, 16, v221
    v_mad_i32_i24 v220, v221, -14, v220
    v_add_u32 v220, s65, v220
    v_subrev_u32 v222, 14, v220
    v_min_u32 v220, v220, v222
    v_lshrrev_b32 v222, 1, v221
    v_xor_b32 v222, v222, v221
    v_and_b32 v222, 4, v222
    v_mul_u32_u24 v222, 3, v222
    v_xor_b32 v221, v221, v222
    v_mul_u32_u24 v221, 7168, v221
    v_lshl_add_u32 v7, v220, 4, v221
    v_subrev_u32 v7, 1024, v7
    v_add_u32 v220, 384, v0
    v_mul_u32_u24 v221, 4682, v220
    v_lshrrev_b32 v221, 16, v221
    v_mad_i32_i24 v220, v221, -14, v220
    v_add_u32 v220, s65, v220
    v_subrev_u32 v222, 14, v220
    v_min_u32 v220, v220, v222
    v_lshrrev_b32 v222, 1, v221
    v_xor_b32 v222, v222, v221
    v_and_b32 v222, 4, v222
    v_mul_u32_u24 v222, 3, v222
    v_xor_b32 v221, v221, v222
    v_mul_u32_u24 v221, 7168, v221
    v_lshl_add_u32 v8, v220, 4, v221
    v_subrev_u32 v8, 2048, v8
    v_lshrrev_b32 v218, 3, v0
    v_lshrrev_b32 v219, 4, v0
    v_and_b32 v222, 7, v0
    v_xor_b32 v221, v219, v222
    v_lshlrev_b32 v220, 11, v218
    v_lshl_add_u32 v9, v221, 4, v220
    v_xor_b32 v10, 64, v9
    v_add_u32 v10, 15360, v10
    s_mul_i32 s60, s72, 135168
    s_mul_i32 s61, s57, 224
    s_mul_i32 s65, s83, 229376
    s_add_u32 s61, s61, s65
    s_lshl1_add_u32 s62, s57, s83
    s_lshl_b32 s62, s62, 15
    s_mul_i32 s63, s82, 14336
    s_mul_i32 s65, s83, 7168
    s_add_u32 s63, s63, s65
    s_lshl_b32 s64, s3, 11
    s_add_u32 s64, s64, 28672
    s_lshl_b32 s65, s3, 1
    v_xor_b32 v221, s65, v222
    v_lshlrev_b32 v221, 4, v221
    v_lshl_add_u32 v210, v0, 7, v221
    v_add_u32 v210, 110592, v210
    v_xor_b32 v211, 16, v210
    v_xor_b32 v221, v218, v222
    v_lshlrev_b32 v221, 4, v221
    v_lshl_add_u32 v212, v218, 7, v221
    s_lshl_b32 s65, s3, 12
    s_add_u32 s65, s65, 110592
    v_add_u32 v212, s65, v212
    v_and_b32 v221, 3, v218
    v_lshlrev_b32 v221, 8, v221
    v_lshl_add_u32 v221, v222, 4, v221
    v_lshrrev_b32 v220, 5, v0
    v_lshl_add_u32 v213, v220, 12, v221
    v_and_b32 v215, 15, v0
    v_lshlrev_b32 v215, 1, v215
    s_lshl2_add_u32 s73, s72, s58
    s_lshl_b32 s74, s73, 10
    s_add_u32 s74, s74, 29491200
    s_lshl2_add_u32 s75, s59, s74
    s_lshl2_add_u32 s76, s2, s3
    s_lshl_b32 s77, s76, 9
    s_add_u32 s77, s77, 29884416
    s_lshl3_add_u32 s78, s57, 7
    s_sub_u32 s78, s78, s56
    s_lshl_b32 s78, s78, 8
    s_add_u32 s78, s78, 29360128
    v_cmp_ne_u32 vcc, 0, v0
    v_mov_b32 v29, 0
    v_mov_b32 v206, -1
    v_bfrev_b32 v218, 1
    v_cndmask_b32 v28, 0, v218, vcc
    v_cmp_gt_u32 vcc, 4, v0
    v_lshlrev_b32 v219, 7, v0
    v_mov_b32 v209, 1
    v_cndmask_b32 v205, v218, v219, vcc
    s_min_u32 s65, s3, 1
    s_lshl_b32 s65, s65, 31
    v_lshl_or_b32 v207, v0, 2, s65
    v_or_b32 v214, s65, v28
    s_min_u32 s65, s76, 1
    s_lshl_b32 s65, s65, 31
    v_or_b32 v208, s65, v28
    v_cmp_lt_u32 s[68:69], 31, v0
    v_and_b32 v220, 16, v0
    v_cmp_ne_u32 s[66:67], 0, v220
    s_sub_u32 s16, 0, s83
    s_mov_b32 s17, s16
    s_sub_u32 s18, 0, s82
    s_mov_b32 s19, s18
    s_mov_b32 s42, 256
    s_mov_b32 s43, 0x20000
    s_mov_b32 s46, 2048
    s_mov_b32 s47, 0x20000
    s_mov_b32 s50, 2048
    s_mov_b32 s51, 0x20000
    s_mov_b32 s54, 2048
    s_mov_b32 s55, 0x20000
    s_lshl_b32 s26, s57, 6
    s_waitcnt lgkmcnt(0)
    buffer_store_dword v200, v205, s[4:7], s75 offen sc1
    buffer_store_dword v200, v205, s[4:7], s77 offen sc1
    buffer_store_dword v206, v207, s[4:7], s78 offen sc1
    s_waitcnt vmcnt(7)
    buffer_store_dword v209, v208, s[40:43], 0 offen sc1
    s_waitcnt vmcnt(4)
    v_readfirstlane_b32 s30, v32
    v_readfirstlane_b32 s31, v40
    v_lshlrev_b32 v48, 16, v32
    v_lshlrev_b32 v64, 16, v40
    v_and_b32 v49, 0xffff0000, v32
    v_and_b32 v65, 0xffff0000, v40
    v_lshlrev_b32 v50, 16, v33
    v_lshlrev_b32 v66, 16, v41
    v_and_b32 v51, 0xffff0000, v33
    s_add_u32 m0, s63, 0
    s_nop 0
    buffer_load_dwordx4 v2, s[8:11], s61 offen offset:0 lds
    v_and_b32 v67, 0xffff0000, v41
    v_lshlrev_b32 v52, 16, v34
    v_lshlrev_b32 v68, 16, v42
    v_and_b32 v53, 0xffff0000, v34
    v_and_b32 v69, 0xffff0000, v42
    s_lshl_b32 s30, s30, 16
    s_lshl_b32 s31, s31, 16
    v_lshlrev_b32 v54, 16, v35
    v_lshlrev_b32 v70, 16, v43
    buffer_load_dwordx4 v3, s[8:11], s61 offen offset:1024 lds
    v_and_b32 v55, 0xffff0000, v35
    v_and_b32 v71, 0xffff0000, v43
    v_lshlrev_b32 v56, 16, v36
    v_lshlrev_b32 v72, 16, v44
    v_and_b32 v57, 0xffff0000, v36
    v_and_b32 v73, 0xffff0000, v44
    v_lshlrev_b32 v58, 16, v37
    v_lshlrev_b32 v74, 16, v45
    v_and_b32 v59, 0xffff0000, v37
    buffer_load_dwordx4 v4, s[8:11], s61 offen offset:2048 lds
    v_and_b32 v75, 0xffff0000, v45
    v_lshlrev_b32 v60, 16, v38
    v_lshlrev_b32 v76, 16, v46
    v_and_b32 v61, 0xffff0000, v38
    v_and_b32 v77, 0xffff0000, v46
    v_lshlrev_b32 v62, 16, v39
    v_lshlrev_b32 v78, 16, v47
    v_and_b32 v63, 0xffff0000, v39
    v_and_b32 v79, 0xffff0000, v47
    buffer_load_dwordx4 v5, s[8:11], s61 offen offset:3072 lds
    v_pk_add_f32 v[48:49], v[48:49], s[30:31] op_sel_hi:[1,0] neg_lo:[0,1] neg_hi:[0,1]
    v_pk_add_f32 v[64:65], v[64:65], s[30:31] op_sel:[0,1] neg_lo:[0,1] neg_hi:[0,1]
    v_pk_mul_f32 v[82:83], v[48:49], v[48:49]
    v_pk_mul_f32 v[90:91], v[64:65], v[64:65]
    v_pk_add_f32 v[50:51], v[50:51], s[30:31] op_sel_hi:[1,0] neg_lo:[0,1] neg_hi:[0,1]
    v_pk_add_f32 v[66:67], v[66:67], s[30:31] op_sel:[0,1] neg_lo:[0,1] neg_hi:[0,1]
    v_pk_fma_f32 v[82:83], v[50:51], v[50:51], v[82:83]
    v_pk_fma_f32 v[90:91], v[66:67], v[66:67], v[90:91]
    v_pk_add_f32 v[80:81], v[50:51], v[48:49]
    s_add_u32 m0, s63, 4096
    s_nop 0
    buffer_load_dwordx4 v6, s[8:11], s61 offen offset:0 lds
    v_pk_add_f32 v[88:89], v[66:67], v[64:65]
    v_pk_add_f32 v[52:53], v[52:53], s[30:31] op_sel_hi:[1,0] neg_lo:[0,1] neg_hi:[0,1]
    v_pk_add_f32 v[68:69], v[68:69], s[30:31] op_sel:[0,1] neg_lo:[0,1] neg_hi:[0,1]
    v_pk_fma_f32 v[82:83], v[52:53], v[52:53], v[82:83]
    v_pk_fma_f32 v[90:91], v[68:69], v[68:69], v[90:91]
    v_pk_add_f32 v[80:81], v[52:53], v[80:81]
    v_pk_add_f32 v[88:89], v[68:69], v[88:89]
    v_pk_add_f32 v[54:55], v[54:55], s[30:31] op_sel_hi:[1,0] neg_lo:[0,1] neg_hi:[0,1]
    v_pk_add_f32 v[70:71], v[70:71], s[30:31] op_sel:[0,1] neg_lo:[0,1] neg_hi:[0,1]
    buffer_load_dwordx4 v7, s[8:11], s61 offen offset:1024 lds
    v_pk_fma_f32 v[82:83], v[54:55], v[54:55], v[82:83]
    v_pk_fma_f32 v[90:91], v[70:71], v[70:71], v[90:91]
    v_pk_add_f32 v[80:81], v[54:55], v[80:81]
    v_pk_add_f32 v[88:89], v[70:71], v[88:89]
    v_pk_add_f32 v[56:57], v[56:57], s[30:31] op_sel_hi:[1,0] neg_lo:[0,1] neg_hi:[0,1]
    v_pk_add_f32 v[72:73], v[72:73], s[30:31] op_sel:[0,1] neg_lo:[0,1] neg_hi:[0,1]
    v_pk_fma_f32 v[82:83], v[56:57], v[56:57], v[82:83]
    v_pk_fma_f32 v[90:91], v[72:73], v[72:73], v[90:91]
    v_pk_add_f32 v[80:81], v[56:57], v[80:81]
    buffer_load_dwordx4 v8, s[8:11], s61 offen offset:2048 lds
    s_add_u32 s61, s61, 458752
    v_pk_add_f32 v[88:89], v[72:73], v[88:89]
    v_pk_add_f32 v[58:59], v[58:59], s[30:31] op_sel_hi:[1,0] neg_lo:[0,1] neg_hi:[0,1]
    v_pk_add_f32 v[74:75], v[74:75], s[30:31] op_sel:[0,1] neg_lo:[0,1] neg_hi:[0,1]
    v_pk_fma_f32 v[82:83], v[58:59], v[58:59], v[82:83]
    v_pk_fma_f32 v[90:91], v[74:75], v[74:75], v[90:91]
    v_pk_add_f32 v[80:81], v[58:59], v[80:81]
    v_pk_add_f32 v[88:89], v[74:75], v[88:89]
    v_pk_add_f32 v[60:61], v[60:61], s[30:31] op_sel_hi:[1,0] neg_lo:[0,1] neg_hi:[0,1]
    v_pk_add_f32 v[76:77], v[76:77], s[30:31] op_sel:[0,1] neg_lo:[0,1] neg_hi:[0,1]
    s_add_u32 m0, s64, 0
    s_nop 0
    buffer_load_dwordx4 v9, s[12:15], s62 offen offset:0 lds
    v_pk_fma_f32 v[82:83], v[60:61], v[60:61], v[82:83]
    v_pk_fma_f32 v[90:91], v[76:77], v[76:77], v[90:91]
    v_pk_add_f32 v[80:81], v[60:61], v[80:81]
    v_pk_add_f32 v[88:89], v[76:77], v[88:89]
    v_pk_add_f32 v[62:63], v[62:63], s[30:31] op_sel_hi:[1,0] neg_lo:[0,1] neg_hi:[0,1]
    v_pk_add_f32 v[78:79], v[78:79], s[30:31] op_sel:[0,1] neg_lo:[0,1] neg_hi:[0,1]
    v_pk_fma_f32 v[82:83], v[62:63], v[62:63], v[82:83]
    v_pk_fma_f32 v[90:91], v[78:79], v[78:79], v[90:91]
    v_pk_add_f32 v[80:81], v[62:63], v[80:81]
    buffer_load_dwordx4 v10, s[12:15], s62 offen offset:1024 lds
    s_add_u32 s62, s62, 128
    v_pk_add_f32 v[88:89], v[78:79], v[88:89]
    v_add_f32 v82, v82, v83
    v_add_f32 v90, v90, v91
    v_add_f32 v80, v80, v81
    v_add_f32 v88, v88, v89
    v_mov_b32 v84, s30
    v_mov_b32 v85, s31
    v_permlane32_swap_b32 v82, v90
    v_permlane32_swap_b32 v80, v88
    v_add_f32 v82, v82, v90
    v_add_f32 v80, v80, v88
    v_cndmask_b32 v84, v84, v85, s[68:69]
    s_nop 0
    v_permlane16_swap_b32 v80, v82
    v_add_f32 v80, v80, v82
    s_nop 1
    v_add_f32_dpp v80, v80, v80 quad_perm:[1,0,3,2] row_mask:0xf bank_mask:0xf
    s_nop 1
    v_add_f32_dpp v80, v80, v80 quad_perm:[2,3,0,1] row_mask:0xf bank_mask:0xf
    s_nop 1
    v_add_f32_dpp v80, v80, v80 row_ror:4 row_mask:0xf bank_mask:0xf
    s_nop 1
    v_add_f32_dpp v80, v80, v80 row_ror:8 row_mask:0xf bank_mask:0xf
    v_mul_f32 v80, 0x3a800000, v80
    v_mov_b32 v82, v80
    s_nop 1
    v_permlane16_swap_b32 v80, v82
    v_fma_f32 v82, -v80, v80, v82
    v_add_f32 v80, v80, v84
    v_max_f32 v82, 0, v82
    v_cvt_pk_bf16_f32 v80, v80, v82
    v_and_b32 v82, 0xffff0000, v80
    v_lshlrev_b32 v80, 16, v80
    v_add_f32 v82, 0x3727c5ac, v82
    v_cvt_pk_bf16_f32 v82, v82, v82
    v_lshlrev_b32 v82, 16, v82
    v_sqrt_f32 v82, v82
    v_sub_f32 v80, v84, v80
    v_cvt_pk_bf16_f32 v82, v82, v82
    v_lshlrev_b32 v82, 16, v82
    v_rcp_f32 v82, v82
    s_nop 0
    v_mul_f32 v80, v80, v82
    v_readlane_b32 s30, v82, 0
    v_readlane_b32 s34, v82, 32
    v_readlane_b32 s31, v80, 0
    v_readlane_b32 s35, v80, 32
    s_nop 1
    v_pk_fma_f32 v[48:49], v[48:49], s[30:31], s[30:31] op_sel:[0,0,1] op_sel_hi:[1,0,1]
    v_pk_fma_f32 v[64:65], v[64:65], s[34:35], s[34:35] op_sel:[0,0,1] op_sel_hi:[1,0,1]
    v_cvt_pk_bf16_f32 v80, v48, v49
    v_cvt_pk_bf16_f32 v88, v64, v65
    v_pk_fma_f32 v[50:51], v[50:51], s[30:31], s[30:31] op_sel:[0,0,1] op_sel_hi:[1,0,1]
    v_pk_fma_f32 v[66:67], v[66:67], s[34:35], s[34:35] op_sel:[0,0,1] op_sel_hi:[1,0,1]
    v_cvt_pk_bf16_f32 v81, v50, v51
    v_cvt_pk_bf16_f32 v89, v66, v67
    v_pk_fma_f32 v[52:53], v[52:53], s[30:31], s[30:31] op_sel:[0,0,1] op_sel_hi:[1,0,1]
    v_pk_fma_f32 v[68:69], v[68:69], s[34:35], s[34:35] op_sel:[0,0,1] op_sel_hi:[1,0,1]
    v_cvt_pk_bf16_f32 v82, v52, v53
    v_cvt_pk_bf16_f32 v90, v68, v69
    v_pk_fma_f32 v[54:55], v[54:55], s[30:31], s[30:31] op_sel:[0,0,1] op_sel_hi:[1,0,1]
    v_pk_fma_f32 v[70:71], v[70:71], s[34:35], s[34:35] op_sel:[0,0,1] op_sel_hi:[1,0,1]
    v_cvt_pk_bf16_f32 v83, v54, v55
    v_cvt_pk_bf16_f32 v91, v70, v71
    ds_write_b128 v210, v[80:83] offset:0
    ds_write_b128 v211, v[88:91] offset:0
    v_pk_fma_f32 v[56:57], v[56:57], s[30:31], s[30:31] op_sel:[0,0,1] op_sel_hi:[1,0,1]
    v_pk_fma_f32 v[72:73], v[72:73], s[34:35], s[34:35] op_sel:[0,0,1] op_sel_hi:[1,0,1]
    v_cvt_pk_bf16_f32 v84, v56, v57
    v_cvt_pk_bf16_f32 v92, v72, v73
    v_pk_fma_f32 v[58:59], v[58:59], s[30:31], s[30:31] op_sel:[0,0,1] op_sel_hi:[1,0,1]
    v_pk_fma_f32 v[74:75], v[74:75], s[34:35], s[34:35] op_sel:[0,0,1] op_sel_hi:[1,0,1]
    v_cvt_pk_bf16_f32 v85, v58, v59
    v_cvt_pk_bf16_f32 v93, v74, v75
    v_pk_fma_f32 v[60:61], v[60:61], s[30:31], s[30:31] op_sel:[0,0,1] op_sel_hi:[1,0,1]
    v_pk_fma_f32 v[76:77], v[76:77], s[34:35], s[34:35] op_sel:[0,0,1] op_sel_hi:[1,0,1]
    v_cvt_pk_bf16_f32 v86, v60, v61
    v_cvt_pk_bf16_f32 v94, v76, v77
    v_pk_fma_f32 v[62:63], v[62:63], s[30:31], s[30:31] op_sel:[0,0,1] op_sel_hi:[1,0,1]
    v_pk_fma_f32 v[78:79], v[78:79], s[34:35], s[34:35] op_sel:[0,0,1] op_sel_hi:[1,0,1]
    v_cvt_pk_bf16_f32 v87, v62, v63
    v_cvt_pk_bf16_f32 v95, v78, v79
    ds_write_b128 v210, v[84:87] offset:8192
    ds_write_b128 v211, v[92:95] offset:8192
    s_waitcnt lgkmcnt(0)
    s_barrier
    ds_read_b128 v[48:51], v212 offset:0
    ds_read_b128 v[52:55], v212 offset:1024
    ds_read_b128 v[56:59], v212 offset:2048
    ds_read_b128 v[60:63], v212 offset:3072
    s_waitcnt lgkmcnt(3)
    buffer_store_dwordx4 v[48:51], v213, s[4:7], s70 offen sc1
    s_add_u32 s70, s70, 8192
    s_waitcnt lgkmcnt(2)
    buffer_store_dwordx4 v[52:55], v213, s[4:7], s70 offen sc1
    s_add_u32 s70, s70, 8192
    s_waitcnt lgkmcnt(1)
    buffer_store_dwordx4 v[56:59], v213, s[4:7], s70 offen sc1
    s_add_u32 s70, s70, 8192
    s_waitcnt lgkmcnt(0)
    buffer_store_dwordx4 v[60:63], v213, s[4:7], s70 offen sc1
    s_add_u32 s70, s70, 8192
    buffer_load_dword v31, v29, s[40:43], 0 offen sc1
    buffer_load_ushort v96, v215, s[44:47], s26 offen offset:0
    buffer_load_ushort v97, v215, s[48:51], s26 offen offset:0
    buffer_load_ushort v98, v215, s[52:55], s26 offen offset:0
    buffer_load_ushort v100, v215, s[44:47], s26 offen offset:32
    buffer_load_ushort v101, v215, s[48:51], s26 offen offset:32
    buffer_load_ushort v102, v215, s[52:55], s26 offen offset:32
    s_mov_b64 s[48:49], s[80:81]
    buffer_load_ushort v17, v215, s[48:51], s26 offen
    s_mov_b64 s[80:81], s[20:21]
    s_bitcmp1_b32 s2, 0
    s_cselect_b64 s[20:21], s[32:33], s[28:29]
    s_cmp_eq_u32 s3, 3
    s_cselect_b64 s[20:21], s[20:21], s[24:25]
    s_cselect_b32 s22, 2097152, s10
    s_lshl1_add_u32 s71, s2, s83
    s_mul_i32 s65, s71, 896
    v_add_u32 v221, s65, v219
    s_lshl_b32 s65, s71, 12
    v_add_u32 v217, s65, v219
    s_mov_b32 s71, 457856
    v_mul_u32_u24 v220, 9363, v0
    v_lshrrev_b32 v220, 16, v220
    v_mul_lo_u32 v220, v220, s71
    v_cndmask_b32 v217, v217, v218, s[68:69]
    v_cmp_gt_u32 vcc, 14, v0
    v_add_u32 v220, v220, v221
    v_add_u32 v216, 458752, v220
    v_cndmask_b32 v216, v218, v216, vcc
    buffer_load_dword v17, v216, s[8:11], 0 offen
    v_and_b32 v216, 15, v0
    v_cmp_gt_u32 vcc, 4, v216
    v_add_u32 v23, 512, v217
    v_cmp_gt_u32 s[0:1], 4, v216
    v_cndmask_b32 v23, v218, v23, vcc
    s_nop 0
    v_cndmask_b32 v217, v218, v217, s[0:1]
    buffer_load_dword v17, v217, s[12:15], 0 offen
    v_cmp_gt_u32 vcc, 0, v0
    v_add_u32 v22, 1376256, v220
    v_add_u32 v21, 1376256, v220
    v_cndmask_b32 v22, v218, v22, vcc
    v_cmp_gt_u32 vcc, 7, v0
    s_lshr_b32 s26, s2, 1
    s_mul_i32 s26, s26, 1664
    v_cndmask_b32 v21, v218, v21, vcc
    s_mul_i32 s27, s2, 3
    s_add_u32 s27, s27, s3
    s_mul_i32 s27, s27, 1024
    s_cmp_eq_u32 s3, 3
    s_cselect_b32 s26, s26, s27
    s_mov_b32 s27, 786432
    s_cselect_b32 s27, 212992, s27
    s_cselect_b32 s65, 13, 8
    v_cmp_gt_u32 vcc, s65, v0
    v_add_u32 v20, s26, v219
    s_nop 0
    v_cndmask_b32 v20, v218, v20, vcc
    v_and_b32 v222, 7, v0
    v_lshrrev_b32 v220, 3, v0
    v_lshlrev_b32 v30, 2, v222
    s_lshl_b32 s65, s3, 10
    s_add_u32 s65, s65, s39
    v_lshl_add_u32 v26, v220, 7, v30
    v_lshrrev_b32 v220, 5, v0
    v_add_u32 v26, s65, v26
    v_bfe_u32 v221, v0, 2, 3
    v_lshl_add_u32 v221, v220, 4, v221
    v_mul_u32_u24 v221, 224, v221
    v_and_b32 v222, 3, v0
    v_lshl_add_u32 v11, v222, 3, v221
    v_add_u32 v14, 73728, v11
    v_bfe_u32 v221, v0, 1, 3
    v_lshrrev_b32 v220, 4, v0
    v_xor_b32 v221, v221, v220
    v_and_b32 v222, 15, v0
    v_lshlrev_b32 v222, 7, v222
    v_lshl_add_u32 v221, v221, 4, v222
    v_add_u32 v12, 28672, v221
    v_xor_b32 v13, 64, v12
    v_add_u32 v15, 73728, v12
    v_add_u32 v16, 73728, v13
    s_waitcnt vmcnt(9)
    v_cmp_ne_u32 vcc, 1, v31
    s_cbranch_vccnz L_far1
L_back1:
    s_barrier
    buffer_store_dword v209, v214, s[4:7], s79 offen sc1
    s_waitcnt vmcnt(4)
    v_lshlrev_b32 v96, 16, v96
    v_lshlrev_b32 v100, 16, v100
    v_lshlrev_b32 v97, 16, v97
    v_lshlrev_b32 v101, 16, v101
    v_lshlrev_b32 v98, 16, v98
    v_lshlrev_b32 v102, 16, v102
    v_mul_f32 v98, 0x3fb8aa3b, v98
    v_mul_f32 v102, 0x3fb8aa3b, v102
    v_exp_f32 v98, v98
    v_exp_f32 v102, v102
    v_mul_f32 v136, v96, v96
    v_mul_f32 v176, v100, v100
    v_cvt_pk_bf16_f32 v98, v98, v98
    v_cvt_pk_bf16_f32 v102, v102, v102
    v_lshlrev_b32 v98, 16, v98
    v_lshlrev_b32 v102, 16, v102
    v_mul_f32 v132, v98, v96
    v_mul_f32 v172, v102, v100
    v_mul_f32 v133, v98, v97
    v_mul_f32 v173, v102, v101
    v_mul_f32 v132, 0x3fb8aa3b, v132
    v_mul_f32 v172, 0x3fb8aa3b, v172
    v_mul_f32 v133, 0.15915494, v133
    v_mul_f32 v173, 0.15915494, v173
    v_exp_f32 v132, v132
    v_exp_f32 v172, v172
    v_rndne_f32 v134, v133
    v_rndne_f32 v174, v173
    v_sub_f32 v133, v133, v134
    v_sub_f32 v173, v173, v174
    v_cos_f32 v134, v133
    v_cos_f32 v174, v173
    v_sin_f32 v135, v133
    v_sin_f32 v175, v173
    v_fmac_f32 v136, v97, v97
    v_fmac_f32 v176, v101, v101
    v_mul_f32 v112, v132, v134
    v_mul_f32 v152, v172, v174
    v_mul_f32 v113, v132, v135
    v_mul_f32 v153, v172, v175
    v_rcp_f32 v136, v136
    v_rcp_f32 v176, v176
    v_add_f32 v132, -1.0, v112
    v_add_f32 v172, -1.0, v152
    v_add_f32 v136, v136, v136
    v_add_f32 v176, v176, v176
    v_mul_f32 v133, v132, v96
    v_mul_f32 v173, v172, v100
    v_mul_f32 v134, v113, v96
    v_mul_f32 v174, v153, v100
    v_fmac_f32 v133, v113, v97
    v_fmac_f32 v173, v153, v101
    v_fma_f32 v134, -v132, v97, v134
    v_fma_f32 v174, -v172, v101, v174
    v_mul_f32 v114, v133, v136
    v_mul_f32 v154, v173, v176
    v_mul_f32 v115, v134, v136
    v_mul_f32 v155, v174, v176
    v_pk_mul_f32 v[132:133], v[112:113], v[112:113] op_sel_hi:[0,1]
    v_pk_mul_f32 v[172:173], v[152:153], v[152:153] op_sel_hi:[0,1]
    v_pk_fma_f32 v[132:133], v[112:113], v[112:113], v[132:133] op_sel:[1,1,0] op_sel_hi:[1,0,1] neg_lo:[1,0,0]
    v_pk_fma_f32 v[172:173], v[152:153], v[152:153], v[172:173] op_sel:[1,1,0] op_sel_hi:[1,0,1] neg_lo:[1,0,0]
    v_pk_mul_f32 v[134:135], v[132:133], v[132:133] op_sel_hi:[0,1]
    v_pk_mul_f32 v[174:175], v[172:173], v[172:173] op_sel_hi:[0,1]
    v_pk_fma_f32 v[134:135], v[132:133], v[132:133], v[134:135] op_sel:[1,1,0] op_sel_hi:[1,0,1] neg_lo:[1,0,0]
    v_pk_fma_f32 v[174:175], v[172:173], v[172:173], v[174:175] op_sel:[1,1,0] op_sel_hi:[1,0,1] neg_lo:[1,0,0]
    v_pk_mul_f32 v[132:133], v[134:135], v[134:135] op_sel_hi:[0,1]
    v_pk_mul_f32 v[172:173], v[174:175], v[174:175] op_sel_hi:[0,1]
    v_pk_fma_f32 v[132:133], v[134:135], v[134:135], v[132:133] op_sel:[1,1,0] op_sel_hi:[1,0,1] neg_lo:[1,0,0]
    v_pk_fma_f32 v[172:173], v[174:175], v[174:175], v[172:173] op_sel:[1,1,0] op_sel_hi:[1,0,1] neg_lo:[1,0,0]
    v_pk_mul_f32 v[116:117], v[132:133], v[132:133] op_sel_hi:[0,1]
    v_pk_mul_f32 v[156:157], v[172:173], v[172:173] op_sel_hi:[0,1]
    v_pk_fma_f32 v[116:117], v[132:133], v[132:133], v[116:117] op_sel:[1,1,0] op_sel_hi:[1,0,1] neg_lo:[1,0,0]
    v_pk_fma_f32 v[156:157], v[172:173], v[172:173], v[156:157] op_sel:[1,1,0] op_sel_hi:[1,0,1] neg_lo:[1,0,0]
    v_pk_mul_f32 v[118:119], v[116:117], v[116:117] op_sel_hi:[0,1]
    v_pk_mul_f32 v[158:159], v[156:157], v[156:157] op_sel_hi:[0,1]
    v_pk_fma_f32 v[118:119], v[116:117], v[116:117], v[118:119] op_sel:[1,1,0] op_sel_hi:[1,0,1] neg_lo:[1,0,0]
    v_pk_fma_f32 v[158:159], v[156:157], v[156:157], v[158:159] op_sel:[1,1,0] op_sel_hi:[1,0,1] neg_lo:[1,0,0]
    v_pk_mul_f32 v[120:121], v[118:119], v[118:119] op_sel_hi:[0,1]
    v_pk_mul_f32 v[160:161], v[158:159], v[158:159] op_sel_hi:[0,1]
    v_pk_fma_f32 v[120:121], v[118:119], v[118:119], v[120:121] op_sel:[1,1,0] op_sel_hi:[1,0,1] neg_lo:[1,0,0]
    v_pk_fma_f32 v[160:161], v[158:159], v[158:159], v[160:161] op_sel:[1,1,0] op_sel_hi:[1,0,1] neg_lo:[1,0,0]
    v_pk_mul_f32 v[122:123], v[120:121], v[120:121] op_sel_hi:[0,1]
    v_pk_mul_f32 v[162:163], v[160:161], v[160:161] op_sel_hi:[0,1]
    v_pk_fma_f32 v[122:123], v[120:121], v[120:121], v[122:123] op_sel:[1,1,0] op_sel_hi:[1,0,1] neg_lo:[1,0,0]
    v_pk_fma_f32 v[162:163], v[160:161], v[160:161], v[162:163] op_sel:[1,1,0] op_sel_hi:[1,0,1] neg_lo:[1,0,0]
    v_pk_mul_f32 v[124:125], v[122:123], v[122:123] op_sel_hi:[0,1]
    v_pk_mul_f32 v[164:165], v[162:163], v[162:163] op_sel_hi:[0,1]
    v_pk_fma_f32 v[124:125], v[122:123], v[122:123], v[124:125] op_sel:[1,1,0] op_sel_hi:[1,0,1] neg_lo:[1,0,0]
    v_pk_fma_f32 v[164:165], v[162:163], v[162:163], v[164:165] op_sel:[1,1,0] op_sel_hi:[1,0,1] neg_lo:[1,0,0]
    v_pk_mul_f32 v[126:127], v[124:125], v[124:125] op_sel_hi:[0,1]
    v_pk_mul_f32 v[166:167], v[164:165], v[164:165] op_sel_hi:[0,1]
    v_pk_fma_f32 v[126:127], v[124:125], v[124:125], v[126:127] op_sel:[1,1,0] op_sel_hi:[1,0,1] neg_lo:[1,0,0]
    v_pk_fma_f32 v[166:167], v[164:165], v[164:165], v[166:167] op_sel:[1,1,0] op_sel_hi:[1,0,1] neg_lo:[1,0,0]
    v_pk_mul_f32 v[128:129], v[126:127], v[126:127] op_sel_hi:[0,1]
    v_pk_mul_f32 v[168:169], v[166:167], v[166:167] op_sel_hi:[0,1]
    v_pk_fma_f32 v[128:129], v[126:127], v[126:127], v[128:129] op_sel:[1,1,0] op_sel_hi:[1,0,1] neg_lo:[1,0,0]
    v_pk_fma_f32 v[168:169], v[166:167], v[166:167], v[168:169] op_sel:[1,1,0] op_sel_hi:[1,0,1] neg_lo:[1,0,0]
    v_cndmask_b32 v132, 1.0, v120, s[16:17]
    v_cndmask_b32 v172, 1.0, v160, s[16:17]
    v_cndmask_b32 v133, 0, v121, s[16:17]
    v_cndmask_b32 v173, 0, v161, s[16:17]
    v_cndmask_b32 v134, 1.0, v122, s[18:19]
    v_cndmask_b32 v174, 1.0, v162, s[18:19]
    v_cndmask_b32 v135, 0, v123, s[18:19]
    v_cndmask_b32 v175, 0, v163, s[18:19]
    v_pk_mul_f32 v[138:139], v[132:133], v[134:135] op_sel_hi:[0,1]
    v_pk_mul_f32 v[178:179], v[172:173], v[174:175] op_sel_hi:[0,1]
    v_pk_fma_f32 v[138:139], v[132:133], v[134:135], v[138:139] op_sel:[1,1,0] op_sel_hi:[1,0,1] neg_lo:[1,0,0]
    v_pk_fma_f32 v[178:179], v[172:173], v[174:175], v[178:179] op_sel:[1,1,0] op_sel_hi:[1,0,1] neg_lo:[1,0,0]
    v_cndmask_b32 v132, 1.0, v116, s[66:67]
    v_cndmask_b32 v172, 1.0, v156, s[66:67]
    v_cndmask_b32 v133, 0, v117, s[66:67]
    v_cndmask_b32 v173, 0, v157, s[66:67]
    v_cndmask_b32 v134, 1.0, v118, s[68:69]
    v_cndmask_b32 v174, 1.0, v158, s[68:69]
    v_cndmask_b32 v135, 0, v119, s[68:69]
    v_cndmask_b32 v175, 0, v159, s[68:69]
    v_pk_mul_f32 v[122:123], v[132:133], v[134:135] op_sel_hi:[0,1]
    v_pk_mul_f32 v[162:163], v[172:173], v[174:175] op_sel_hi:[0,1]
    v_pk_fma_f32 v[122:123], v[132:133], v[134:135], v[122:123] op_sel:[1,1,0] op_sel_hi:[1,0,1] neg_lo:[1,0,0]
    v_pk_fma_f32 v[162:163], v[172:173], v[174:175], v[162:163] op_sel:[1,1,0] op_sel_hi:[1,0,1] neg_lo:[1,0,0]
    v_cndmask_b32 v132, 1.0, v124, s[66:67]
    v_cndmask_b32 v172, 1.0, v164, s[66:67]
    v_cndmask_b32 v133, 0, v125, s[66:67]
    v_cndmask_b32 v173, 0, v165, s[66:67]
    v_cndmask_b32 v134, 1.0, v126, s[68:69]
    v_cndmask_b32 v174, 1.0, v166, s[68:69]
    v_cndmask_b32 v135, 0, v127, s[68:69]
    v_cndmask_b32 v175, 0, v167, s[68:69]
    v_pk_mul_f32 v[124:125], v[132:133], v[134:135] op_sel_hi:[0,1]
    v_pk_mul_f32 v[164:165], v[172:173], v[174:175] op_sel_hi:[0,1]
    v_pk_fma_f32 v[124:125], v[132:133], v[134:135], v[124:125] op_sel:[1,1,0] op_sel_hi:[1,0,1] neg_lo:[1,0,0]
    v_pk_fma_f32 v[164:165], v[172:173], v[174:175], v[164:165] op_sel:[1,1,0] op_sel_hi:[1,0,1] neg_lo:[1,0,0]
    v_pk_mul_f32 v[126:127], v[122:123], v[138:139] op_sel_hi:[0,1]
    v_pk_mul_f32 v[166:167], v[162:163], v[178:179] op_sel_hi:[0,1]
    v_pk_fma_f32 v[126:127], v[122:123], v[138:139], v[126:127] op_sel:[1,1,0] op_sel_hi:[1,0,1] neg_lo:[1,0,0]
    v_pk_fma_f32 v[166:167], v[162:163], v[178:179], v[166:167] op_sel:[1,1,0] op_sel_hi:[1,0,1] neg_lo:[1,0,0]
    v_accvgpr_write_b32 a88, v112
    v_accvgpr_write_b32 a106, v152
    v_accvgpr_write_b32 a89, v113
    v_accvgpr_write_b32 a107, v153
    v_accvgpr_write_b32 a90, v114
    v_accvgpr_write_b32 a108, v154
    v_accvgpr_write_b32 a91, v115
    v_accvgpr_write_b32 a109, v155
    v_accvgpr_write_b32 a92, v116
    v_accvgpr_write_b32 a110, v156
    v_accvgpr_write_b32 a93, v117
    v_accvgpr_write_b32 a111, v157
    v_accvgpr_write_b32 a94, v118
    v_accvgpr_write_b32 a112, v158
    v_accvgpr_write_b32 a95, v119
    v_accvgpr_write_b32 a113, v159
    v_accvgpr_write_b32 a96, v120
    v_accvgpr_write_b32 a114, v160
    v_accvgpr_write_b32 a97, v121
    v_accvgpr_write_b32 a115, v161
    v_accvgpr_write_b32 a98, v122
    v_accvgpr_write_b32 a116, v162
    v_accvgpr_write_b32 a99, v123
    v_accvgpr_write_b32 a117, v163
    v_accvgpr_write_b32 a100, v124
    v_accvgpr_write_b32 a118, v164
    v_accvgpr_write_b32 a101, v125
    v_accvgpr_write_b32 a119, v165
    v_accvgpr_write_b32 a102, v126
    v_accvgpr_write_b32 a120, v166
    v_accvgpr_write_b32 a103, v127
    v_accvgpr_write_b32 a121, v167
    v_accvgpr_write_b32 a104, v128
    v_accvgpr_write_b32 a122, v168
    v_accvgpr_write_b32 a105, v129
    v_accvgpr_write_b32 a123, v169
    ds_read_b64_tr_b16 a[64:65], v11 offset:0
    ds_read_b64_tr_b16 a[66:67], v11 offset:1792
    ds_read_b64_tr_b16 a[68:69], v11 offset:7168
    ds_read_b64_tr_b16 a[70:71], v11 offset:8960
    ds_read_b64_tr_b16 a[72:73], v11 offset:14336
    ds_read_b64_tr_b16 a[74:75], v11 offset:16128
    ds_read_b64_tr_b16 a[76:77], v11 offset:21504
    ds_read_b64_tr_b16 a[78:79], v11 offset:23296
    s_lshl_b32 s65, s72, 7
    s_add_u32 s65, s65, 29425664
    v_cmp_gt_u32 vcc, 8, v0
    s_nop 1
    v_cndmask_b32 v30, v28, v30, vcc
    s_mov_b32 s71, 2097152
L_poll2:
    buffer_load_dword v31, v30, s[4:7], s65 offen sc1
    s_sub_u32 s71, s71, 1
    s_waitcnt vmcnt(0)
    s_cbranch_scc1 L_go2
L_chk2:
    v_cmp_ne_u32 vcc, 1, v31
    s_and_b64 vcc, vcc, 0xff
    s_cbranch_vccnz L_poll2
L_go2:
    buffer_load_dwordx4 a[128:131], v1, s[4:7], s60 offen offset:0 sc1
    buffer_load_dwordx4 a[132:135], v1, s[4:7], s60 offen offset:1024 sc1
    buffer_load_dwordx4 a[136:139], v1, s[4:7], s60 offen offset:2048 sc1
    buffer_load_dwordx4 a[140:143], v1, s[4:7], s60 offen offset:3072 sc1
    s_add_u32 s60, s60, 4096
    buffer_load_dwordx4 a[144:147], v1, s[4:7], s60 offen offset:0 sc1
    buffer_load_dwordx4 a[148:151], v1, s[4:7], s60 offen offset:1024 sc1
    buffer_load_dwordx4 a[152:155], v1, s[4:7], s60 offen offset:2048 sc1
    buffer_load_dwordx4 a[156:159], v1, s[4:7], s60 offen offset:3072 sc1
    s_add_u32 s60, s60, 4096
    s_mov_b64 exec, 0
    s_cmp_eq_u32 s3, 0
    s_cbranch_scc1 L_pad0
    s_cmp_eq_u32 s3, 1
    s_cbranch_scc1 L_pad1
    s_cmp_eq_u32 s3, 2
    s_cbranch_scc1 L_pad2
    s_branch L_pad3
L_warm_ret:
    s_mov_b64 exec, -1
    s_waitcnt vmcnt(0) lgkmcnt(4)
    v_mfma_f32_16x16x32_bf16 v[96:99], a[64:67], a[128:131], 0
    ds_read_b64_tr_b16 a[80:81], v11 offset:32
    v_mfma_f32_16x16x32_bf16 v[96:99], a[68:71], a[144:147], v[96:99]
    ds_read_b64_tr_b16 a[82:83], v11 offset:1824
    v_mfma_f32_16x16x32_bf16 v[100:103], a[68:71], a[148:151], 0
    ds_read_b64_tr_b16 a[84:85], v11 offset:7200
    v_mfma_f32_16x16x32_bf16 v[100:103], a[64:67], a[132:135], v[100:103]
    ds_read_b64_tr_b16 a[86:87], v11 offset:8992
    s_add_u32 m0, s63, 36864
    v_mfma_f32_16x16x32_bf16 v[104:107], a[64:67], a[136:139], 0
    buffer_load_dwordx4 v2, s[8:11], s61 offen offset:0 lds
    v_mfma_f32_16x16x32_bf16 v[104:107], a[68:71], a[152:155], v[104:107]
    v_mfma_f32_16x16x32_bf16 v[108:111], a[68:71], a[156:159], 0
    buffer_load_dwordx4 v3, s[8:11], s61 offen offset:1024 lds
    v_mfma_f32_16x16x32_bf16 v[108:111], a[64:67], a[140:143], v[108:111]
    s_waitcnt lgkmcnt(0)
    v_mfma_f32_16x16x32_bf16 v[124:127], a[72:75], a[140:143], 0
    ds_read_b64_tr_b16 a[64:65], v11 offset:14368
    v_mfma_f32_16x16x32_bf16 v[124:127], a[76:79], a[156:159], v[124:127]
    ds_read_b64_tr_b16 a[66:67], v11 offset:16160
    v_mfma_f32_16x16x32_bf16 v[120:123], a[76:79], a[152:155], 0
    ds_read_b64_tr_b16 a[68:69], v11 offset:21536
    v_mfma_f32_16x16x32_bf16 v[120:123], a[72:75], a[136:139], v[120:123]
    ds_read_b64_tr_b16 a[70:71], v11 offset:23328
    v_mfma_f32_16x16x32_bf16 v[116:119], a[72:75], a[132:135], 0
    v_mfma_f32_16x16x32_bf16 v[116:119], a[76:79], a[148:151], v[116:119]
    buffer_load_dwordx4 v4, s[8:11], s61 offen offset:2048 lds
    v_mfma_f32_16x16x32_bf16 v[112:115], a[76:79], a[144:147], 0
    v_mfma_f32_16x16x32_bf16 v[112:115], a[72:75], a[128:131], v[112:115]
    v_mfma_f32_16x16x32_bf16 v[128:131], a[80:83], a[128:131], 0
    ds_read_b64_tr_b16 a[72:73], v11 offset:64
    v_mfma_f32_16x16x32_bf16 v[128:131], a[84:87], a[144:147], v[128:131]
    ds_read_b64_tr_b16 a[74:75], v11 offset:1856
    v_mfma_f32_16x16x32_bf16 v[132:135], a[84:87], a[148:151], 0
    ds_read_b64_tr_b16 a[76:77], v11 offset:7232
    v_mfma_f32_16x16x32_bf16 v[132:135], a[80:83], a[132:135], v[132:135]
    ds_read_b64_tr_b16 a[78:79], v11 offset:9024
    v_mfma_f32_16x16x32_bf16 v[136:139], a[80:83], a[136:139], 0
    v_mfma_f32_16x16x32_bf16 v[136:139], a[84:87], a[152:155], v[136:139]
    buffer_load_dwordx4 v5, s[8:11], s61 offen offset:3072 lds
    v_mfma_f32_16x16x32_bf16 v[140:143], a[84:87], a[156:159], 0
    v_mfma_f32_16x16x32_bf16 v[140:143], a[80:83], a[140:143], v[140:143]
    s_waitcnt lgkmcnt(0)
    v_mfma_f32_16x16x32_bf16 v[156:159], a[64:67], a[140:143], 0
    ds_read_b64_tr_b16 a[80:81], v11 offset:14400
    v_mfma_f32_16x16x32_bf16 v[156:159], a[68:71], a[156:159], v[156:159]
    ds_read_b64_tr_b16 a[82:83], v11 offset:16192
    v_mfma_f32_16x16x32_bf16 v[152:155], a[68:71], a[152:155], 0
    ds_read_b64_tr_b16 a[84:85], v11 offset:21568
    v_mfma_f32_16x16x32_bf16 v[152:155], a[64:67], a[136:139], v[152:155]
    ds_read_b64_tr_b16 a[86:87], v11 offset:23360
    s_add_u32 m0, s63, 40960
    v_mfma_f32_16x16x32_bf16 v[148:151], a[64:67], a[132:135], 0
    buffer_load_dwordx4 v6, s[8:11], s61 offen offset:0 lds
    v_mfma_f32_16x16x32_bf16 v[148:151], a[68:71], a[148:151], v[148:151]
    v_mfma_f32_16x16x32_bf16 v[144:147], a[68:71], a[144:147], 0
    buffer_load_dwordx4 v7, s[8:11], s61 offen offset:1024 lds
    v_mfma_f32_16x16x32_bf16 v[144:147], a[64:67], a[128:131], v[144:147]
    v_mfma_f32_16x16x32_bf16 v[160:163], a[72:75], a[128:131], 0
    ds_read_b64_tr_b16 a[64:65], v11 offset:96
    v_mfma_f32_16x16x32_bf16 v[160:163], a[76:79], a[144:147], v[160:163]
    ds_read_b64_tr_b16 a[66:67], v11 offset:1888
    v_mfma_f32_16x16x32_bf16 v[164:167], a[76:79], a[148:151], 0
    ds_read_b64_tr_b16 a[68:69], v11 offset:7264
    v_mfma_f32_16x16x32_bf16 v[164:167], a[72:75], a[132:135], v[164:167]
    ds_read_b64_tr_b16 a[70:71], v11 offset:9056
    v_mfma_f32_16x16x32_bf16 v[168:171], a[72:75], a[136:139], 0
    v_mfma_f32_16x16x32_bf16 v[168:171], a[76:79], a[152:155], v[168:171]
    buffer_load_dwordx4 v8, s[8:11], s61 offen offset:2048 lds
    s_add_u32 s61, s61, 458752
    v_mfma_f32_16x16x32_bf16 v[172:175], a[76:79], a[156:159], 0
    v_mfma_f32_16x16x32_bf16 v[172:175], a[72:75], a[140:143], v[172:175]
    s_waitcnt lgkmcnt(0)
    v_mfma_f32_16x16x32_bf16 v[188:191], a[80:83], a[140:143], 0
    ds_read_b64_tr_b16 a[72:73], v11 offset:14432
    v_mfma_f32_16x16x32_bf16 v[188:191], a[84:87], a[156:159], v[188:191]
    ds_read_b64_tr_b16 a[74:75], v11 offset:16224
    v_mfma_f32_16x16x32_bf16 v[184:187], a[84:87], a[152:155], 0
    ds_read_b64_tr_b16 a[76:77], v11 offset:21600
    v_mfma_f32_16x16x32_bf16 v[184:187], a[80:83], a[136:139], v[184:187]
    ds_read_b64_tr_b16 a[78:79], v11 offset:23392
    v_mfma_f32_16x16x32_bf16 v[180:183], a[80:83], a[132:135], 0
    v_mfma_f32_16x16x32_bf16 v[180:183], a[84:87], a[148:151], v[180:183]
    buffer_load_dword v31, v21, s[8:11], 0 offen
    v_add_u32 v21, 458752, v21
    v_mfma_f32_16x16x32_bf16 v[176:179], a[84:87], a[144:147], 0
    v_mfma_f32_16x16x32_bf16 v[176:179], a[80:83], a[128:131], v[176:179]
    v_mfma_f32_16x16x32_bf16 v[192:195], a[64:67], a[128:131], 0
    ds_read_b64_tr_b16 a[80:81], v11 offset:128
    v_mfma_f32_16x16x32_bf16 v[192:195], a[68:71], a[144:147], v[192:195]
    ds_read_b64_tr_b16 a[82:83], v11 offset:1920
    v_mfma_f32_16x16x32_bf16 v[196:199], a[68:71], a[148:151], 0
    ds_read_b64_tr_b16 a[84:85], v11 offset:7296
    v_mfma_f32_16x16x32_bf16 v[196:199], a[64:67], a[132:135], v[196:199]
    ds_read_b64_tr_b16 a[86:87], v11 offset:9088
    s_add_u32 m0, s64, 36864
    v_mfma_f32_16x16x32_bf16 v[200:203], a[64:67], a[136:139], 0
    buffer_load_dwordx4 v9, s[12:15], s62 offen offset:0 lds
    v_mfma_f32_16x16x32_bf16 v[200:203], a[68:71], a[152:155], v[200:203]
    v_mfma_f32_16x16x32_bf16 v[204:207], a[68:71], a[156:159], 0
    buffer_load_dwordx4 v10, s[12:15], s62 offen offset:1024 lds
    s_add_u32 s62, s62, 128
    v_mfma_f32_16x16x32_bf16 v[204:207], a[64:67], a[140:143], v[204:207]
    s_waitcnt lgkmcnt(0)
    v_mfma_f32_16x16x32_bf16 v[220:223], a[72:75], a[140:143], 0
    ds_read_b64_tr_b16 a[64:65], v11 offset:14464
    v_mfma_f32_16x16x32_bf16 v[220:223], a[76:79], a[156:159], v[220:223]
    ds_read_b64_tr_b16 a[66:67], v11 offset:16256
    v_mfma_f32_16x16x32_bf16 v[216:219], a[76:79], a[152:155], 0
    ds_read_b64_tr_b16 a[68:69], v11 offset:21632
    v_mfma_f32_16x16x32_bf16 v[216:219], a[72:75], a[136:139], v[216:219]
    ds_read_b64_tr_b16 a[70:71], v11 offset:23424
    v_mfma_f32_16x16x32_bf16 v[212:215], a[72:75], a[132:135], 0
    v_mfma_f32_16x16x32_bf16 v[212:215], a[76:79], a[148:151], v[212:215]
    buffer_load_dwordx4 a[160:163], v1, s[4:7], s60 offen offset:0 sc1
    v_mfma_f32_16x16x32_bf16 v[208:211], a[76:79], a[144:147], 0
    v_mfma_f32_16x16x32_bf16 v[208:211], a[72:75], a[128:131], v[208:211]
    v_mfma_f32_16x16x32_bf16 v[224:227], a[80:83], a[128:131], 0
    ds_read_b64_tr_b16 a[72:73], v11 offset:160
    v_mfma_f32_16x16x32_bf16 v[224:227], a[84:87], a[144:147], v[224:227]
    ds_read_b64_tr_b16 a[74:75], v11 offset:1952
    v_mfma_f32_16x16x32_bf16 v[228:231], a[84:87], a[148:151], 0
    ds_read_b64_tr_b16 a[76:77], v11 offset:7328
    v_mfma_f32_16x16x32_bf16 v[228:231], a[80:83], a[132:135], v[228:231]
    ds_read_b64_tr_b16 a[78:79], v11 offset:9120
    v_mfma_f32_16x16x32_bf16 v[232:235], a[80:83], a[136:139], 0
    v_mfma_f32_16x16x32_bf16 v[232:235], a[84:87], a[152:155], v[232:235]
    buffer_load_dwordx4 a[164:167], v1, s[4:7], s60 offen offset:1024 sc1
    v_mfma_f32_16x16x32_bf16 v[236:239], a[84:87], a[156:159], 0
    v_mfma_f32_16x16x32_bf16 v[236:239], a[80:83], a[140:143], v[236:239]
    s_waitcnt lgkmcnt(0)
    v_mfma_f32_16x16x32_bf16 v[252:255], a[64:67], a[140:143], 0
    ds_read_b64_tr_b16 a[80:81], v11 offset:14496
    v_mfma_f32_16x16x32_bf16 v[252:255], a[68:71], a[156:159], v[252:255]
    ds_read_b64_tr_b16 a[82:83], v11 offset:16288
    v_mfma_f32_16x16x32_bf16 v[248:251], a[68:71], a[152:155], 0
    ds_read_b64_tr_b16 a[84:85], v11 offset:21664
    v_mfma_f32_16x16x32_bf16 v[248:251], a[64:67], a[136:139], v[248:251]
    ds_read_b64_tr_b16 a[86:87], v11 offset:23456
    v_mfma_f32_16x16x32_bf16 v[244:247], a[64:67], a[132:135], 0
    buffer_load_dwordx4 a[168:171], v1, s[4:7], s60 offen offset:2048 sc1
    v_mfma_f32_16x16x32_bf16 v[244:247], a[68:71], a[148:151], v[244:247]
    v_mfma_f32_16x16x32_bf16 v[240:243], a[68:71], a[144:147], 0
    buffer_load_dwordx4 a[172:175], v1, s[4:7], s60 offen offset:3072 sc1
    s_add_u32 s60, s60, 4096
    v_mfma_f32_16x16x32_bf16 v[240:243], a[64:67], a[128:131], v[240:243]
    v_mfma_f32_16x16x32_bf16 a[0:3], a[72:75], a[128:131], 0
    ds_read_b64_tr_b16 a[64:65], v11 offset:192
    v_mfma_f32_16x16x32_bf16 a[0:3], a[76:79], a[144:147], a[0:3]
    ds_read_b64_tr_b16 a[66:67], v11 offset:1984
    v_mfma_f32_16x16x32_bf16 a[4:7], a[76:79], a[148:151], 0
    ds_read_b64_tr_b16 a[68:69], v11 offset:7360
    v_mfma_f32_16x16x32_bf16 a[4:7], a[72:75], a[132:135], a[4:7]
    ds_read_b64_tr_b16 a[70:71], v11 offset:9152
    v_mfma_f32_16x16x32_bf16 a[8:11], a[72:75], a[136:139], 0
    v_mfma_f32_16x16x32_bf16 a[8:11], a[76:79], a[152:155], a[8:11]
    buffer_load_dwordx4 a[176:179], v1, s[4:7], s60 offen offset:0 sc1
    v_mfma_f32_16x16x32_bf16 a[12:15], a[76:79], a[156:159], 0
    v_mfma_f32_16x16x32_bf16 a[12:15], a[72:75], a[140:143], a[12:15]
    s_waitcnt lgkmcnt(0)
    v_mfma_f32_16x16x32_bf16 a[28:31], a[80:83], a[140:143], 0
    ds_read_b64_tr_b16 a[72:73], v11 offset:14528
    v_mfma_f32_16x16x32_bf16 a[28:31], a[84:87], a[156:159], a[28:31]
    ds_read_b64_tr_b16 a[74:75], v11 offset:16320
    v_mfma_f32_16x16x32_bf16 a[24:27], a[84:87], a[152:155], 0
    ds_read_b64_tr_b16 a[76:77], v11 offset:21696
    v_mfma_f32_16x16x32_bf16 a[24:27], a[80:83], a[136:139], a[24:27]
    ds_read_b64_tr_b16 a[78:79], v11 offset:23488
    v_mfma_f32_16x16x32_bf16 a[20:23], a[80:83], a[132:135], 0
    v_mfma_f32_16x16x32_bf16 a[20:23], a[84:87], a[148:151], a[20:23]
    buffer_load_dwordx4 a[180:183], v1, s[4:7], s60 offen offset:1024 sc1
    v_mfma_f32_16x16x32_bf16 a[16:19], a[84:87], a[144:147], 0
    v_mfma_f32_16x16x32_bf16 a[16:19], a[80:83], a[128:131], a[16:19]
    v_mfma_f32_16x16x32_bf16 a[32:35], a[64:67], a[128:131], 0
    ds_read_b128 a[80:83], v12 offset:0
    v_mfma_f32_16x16x32_bf16 a[32:35], a[68:71], a[144:147], a[32:35]
    ds_read_b128 a[84:87], v13 offset:0
    v_mfma_f32_16x16x32_bf16 a[36:39], a[68:71], a[148:151], 0
    v_mfma_f32_16x16x32_bf16 a[36:39], a[64:67], a[132:135], a[36:39]
    v_mfma_f32_16x16x32_bf16 a[40:43], a[64:67], a[136:139], 0
    buffer_load_dwordx4 a[184:187], v1, s[4:7], s60 offen offset:2048 sc1
    v_mfma_f32_16x16x32_bf16 a[40:43], a[68:71], a[152:155], a[40:43]
    v_mfma_f32_16x16x32_bf16 a[44:47], a[68:71], a[156:159], 0
    buffer_load_dwordx4 a[188:191], v1, s[4:7], s60 offen offset:3072 sc1
    s_add_u32 s60, s60, 4096
    v_mfma_f32_16x16x32_bf16 a[44:47], a[64:67], a[140:143], a[44:47]
    s_waitcnt lgkmcnt(0)
    v_mfma_f32_16x16x32_bf16 a[60:63], a[72:75], a[140:143], 0
    ds_read_b128 a[64:67], v12 offset:2048
    v_mfma_f32_16x16x32_bf16 a[60:63], a[76:79], a[156:159], a[60:63]
    ds_read_b128 a[68:71], v13 offset:2048
    v_mfma_f32_16x16x32_bf16 a[56:59], a[76:79], a[152:155], 0
    v_mfma_f32_16x16x32_bf16 a[56:59], a[72:75], a[136:139], a[56:59]
    s_add_u32 m0, s63, 73728
    v_mfma_f32_16x16x32_bf16 a[52:55], a[72:75], a[132:135], 0
    buffer_load_dwordx4 v2, s[8:11], s61 offen offset:0 lds
    v_mfma_f32_16x16x32_bf16 a[52:55], a[76:79], a[148:151], a[52:55]
    v_mfma_f32_16x16x32_bf16 a[48:51], a[76:79], a[144:147], 0
    buffer_load_dwordx4 v3, s[8:11], s61 offen offset:1024 lds
    v_mfma_f32_16x16x32_bf16 a[48:51], a[72:75], a[128:131], a[48:51]
    v_mfma_f32_16x16x32_bf16 v[32:35], a[128:131], a[80:83], 0
    ds_read_b128 a[72:75], v12 offset:4096
    v_mfma_f32_16x16x32_bf16 v[32:35], a[144:147], a[84:87], v[32:35]
    ds_read_b128 a[76:79], v13 offset:4096
    v_mfma_f32_16x16x32_bf16 v[36:39], a[148:151], a[84:87], 0
    v_mfma_f32_16x16x32_bf16 v[36:39], a[132:135], a[80:83], v[36:39]
    v_mfma_f32_16x16x32_bf16 v[40:43], a[136:139], a[80:83], 0
    v_mfma_f32_16x16x32_bf16 v[40:43], a[152:155], a[84:87], v[40:43]
    buffer_load_dwordx4 v4, s[8:11], s61 offen offset:2048 lds
    v_mfma_f32_16x16x32_bf16 v[44:47], a[156:159], a[84:87], 0
    v_mfma_f32_16x16x32_bf16 v[44:47], a[140:143], a[80:83], v[44:47]
    s_waitcnt lgkmcnt(0)
    v_mfma_f32_16x16x32_bf16 v[60:63], a[140:143], a[64:67], 0
    ds_read_b128 a[80:83], v12 offset:6144
    v_mfma_f32_16x16x32_bf16 v[60:63], a[156:159], a[68:71], v[60:63]
    ds_read_b128 a[84:87], v13 offset:6144
    v_mfma_f32_16x16x32_bf16 v[56:59], a[152:155], a[68:71], 0
    v_mfma_f32_16x16x32_bf16 v[56:59], a[136:139], a[64:67], v[56:59]
    v_mfma_f32_16x16x32_bf16 v[52:55], a[132:135], a[64:67], 0
    buffer_load_dwordx4 v5, s[8:11], s61 offen offset:3072 lds
    v_mfma_f32_16x16x32_bf16 v[52:55], a[148:151], a[68:71], v[52:55]
    s_add_u32 m0, s63, 77824
    v_mfma_f32_16x16x32_bf16 v[48:51], a[144:147], a[68:71], 0
    buffer_load_dwordx4 v6, s[8:11], s61 offen offset:0 lds
    v_mfma_f32_16x16x32_bf16 v[48:51], a[128:131], a[64:67], v[48:51]
    v_mfma_f32_16x16x32_bf16 v[64:67], a[128:131], a[72:75], 0
    s_waitcnt vmcnt(13)
    s_barrier
    ds_read_b64_tr_b16 a[64:65], v11 offset:36864
    v_mfma_f32_16x16x32_bf16 v[64:67], a[144:147], a[76:79], v[64:67]
    ds_read_b64_tr_b16 a[66:67], v11 offset:38656
    v_mfma_f32_16x16x32_bf16 v[68:71], a[148:151], a[76:79], 0
    ds_read_b64_tr_b16 a[68:69], v11 offset:44032
    v_mfma_f32_16x16x32_bf16 v[68:71], a[132:135], a[72:75], v[68:71]
    ds_read_b64_tr_b16 a[70:71], v11 offset:45824
    v_mfma_f32_16x16x32_bf16 v[72:75], a[136:139], a[72:75], 0
    v_mfma_f32_16x16x32_bf16 v[72:75], a[152:155], a[76:79], v[72:75]
    buffer_load_dwordx4 v7, s[8:11], s61 offen offset:1024 lds
    v_mfma_f32_16x16x32_bf16 v[76:79], a[156:159], a[76:79], 0
    v_mfma_f32_16x16x32_bf16 v[76:79], a[140:143], a[72:75], v[76:79]
    s_waitcnt lgkmcnt(0)
    v_mfma_f32_16x16x32_bf16 v[92:95], a[140:143], a[80:83], 0
    ds_read_b64_tr_b16 a[72:73], v11 offset:51200
    v_mfma_f32_16x16x32_bf16 v[92:95], a[156:159], a[84:87], v[92:95]
    ds_read_b64_tr_b16 a[74:75], v11 offset:52992
    v_mfma_f32_16x16x32_bf16 v[88:91], a[152:155], a[84:87], 0
    ds_read_b64_tr_b16 a[76:77], v11 offset:58368
    v_mfma_f32_16x16x32_bf16 v[88:91], a[136:139], a[80:83], v[88:91]
    ds_read_b64_tr_b16 a[78:79], v11 offset:60160
    v_mfma_f32_16x16x32_bf16 v[84:87], a[132:135], a[80:83], 0
    v_mfma_f32_16x16x32_bf16 v[84:87], a[148:151], a[84:87], v[84:87]
    buffer_load_dwordx4 v8, s[8:11], s61 offen offset:2048 lds
    s_add_u32 s61, s61, 458752
    v_mfma_f32_16x16x32_bf16 v[80:83], a[144:147], a[84:87], 0
    v_mfma_f32_16x16x32_bf16 v[80:83], a[128:131], a[80:83], v[80:83]
    s_waitcnt vmcnt(7)
    v_mfma_f32_16x16x32_bf16 v[96:99], a[64:67], a[160:163], v[96:99]
    ds_read_b64_tr_b16 a[80:81], v11 offset:36896
    v_mfma_f32_16x16x32_bf16 v[96:99], a[68:71], a[176:179], v[96:99]
    ds_read_b64_tr_b16 a[82:83], v11 offset:38688
    v_mfma_f32_16x16x32_bf16 v[100:103], a[68:71], a[180:183], v[100:103]
    ds_read_b64_tr_b16 a[84:85], v11 offset:44064
    v_mfma_f32_16x16x32_bf16 v[100:103], a[64:67], a[164:167], v[100:103]
    ds_read_b64_tr_b16 a[86:87], v11 offset:45856
    v_mfma_f32_16x16x32_bf16 v[104:107], a[64:67], a[168:171], v[104:107]
    buffer_load_dword v31, v23, s[12:15], 0 offen
    v_add_u32 v23, 512, v23
    v_mfma_f32_16x16x32_bf16 v[104:107], a[68:71], a[184:187], v[104:107]
    s_add_u32 m0, s64, 73728
    v_mfma_f32_16x16x32_bf16 v[108:111], a[68:71], a[188:191], v[108:111]
    buffer_load_dwordx4 v9, s[12:15], s62 offen offset:0 lds
    v_mfma_f32_16x16x32_bf16 v[108:111], a[64:67], a[172:175], v[108:111]
    s_waitcnt lgkmcnt(0)
    v_mfma_f32_16x16x32_bf16 v[124:127], a[72:75], a[172:175], v[124:127]
    ds_read_b64_tr_b16 a[64:65], v11 offset:51232
    v_mfma_f32_16x16x32_bf16 v[124:127], a[76:79], a[188:191], v[124:127]
    ds_read_b64_tr_b16 a[66:67], v11 offset:53024
    v_mfma_f32_16x16x32_bf16 v[120:123], a[76:79], a[184:187], v[120:123]
    ds_read_b64_tr_b16 a[68:69], v11 offset:58400
    v_mfma_f32_16x16x32_bf16 v[120:123], a[72:75], a[168:171], v[120:123]
    ds_read_b64_tr_b16 a[70:71], v11 offset:60192
    v_mfma_f32_16x16x32_bf16 v[116:119], a[72:75], a[164:167], v[116:119]
    v_mfma_f32_16x16x32_bf16 v[116:119], a[76:79], a[180:183], v[116:119]
    buffer_load_dwordx4 v10, s[12:15], s62 offen offset:1024 lds
    s_add_u32 s62, s62, 128
    v_mfma_f32_16x16x32_bf16 v[112:115], a[76:79], a[176:179], v[112:115]
    v_mfma_f32_16x16x32_bf16 v[112:115], a[72:75], a[160:163], v[112:115]
    v_mfma_f32_16x16x32_bf16 v[128:131], a[80:83], a[160:163], v[128:131]
    ds_read_b64_tr_b16 a[72:73], v11 offset:36928
    v_mfma_f32_16x16x32_bf16 v[128:131], a[84:87], a[176:179], v[128:131]
    ds_read_b64_tr_b16 a[74:75], v11 offset:38720
    v_mfma_f32_16x16x32_bf16 v[132:135], a[84:87], a[180:183], v[132:135]
    ds_read_b64_tr_b16 a[76:77], v11 offset:44096
    v_mfma_f32_16x16x32_bf16 v[132:135], a[80:83], a[164:167], v[132:135]
    ds_read_b64_tr_b16 a[78:79], v11 offset:45888
    v_mfma_f32_16x16x32_bf16 v[136:139], a[80:83], a[168:171], v[136:139]
    v_mfma_f32_16x16x32_bf16 v[136:139], a[84:87], a[184:187], v[136:139]
    buffer_load_dwordx4 a[192:195], v1, s[4:7], s60 offen offset:0 sc1
    v_mfma_f32_16x16x32_bf16 v[140:143], a[84:87], a[188:191], v[140:143]
    v_mfma_f32_16x16x32_bf16 v[140:143], a[80:83], a[172:175], v[140:143]
    s_waitcnt lgkmcnt(0)
    v_mfma_f32_16x16x32_bf16 v[156:159], a[64:67], a[172:175], v[156:159]
    ds_read_b64_tr_b16 a[80:81], v11 offset:51264
    v_mfma_f32_16x16x32_bf16 v[156:159], a[68:71], a[188:191], v[156:159]
    ds_read_b64_tr_b16 a[82:83], v11 offset:53056
    v_mfma_f32_16x16x32_bf16 v[152:155], a[68:71], a[184:187], v[152:155]
    ds_read_b64_tr_b16 a[84:85], v11 offset:58432
    v_mfma_f32_16x16x32_bf16 v[152:155], a[64:67], a[168:171], v[152:155]
    ds_read_b64_tr_b16 a[86:87], v11 offset:60224
    v_mfma_f32_16x16x32_bf16 v[148:151], a[64:67], a[164:167], v[148:151]
    buffer_load_dwordx4 a[196:199], v1, s[4:7], s60 offen offset:1024 sc1
    v_mfma_f32_16x16x32_bf16 v[148:151], a[68:71], a[180:183], v[148:151]
    v_mfma_f32_16x16x32_bf16 v[144:147], a[68:71], a[176:179], v[144:147]
    buffer_load_dwordx4 a[200:203], v1, s[4:7], s60 offen offset:2048 sc1
    v_mfma_f32_16x16x32_bf16 v[144:147], a[64:67], a[160:163], v[144:147]
    v_mfma_f32_16x16x32_bf16 v[160:163], a[72:75], a[160:163], v[160:163]
    ds_read_b64_tr_b16 a[64:65], v11 offset:36960
    v_mfma_f32_16x16x32_bf16 v[160:163], a[76:79], a[176:179], v[160:163]
    ds_read_b64_tr_b16 a[66:67], v11 offset:38752
    v_mfma_f32_16x16x32_bf16 v[164:167], a[76:79], a[180:183], v[164:167]
    ds_read_b64_tr_b16 a[68:69], v11 offset:44128
    v_mfma_f32_16x16x32_bf16 v[164:167], a[72:75], a[164:167], v[164:167]
    ds_read_b64_tr_b16 a[70:71], v11 offset:45920
    v_mfma_f32_16x16x32_bf16 v[168:171], a[72:75], a[168:171], v[168:171]
    v_mfma_f32_16x16x32_bf16 v[168:171], a[76:79], a[184:187], v[168:171]
    buffer_load_dwordx4 a[204:207], v1, s[4:7], s60 offen offset:3072 sc1
    s_add_u32 s60, s60, 4096
    v_mfma_f32_16x16x32_bf16 v[172:175], a[76:79], a[188:191], v[172:175]
    v_mfma_f32_16x16x32_bf16 v[172:175], a[72:75], a[172:175], v[172:175]
    s_waitcnt lgkmcnt(0)
    v_mfma_f32_16x16x32_bf16 v[188:191], a[80:83], a[172:175], v[188:191]
    ds_read_b64_tr_b16 a[72:73], v11 offset:51296
    v_mfma_f32_16x16x32_bf16 v[188:191], a[84:87], a[188:191], v[188:191]
    ds_read_b64_tr_b16 a[74:75], v11 offset:53088
    v_mfma_f32_16x16x32_bf16 v[184:187], a[84:87], a[184:187], v[184:187]
L_pad0:
    s_cbranch_execz L_pad4
    ds_read_b64_tr_b16 a[76:77], v11 offset:58464
    v_mfma_f32_16x16x32_bf16 v[184:187], a[80:83], a[168:171], v[184:187]
    ds_read_b64_tr_b16 a[78:79], v11 offset:60256
    v_mfma_f32_16x16x32_bf16 v[180:183], a[80:83], a[164:167], v[180:183]
    v_mfma_f32_16x16x32_bf16 v[180:183], a[84:87], a[180:183], v[180:183]
    buffer_load_dword v31, v21, s[8:11], 0 offen
    v_add_u32 v21, 458752, v21
    v_mfma_f32_16x16x32_bf16 v[176:179], a[84:87], a[176:179], v[176:179]
    v_mfma_f32_16x16x32_bf16 v[176:179], a[80:83], a[160:163], v[176:179]
    v_mfma_f32_16x16x32_bf16 v[192:195], a[64:67], a[160:163], v[192:195]
    ds_read_b64_tr_b16 a[80:81], v11 offset:36992
    v_mfma_f32_16x16x32_bf16 v[192:195], a[68:71], a[176:179], v[192:195]
    ds_read_b64_tr_b16 a[82:83], v11 offset:38784
    v_mfma_f32_16x16x32_bf16 v[196:199], a[68:71], a[180:183], v[196:199]
    ds_read_b64_tr_b16 a[84:85], v11 offset:44160
    v_mfma_f32_16x16x32_bf16 v[196:199], a[64:67], a[164:167], v[196:199]
    ds_read_b64_tr_b16 a[86:87], v11 offset:45952
    v_mfma_f32_16x16x32_bf16 v[200:203], a[64:67], a[168:171], v[200:203]
    buffer_load_dwordx4 a[208:211], v1, s[4:7], s60 offen offset:0 sc1
    v_mfma_f32_16x16x32_bf16 v[200:203], a[68:71], a[184:187], v[200:203]
    v_mfma_f32_16x16x32_bf16 v[204:207], a[68:71], a[188:191], v[204:207]
    buffer_load_dwordx4 a[212:215], v1, s[4:7], s60 offen offset:1024 sc1
    v_mfma_f32_16x16x32_bf16 v[204:207], a[64:67], a[172:175], v[204:207]
    s_waitcnt lgkmcnt(0)
    v_mfma_f32_16x16x32_bf16 v[220:223], a[72:75], a[172:175], v[220:223]
    ds_read_b64_tr_b16 a[64:65], v11 offset:51328
    v_mfma_f32_16x16x32_bf16 v[220:223], a[76:79], a[188:191], v[220:223]
    ds_read_b64_tr_b16 a[66:67], v11 offset:53120
    v_mfma_f32_16x16x32_bf16 v[216:219], a[76:79], a[184:187], v[216:219]
    ds_read_b64_tr_b16 a[68:69], v11 offset:58496
    v_mfma_f32_16x16x32_bf16 v[216:219], a[72:75], a[168:171], v[216:219]
    ds_read_b64_tr_b16 a[70:71], v11 offset:60288
    v_mfma_f32_16x16x32_bf16 v[212:215], a[72:75], a[164:167], v[212:215]
    v_mfma_f32_16x16x32_bf16 v[212:215], a[76:79], a[180:183], v[212:215]
    buffer_load_dwordx4 a[216:219], v1, s[4:7], s60 offen offset:2048 sc1
    v_mfma_f32_16x16x32_bf16 v[208:211], a[76:79], a[176:179], v[208:211]
    v_mfma_f32_16x16x32_bf16 v[208:211], a[72:75], a[160:163], v[208:211]
    v_mfma_f32_16x16x32_bf16 v[224:227], a[80:83], a[160:163], v[224:227]
    ds_read_b64_tr_b16 a[72:73], v11 offset:37024
    v_mfma_f32_16x16x32_bf16 v[224:227], a[84:87], a[176:179], v[224:227]
    ds_read_b64_tr_b16 a[74:75], v11 offset:38816
    v_mfma_f32_16x16x32_bf16 v[228:231], a[84:87], a[180:183], v[228:231]
    ds_read_b64_tr_b16 a[76:77], v11 offset:44192
    v_mfma_f32_16x16x32_bf16 v[228:231], a[80:83], a[164:167], v[228:231]
    ds_read_b64_tr_b16 a[78:79], v11 offset:45984
    v_mfma_f32_16x16x32_bf16 v[232:235], a[80:83], a[168:171], v[232:235]
    v_mfma_f32_16x16x32_bf16 v[232:235], a[84:87], a[184:187], v[232:235]
    buffer_load_dwordx4 a[220:223], v1, s[4:7], s60 offen offset:3072 sc1
    s_add_u32 s60, s60, 4096
    v_mfma_f32_16x16x32_bf16 v[236:239], a[84:87], a[188:191], v[236:239]
    v_mfma_f32_16x16x32_bf16 v[236:239], a[80:83], a[172:175], v[236:239]
    s_waitcnt lgkmcnt(0)
    v_mfma_f32_16x16x32_bf16 v[252:255], a[64:67], a[172:175], v[252:255]
    ds_read_b64_tr_b16 a[80:81], v11 offset:51360
    v_mfma_f32_16x16x32_bf16 v[252:255], a[68:71], a[188:191], v[252:255]
    ds_read_b64_tr_b16 a[82:83], v11 offset:53152
    v_mfma_f32_16x16x32_bf16 v[248:251], a[68:71], a[184:187], v[248:251]
    ds_read_b64_tr_b16 a[84:85], v11 offset:58528
    v_mfma_f32_16x16x32_bf16 v[248:251], a[64:67], a[168:171], v[248:251]
    ds_read_b64_tr_b16 a[86:87], v11 offset:60320
    s_add_u32 m0, s63, 110592
    v_mfma_f32_16x16x32_bf16 v[244:247], a[64:67], a[164:167], v[244:247]
    buffer_load_dwordx4 v2, s[8:11], s61 offen offset:0 lds
    v_mfma_f32_16x16x32_bf16 v[244:247], a[68:71], a[180:183], v[244:247]
    v_mfma_f32_16x16x32_bf16 v[240:243], a[68:71], a[176:179], v[240:243]
    buffer_load_dwordx4 v3, s[8:11], s61 offen offset:1024 lds
    v_mfma_f32_16x16x32_bf16 v[240:243], a[64:67], a[160:163], v[240:243]
    v_mfma_f32_16x16x32_bf16 a[0:3], a[72:75], a[160:163], a[0:3]
    ds_read_b64_tr_b16 a[64:65], v11 offset:37056
    v_mfma_f32_16x16x32_bf16 a[0:3], a[76:79], a[176:179], a[0:3]
    ds_read_b64_tr_b16 a[66:67], v11 offset:38848
    v_mfma_f32_16x16x32_bf16 a[4:7], a[76:79], a[180:183], a[4:7]
    ds_read_b64_tr_b16 a[68:69], v11 offset:44224
    v_mfma_f32_16x16x32_bf16 a[4:7], a[72:75], a[164:167], a[4:7]
    ds_read_b64_tr_b16 a[70:71], v11 offset:46016
    v_mfma_f32_16x16x32_bf16 a[8:11], a[72:75], a[168:171], a[8:11]
    v_mfma_f32_16x16x32_bf16 a[8:11], a[76:79], a[184:187], a[8:11]
    buffer_load_dwordx4 v4, s[8:11], s61 offen offset:2048 lds
    v_mfma_f32_16x16x32_bf16 a[12:15], a[76:79], a[188:191], a[12:15]
    v_mfma_f32_16x16x32_bf16 a[12:15], a[72:75], a[172:175], a[12:15]
    s_waitcnt lgkmcnt(0)
    v_mfma_f32_16x16x32_bf16 a[28:31], a[80:83], a[172:175], a[28:31]
    ds_read_b64_tr_b16 a[72:73], v11 offset:51392
    v_mfma_f32_16x16x32_bf16 a[28:31], a[84:87], a[188:191], a[28:31]
    ds_read_b64_tr_b16 a[74:75], v11 offset:53184
    v_mfma_f32_16x16x32_bf16 a[24:27], a[84:87], a[184:187], a[24:27]
    ds_read_b64_tr_b16 a[76:77], v11 offset:58560
    v_mfma_f32_16x16x32_bf16 a[24:27], a[80:83], a[168:171], a[24:27]
    ds_read_b64_tr_b16 a[78:79], v11 offset:60352
    v_mfma_f32_16x16x32_bf16 a[20:23], a[80:83], a[164:167], a[20:23]
    v_mfma_f32_16x16x32_bf16 a[20:23], a[84:87], a[180:183], a[20:23]
    buffer_load_dwordx4 v5, s[8:11], s61 offen offset:3072 lds
    v_mfma_f32_16x16x32_bf16 a[16:19], a[84:87], a[176:179], a[16:19]
    v_mfma_f32_16x16x32_bf16 a[16:19], a[80:83], a[160:163], a[16:19]
    v_mfma_f32_16x16x32_bf16 a[32:35], a[64:67], a[160:163], a[32:35]
    ds_read_b128 a[80:83], v12 offset:36864
    v_mfma_f32_16x16x32_bf16 a[32:35], a[68:71], a[176:179], a[32:35]
    ds_read_b128 a[84:87], v13 offset:36864
    v_mfma_f32_16x16x32_bf16 a[36:39], a[68:71], a[180:183], a[36:39]
    v_mfma_f32_16x16x32_bf16 a[36:39], a[64:67], a[164:167], a[36:39]
    s_add_u32 m0, s63, 114688
    v_mfma_f32_16x16x32_bf16 a[40:43], a[64:67], a[168:171], a[40:43]
    buffer_load_dwordx4 v6, s[8:11], s61 offen offset:0 lds
    v_mfma_f32_16x16x32_bf16 a[40:43], a[68:71], a[184:187], a[40:43]
    v_mfma_f32_16x16x32_bf16 a[44:47], a[68:71], a[188:191], a[44:47]
    buffer_load_dwordx4 v7, s[8:11], s61 offen offset:1024 lds
    v_mfma_f32_16x16x32_bf16 a[44:47], a[64:67], a[172:175], a[44:47]
    s_waitcnt lgkmcnt(0)
    v_mfma_f32_16x16x32_bf16 a[60:63], a[72:75], a[172:175], a[60:63]
    ds_read_b128 a[64:67], v12 offset:38912
    v_mfma_f32_16x16x32_bf16 a[60:63], a[76:79], a[188:191], a[60:63]
    ds_read_b128 a[68:71], v13 offset:38912
    v_mfma_f32_16x16x32_bf16 a[56:59], a[76:79], a[184:187], a[56:59]
    v_mfma_f32_16x16x32_bf16 a[56:59], a[72:75], a[168:171], a[56:59]
    v_mfma_f32_16x16x32_bf16 a[52:55], a[72:75], a[164:167], a[52:55]
    buffer_load_dwordx4 v8, s[8:11], s61 offen offset:2048 lds
    s_add_u32 s61, s61, 458752
    v_mfma_f32_16x16x32_bf16 a[52:55], a[76:79], a[180:183], a[52:55]
    s_add_u32 m0, s64, 110592
    v_mfma_f32_16x16x32_bf16 a[48:51], a[76:79], a[176:179], a[48:51]
    buffer_load_dwordx4 v9, s[12:15], s62 offen offset:0 lds
    v_mfma_f32_16x16x32_bf16 a[48:51], a[72:75], a[160:163], a[48:51]
    v_mfma_f32_16x16x32_bf16 v[32:35], a[160:163], a[80:83], v[32:35]
    ds_read_b128 a[72:75], v12 offset:40960
    v_mfma_f32_16x16x32_bf16 v[32:35], a[176:179], a[84:87], v[32:35]
    ds_read_b128 a[76:79], v13 offset:40960
    v_mfma_f32_16x16x32_bf16 v[36:39], a[180:183], a[84:87], v[36:39]
    v_mfma_f32_16x16x32_bf16 v[36:39], a[164:167], a[80:83], v[36:39]
    v_mfma_f32_16x16x32_bf16 v[40:43], a[168:171], a[80:83], v[40:43]
    v_mfma_f32_16x16x32_bf16 v[40:43], a[184:187], a[84:87], v[40:43]
    buffer_load_dwordx4 v10, s[12:15], s62 offen offset:1024 lds
    s_add_u32 s62, s62, 128
    v_mfma_f32_16x16x32_bf16 v[44:47], a[188:191], a[84:87], v[44:47]
    v_mfma_f32_16x16x32_bf16 v[44:47], a[172:175], a[80:83], v[44:47]
    s_waitcnt lgkmcnt(0)
    v_mfma_f32_16x16x32_bf16 v[60:63], a[172:175], a[64:67], v[60:63]
    ds_read_b128 a[80:83], v12 offset:43008
    v_mfma_f32_16x16x32_bf16 v[60:63], a[188:191], a[68:71], v[60:63]
    ds_read_b128 a[84:87], v13 offset:43008
    v_mfma_f32_16x16x32_bf16 v[56:59], a[184:187], a[68:71], v[56:59]
    v_mfma_f32_16x16x32_bf16 v[56:59], a[168:171], a[64:67], v[56:59]
    v_mfma_f32_16x16x32_bf16 v[52:55], a[164:167], a[64:67], v[52:55]
    buffer_load_dwordx4 a[224:227], v1, s[4:7], s60 offen offset:0 sc1
    v_mfma_f32_16x16x32_bf16 v[52:55], a[180:183], a[68:71], v[52:55]
    v_mfma_f32_16x16x32_bf16 v[48:51], a[176:179], a[68:71], v[48:51]
    buffer_load_dwordx4 a[228:231], v1, s[4:7], s60 offen offset:1024 sc1
    v_mfma_f32_16x16x32_bf16 v[48:51], a[160:163], a[64:67], v[48:51]
    v_mfma_f32_16x16x32_bf16 v[64:67], a[160:163], a[72:75], v[64:67]
    s_waitcnt vmcnt(20)
    s_barrier
    ds_read_b64_tr_b16 a[64:65], v14 offset:0
    v_mfma_f32_16x16x32_bf16 v[64:67], a[176:179], a[76:79], v[64:67]
    ds_read_b64_tr_b16 a[66:67], v14 offset:1792
    v_mfma_f32_16x16x32_bf16 v[68:71], a[180:183], a[76:79], v[68:71]
    ds_read_b64_tr_b16 a[68:69], v14 offset:7168
    v_mfma_f32_16x16x32_bf16 v[68:71], a[164:167], a[72:75], v[68:71]
    ds_read_b64_tr_b16 a[70:71], v14 offset:8960
    v_mfma_f32_16x16x32_bf16 v[72:75], a[168:171], a[72:75], v[72:75]
    v_mfma_f32_16x16x32_bf16 v[72:75], a[184:187], a[76:79], v[72:75]
    buffer_load_dwordx4 a[232:235], v1, s[4:7], s60 offen offset:2048 sc1
    v_mfma_f32_16x16x32_bf16 v[76:79], a[188:191], a[76:79], v[76:79]
    v_mfma_f32_16x16x32_bf16 v[76:79], a[172:175], a[72:75], v[76:79]
    s_waitcnt lgkmcnt(0)
    v_mfma_f32_16x16x32_bf16 v[92:95], a[172:175], a[80:83], v[92:95]
    ds_read_b64_tr_b16 a[72:73], v14 offset:14336
    v_mfma_f32_16x16x32_bf16 v[92:95], a[188:191], a[84:87], v[92:95]
    ds_read_b64_tr_b16 a[74:75], v14 offset:16128
    v_mfma_f32_16x16x32_bf16 v[88:91], a[184:187], a[84:87], v[88:91]
    ds_read_b64_tr_b16 a[76:77], v14 offset:21504
    v_mfma_f32_16x16x32_bf16 v[88:91], a[168:171], a[80:83], v[88:91]
    ds_read_b64_tr_b16 a[78:79], v14 offset:23296
    v_mfma_f32_16x16x32_bf16 v[84:87], a[164:167], a[80:83], v[84:87]
    v_mfma_f32_16x16x32_bf16 v[84:87], a[180:183], a[84:87], v[84:87]
    buffer_load_dwordx4 a[236:239], v1, s[4:7], s60 offen offset:3072 sc1
    s_add_u32 s60, s60, 4096
    v_mfma_f32_16x16x32_bf16 v[80:83], a[176:179], a[84:87], v[80:83]
    v_mfma_f32_16x16x32_bf16 v[80:83], a[160:163], a[80:83], v[80:83]
    s_waitcnt vmcnt(13)
    v_mfma_f32_16x16x32_bf16 v[96:99], a[64:67], a[192:195], v[96:99]
    ds_read_b64_tr_b16 a[80:81], v14 offset:32
    v_mfma_f32_16x16x32_bf16 v[96:99], a[68:71], a[208:211], v[96:99]
    ds_read_b64_tr_b16 a[82:83], v14 offset:1824
    v_mfma_f32_16x16x32_bf16 v[100:103], a[68:71], a[212:215], v[100:103]
    ds_read_b64_tr_b16 a[84:85], v14 offset:7200
    v_mfma_f32_16x16x32_bf16 v[100:103], a[64:67], a[196:199], v[100:103]
    ds_read_b64_tr_b16 a[86:87], v14 offset:8992
    v_mfma_f32_16x16x32_bf16 v[104:107], a[64:67], a[200:203], v[104:107]
    buffer_load_dwordx4 a[240:243], v1, s[4:7], s60 offen offset:0 sc1
    v_mfma_f32_16x16x32_bf16 v[104:107], a[68:71], a[216:219], v[104:107]
    v_mfma_f32_16x16x32_bf16 v[108:111], a[68:71], a[220:223], v[108:111]
    buffer_load_dwordx4 a[244:247], v1, s[4:7], s60 offen offset:1024 sc1
    v_mfma_f32_16x16x32_bf16 v[108:111], a[64:67], a[204:207], v[108:111]
    s_waitcnt lgkmcnt(0)
    v_mfma_f32_16x16x32_bf16 v[124:127], a[72:75], a[204:207], v[124:127]
    ds_read_b64_tr_b16 a[64:65], v14 offset:14368
    v_mfma_f32_16x16x32_bf16 v[124:127], a[76:79], a[220:223], v[124:127]
    ds_read_b64_tr_b16 a[66:67], v14 offset:16160
    v_mfma_f32_16x16x32_bf16 v[120:123], a[76:79], a[216:219], v[120:123]
    ds_read_b64_tr_b16 a[68:69], v14 offset:21536
    v_mfma_f32_16x16x32_bf16 v[120:123], a[72:75], a[200:203], v[120:123]
    ds_read_b64_tr_b16 a[70:71], v14 offset:23328
    v_mfma_f32_16x16x32_bf16 v[116:119], a[72:75], a[196:199], v[116:119]
    v_mfma_f32_16x16x32_bf16 v[116:119], a[76:79], a[212:215], v[116:119]
    buffer_load_dwordx4 a[248:251], v1, s[4:7], s60 offen offset:2048 sc1
    v_mfma_f32_16x16x32_bf16 v[112:115], a[76:79], a[208:211], v[112:115]
    v_mfma_f32_16x16x32_bf16 v[112:115], a[72:75], a[192:195], v[112:115]
    v_mfma_f32_16x16x32_bf16 v[128:131], a[80:83], a[192:195], v[128:131]
    ds_read_b64_tr_b16 a[72:73], v14 offset:64
    v_mfma_f32_16x16x32_bf16 v[128:131], a[84:87], a[208:211], v[128:131]
    ds_read_b64_tr_b16 a[74:75], v14 offset:1856
    v_mfma_f32_16x16x32_bf16 v[132:135], a[84:87], a[212:215], v[132:135]
    ds_read_b64_tr_b16 a[76:77], v14 offset:7232
    v_mfma_f32_16x16x32_bf16 v[132:135], a[80:83], a[196:199], v[132:135]
    ds_read_b64_tr_b16 a[78:79], v14 offset:9024
    v_mfma_f32_16x16x32_bf16 v[136:139], a[80:83], a[200:203], v[136:139]
    v_mfma_f32_16x16x32_bf16 v[136:139], a[84:87], a[216:219], v[136:139]
    buffer_load_dwordx4 a[252:255], v1, s[4:7], s60 offen offset:3072 sc1
    s_add_u32 s60, s60, 4096
    v_mfma_f32_16x16x32_bf16 v[140:143], a[84:87], a[220:223], v[140:143]
    v_mfma_f32_16x16x32_bf16 v[140:143], a[80:83], a[204:207], v[140:143]
    s_waitcnt lgkmcnt(0)
    v_mfma_f32_16x16x32_bf16 v[156:159], a[64:67], a[204:207], v[156:159]
    ds_read_b64_tr_b16 a[80:81], v14 offset:14400
    v_mfma_f32_16x16x32_bf16 v[156:159], a[68:71], a[220:223], v[156:159]
    ds_read_b64_tr_b16 a[82:83], v14 offset:16192
    v_mfma_f32_16x16x32_bf16 v[152:155], a[68:71], a[216:219], v[152:155]
    ds_read_b64_tr_b16 a[84:85], v14 offset:21568
    v_mfma_f32_16x16x32_bf16 v[152:155], a[64:67], a[200:203], v[152:155]
    ds_read_b64_tr_b16 a[86:87], v14 offset:23360
    s_add_u32 m0, s63, 0
    v_mfma_f32_16x16x32_bf16 v[148:151], a[64:67], a[196:199], v[148:151]
    buffer_load_dwordx4 v2, s[8:11], s61 offen offset:0 lds
    v_mfma_f32_16x16x32_bf16 v[148:151], a[68:71], a[212:215], v[148:151]
    v_mfma_f32_16x16x32_bf16 v[144:147], a[68:71], a[208:211], v[144:147]
    buffer_load_dwordx4 v3, s[8:11], s61 offen offset:1024 lds
    v_mfma_f32_16x16x32_bf16 v[144:147], a[64:67], a[192:195], v[144:147]
    v_mfma_f32_16x16x32_bf16 v[160:163], a[72:75], a[192:195], v[160:163]
    ds_read_b64_tr_b16 a[64:65], v14 offset:96
    v_mfma_f32_16x16x32_bf16 v[160:163], a[76:79], a[208:211], v[160:163]
    ds_read_b64_tr_b16 a[66:67], v14 offset:1888
    v_mfma_f32_16x16x32_bf16 v[164:167], a[76:79], a[212:215], v[164:167]
    ds_read_b64_tr_b16 a[68:69], v14 offset:7264
    v_mfma_f32_16x16x32_bf16 v[164:167], a[72:75], a[196:199], v[164:167]
    ds_read_b64_tr_b16 a[70:71], v14 offset:9056
    v_mfma_f32_16x16x32_bf16 v[168:171], a[72:75], a[200:203], v[168:171]
    v_mfma_f32_16x16x32_bf16 v[168:171], a[76:79], a[216:219], v[168:171]
    buffer_load_dwordx4 v4, s[8:11], s61 offen offset:2048 lds
    v_mfma_f32_16x16x32_bf16 v[172:175], a[76:79], a[220:223], v[172:175]
    v_mfma_f32_16x16x32_bf16 v[172:175], a[72:75], a[204:207], v[172:175]
    s_waitcnt lgkmcnt(0)
    v_mfma_f32_16x16x32_bf16 v[188:191], a[80:83], a[204:207], v[188:191]
    ds_read_b64_tr_b16 a[72:73], v14 offset:14432
    v_mfma_f32_16x16x32_bf16 v[188:191], a[84:87], a[220:223], v[188:191]
    ds_read_b64_tr_b16 a[74:75], v14 offset:16224
    v_mfma_f32_16x16x32_bf16 v[184:187], a[84:87], a[216:219], v[184:187]
    ds_read_b64_tr_b16 a[76:77], v14 offset:21600
    v_mfma_f32_16x16x32_bf16 v[184:187], a[80:83], a[200:203], v[184:187]
    ds_read_b64_tr_b16 a[78:79], v14 offset:23392
    v_mfma_f32_16x16x32_bf16 v[180:183], a[80:83], a[196:199], v[180:183]
    v_mfma_f32_16x16x32_bf16 v[180:183], a[84:87], a[212:215], v[180:183]
    buffer_load_dword v31, v21, s[8:11], 0 offen
    v_add_u32 v21, 458752, v21
    v_mfma_f32_16x16x32_bf16 v[176:179], a[84:87], a[208:211], v[176:179]
    v_mfma_f32_16x16x32_bf16 v[176:179], a[80:83], a[192:195], v[176:179]
    v_mfma_f32_16x16x32_bf16 v[192:195], a[64:67], a[192:195], v[192:195]
    ds_read_b64_tr_b16 a[80:81], v14 offset:128
    v_mfma_f32_16x16x32_bf16 v[192:195], a[68:71], a[208:211], v[192:195]
    ds_read_b64_tr_b16 a[82:83], v14 offset:1920
    v_mfma_f32_16x16x32_bf16 v[196:199], a[68:71], a[212:215], v[196:199]
    ds_read_b64_tr_b16 a[84:85], v14 offset:7296
    v_mfma_f32_16x16x32_bf16 v[196:199], a[64:67], a[196:199], v[196:199]
    ds_read_b64_tr_b16 a[86:87], v14 offset:9088
    v_mfma_f32_16x16x32_bf16 v[200:203], a[64:67], a[200:203], v[200:203]
    buffer_load_dwordx4 v5, s[8:11], s61 offen offset:3072 lds
    v_mfma_f32_16x16x32_bf16 v[200:203], a[68:71], a[216:219], v[200:203]
    s_add_u32 m0, s63, 4096
    v_mfma_f32_16x16x32_bf16 v[204:207], a[68:71], a[220:223], v[204:207]
    buffer_load_dwordx4 v6, s[8:11], s61 offen offset:0 lds
    v_mfma_f32_16x16x32_bf16 v[204:207], a[64:67], a[204:207], v[204:207]
    s_waitcnt lgkmcnt(0)
    v_mfma_f32_16x16x32_bf16 v[220:223], a[72:75], a[204:207], v[220:223]
    ds_read_b64_tr_b16 a[64:65], v14 offset:14464
    v_mfma_f32_16x16x32_bf16 v[220:223], a[76:79], a[220:223], v[220:223]
    ds_read_b64_tr_b16 a[66:67], v14 offset:16256
    v_mfma_f32_16x16x32_bf16 v[216:219], a[76:79], a[216:219], v[216:219]
    ds_read_b64_tr_b16 a[68:69], v14 offset:21632
    v_mfma_f32_16x16x32_bf16 v[216:219], a[72:75], a[200:203], v[216:219]
    ds_read_b64_tr_b16 a[70:71], v14 offset:23424
    v_mfma_f32_16x16x32_bf16 v[212:215], a[72:75], a[196:199], v[212:215]
    v_mfma_f32_16x16x32_bf16 v[212:215], a[76:79], a[212:215], v[212:215]
    buffer_load_dwordx4 v7, s[8:11], s61 offen offset:1024 lds
    v_mfma_f32_16x16x32_bf16 v[208:211], a[76:79], a[208:211], v[208:211]
    v_mfma_f32_16x16x32_bf16 v[208:211], a[72:75], a[192:195], v[208:211]
    v_mfma_f32_16x16x32_bf16 v[224:227], a[80:83], a[192:195], v[224:227]
    ds_read_b64_tr_b16 a[72:73], v14 offset:160
    v_mfma_f32_16x16x32_bf16 v[224:227], a[84:87], a[208:211], v[224:227]
    ds_read_b64_tr_b16 a[74:75], v14 offset:1952
    v_mfma_f32_16x16x32_bf16 v[228:231], a[84:87], a[212:215], v[228:231]
    ds_read_b64_tr_b16 a[76:77], v14 offset:7328
    v_mfma_f32_16x16x32_bf16 v[228:231], a[80:83], a[196:199], v[228:231]
    ds_read_b64_tr_b16 a[78:79], v14 offset:9120
    v_mfma_f32_16x16x32_bf16 v[232:235], a[80:83], a[200:203], v[232:235]
    v_mfma_f32_16x16x32_bf16 v[232:235], a[84:87], a[216:219], v[232:235]
    buffer_load_dwordx4 v8, s[8:11], s61 offen offset:2048 lds
    s_add_u32 s61, s61, 458752
    v_mfma_f32_16x16x32_bf16 v[236:239], a[84:87], a[220:223], v[236:239]
    v_mfma_f32_16x16x32_bf16 v[236:239], a[80:83], a[204:207], v[236:239]
    s_waitcnt lgkmcnt(0)
    v_mfma_f32_16x16x32_bf16 v[252:255], a[64:67], a[204:207], v[252:255]
    ds_read_b64_tr_b16 a[80:81], v14 offset:14496
    v_mfma_f32_16x16x32_bf16 v[252:255], a[68:71], a[220:223], v[252:255]
    ds_read_b64_tr_b16 a[82:83], v14 offset:16288
    v_mfma_f32_16x16x32_bf16 v[248:251], a[68:71], a[216:219], v[248:251]
    ds_read_b64_tr_b16 a[84:85], v14 offset:21664
    v_mfma_f32_16x16x32_bf16 v[248:251], a[64:67], a[200:203], v[248:251]
    ds_read_b64_tr_b16 a[86:87], v14 offset:23456
    s_add_u32 m0, s64, 0
    v_mfma_f32_16x16x32_bf16 v[244:247], a[64:67], a[196:199], v[244:247]
    buffer_load_dwordx4 v9, s[12:15], s62 offen offset:0 lds
    v_mfma_f32_16x16x32_bf16 v[244:247], a[68:71], a[212:215], v[244:247]
    v_mfma_f32_16x16x32_bf16 v[240:243], a[68:71], a[208:211], v[240:243]
    buffer_load_dwordx4 v10, s[12:15], s62 offen offset:1024 lds
    s_add_u32 s62, s62, 128
    v_mfma_f32_16x16x32_bf16 v[240:243], a[64:67], a[192:195], v[240:243]
    v_mfma_f32_16x16x32_bf16 a[0:3], a[72:75], a[192:195], a[0:3]
    ds_read_b64_tr_b16 a[64:65], v14 offset:192
    v_mfma_f32_16x16x32_bf16 a[0:3], a[76:79], a[208:211], a[0:3]
    ds_read_b64_tr_b16 a[66:67], v14 offset:1984
    v_mfma_f32_16x16x32_bf16 a[4:7], a[76:79], a[212:215], a[4:7]
    ds_read_b64_tr_b16 a[68:69], v14 offset:7360
    v_mfma_f32_16x16x32_bf16 a[4:7], a[72:75], a[196:199], a[4:7]
    ds_read_b64_tr_b16 a[70:71], v14 offset:9152
    v_mfma_f32_16x16x32_bf16 a[8:11], a[72:75], a[200:203], a[8:11]
    v_mfma_f32_16x16x32_bf16 a[8:11], a[76:79], a[216:219], a[8:11]
    buffer_load_dwordx4 a[128:131], v1, s[4:7], s60 offen offset:0 sc1
    v_mfma_f32_16x16x32_bf16 a[12:15], a[76:79], a[220:223], a[12:15]
    v_mfma_f32_16x16x32_bf16 a[12:15], a[72:75], a[204:207], a[12:15]
    s_waitcnt lgkmcnt(0)
    v_mfma_f32_16x16x32_bf16 a[28:31], a[80:83], a[204:207], a[28:31]
    ds_read_b64_tr_b16 a[72:73], v14 offset:14528
    v_mfma_f32_16x16x32_bf16 a[28:31], a[84:87], a[220:223], a[28:31]
    ds_read_b64_tr_b16 a[74:75], v14 offset:16320
    v_mfma_f32_16x16x32_bf16 a[24:27], a[84:87], a[216:219], a[24:27]
    ds_read_b64_tr_b16 a[76:77], v14 offset:21696
    v_mfma_f32_16x16x32_bf16 a[24:27], a[80:83], a[200:203], a[24:27]
    ds_read_b64_tr_b16 a[78:79], v14 offset:23488
    v_mfma_f32_16x16x32_bf16 a[20:23], a[80:83], a[196:199], a[20:23]
    v_mfma_f32_16x16x32_bf16 a[20:23], a[84:87], a[212:215], a[20:23]
    buffer_load_dwordx4 a[132:135], v1, s[4:7], s60 offen offset:1024 sc1
    v_mfma_f32_16x16x32_bf16 a[16:19], a[84:87], a[208:211], a[16:19]
    v_mfma_f32_16x16x32_bf16 a[16:19], a[80:83], a[192:195], a[16:19]
    v_mfma_f32_16x16x32_bf16 a[32:35], a[64:67], a[192:195], a[32:35]
    ds_read_b128 a[80:83], v15 offset:0
    v_mfma_f32_16x16x32_bf16 a[32:35], a[68:71], a[208:211], a[32:35]
    ds_read_b128 a[84:87], v16 offset:0
    v_mfma_f32_16x16x32_bf16 a[36:39], a[68:71], a[212:215], a[36:39]
    v_mfma_f32_16x16x32_bf16 a[36:39], a[64:67], a[196:199], a[36:39]
    v_mfma_f32_16x16x32_bf16 a[40:43], a[64:67], a[200:203], a[40:43]
    buffer_load_dwordx4 a[136:139], v1, s[4:7], s60 offen offset:2048 sc1
    v_mfma_f32_16x16x32_bf16 a[40:43], a[68:71], a[216:219], a[40:43]
    v_mfma_f32_16x16x32_bf16 a[44:47], a[68:71], a[220:223], a[44:47]
    buffer_load_dwordx4 a[140:143], v1, s[4:7], s60 offen offset:3072 sc1
    s_add_u32 s60, s60, 4096
    v_mfma_f32_16x16x32_bf16 a[44:47], a[64:67], a[204:207], a[44:47]
    s_waitcnt lgkmcnt(0)
    v_mfma_f32_16x16x32_bf16 a[60:63], a[72:75], a[204:207], a[60:63]
    ds_read_b128 a[64:67], v15 offset:2048
    v_mfma_f32_16x16x32_bf16 a[60:63], a[76:79], a[220:223], a[60:63]
    ds_read_b128 a[68:71], v16 offset:2048
    v_mfma_f32_16x16x32_bf16 a[56:59], a[76:79], a[216:219], a[56:59]
    v_mfma_f32_16x16x32_bf16 a[56:59], a[72:75], a[200:203], a[56:59]
    v_mfma_f32_16x16x32_bf16 a[52:55], a[72:75], a[196:199], a[52:55]
    buffer_load_dwordx4 a[144:147], v1, s[4:7], s60 offen offset:0 sc1
    v_mfma_f32_16x16x32_bf16 a[52:55], a[76:79], a[212:215], a[52:55]
    v_mfma_f32_16x16x32_bf16 a[48:51], a[76:79], a[208:211], a[48:51]
    buffer_load_dwordx4 a[148:151], v1, s[4:7], s60 offen offset:1024 sc1
    v_mfma_f32_16x16x32_bf16 a[48:51], a[72:75], a[192:195], a[48:51]
    v_mfma_f32_16x16x32_bf16 v[32:35], a[192:195], a[80:83], v[32:35]
    ds_read_b128 a[72:75], v15 offset:4096
    v_mfma_f32_16x16x32_bf16 v[32:35], a[208:211], a[84:87], v[32:35]
    ds_read_b128 a[76:79], v16 offset:4096
    v_mfma_f32_16x16x32_bf16 v[36:39], a[212:215], a[84:87], v[36:39]
    v_mfma_f32_16x16x32_bf16 v[36:39], a[196:199], a[80:83], v[36:39]
    v_mfma_f32_16x16x32_bf16 v[40:43], a[200:203], a[80:83], v[40:43]
    v_mfma_f32_16x16x32_bf16 v[40:43], a[216:219], a[84:87], v[40:43]
    buffer_load_dwordx4 a[152:155], v1, s[4:7], s60 offen offset:2048 sc1
    v_mfma_f32_16x16x32_bf16 v[44:47], a[220:223], a[84:87], v[44:47]
    v_mfma_f32_16x16x32_bf16 v[44:47], a[204:207], a[80:83], v[44:47]
    s_waitcnt lgkmcnt(0)
    v_mfma_f32_16x16x32_bf16 v[60:63], a[204:207], a[64:67], v[60:63]
    ds_read_b128 a[80:83], v15 offset:6144
    v_mfma_f32_16x16x32_bf16 v[60:63], a[220:223], a[68:71], v[60:63]
    ds_read_b128 a[84:87], v16 offset:6144
    v_mfma_f32_16x16x32_bf16 v[56:59], a[216:219], a[68:71], v[56:59]
    v_mfma_f32_16x16x32_bf16 v[56:59], a[200:203], a[64:67], v[56:59]
    v_mfma_f32_16x16x32_bf16 v[52:55], a[196:199], a[64:67], v[52:55]
    buffer_load_dwordx4 a[156:159], v1, s[4:7], s60 offen offset:3072 sc1
    s_add_u32 s60, s60, 4096
    v_mfma_f32_16x16x32_bf16 v[52:55], a[212:215], a[68:71], v[52:55]
    v_mfma_f32_16x16x32_bf16 v[48:51], a[208:211], a[68:71], v[48:51]
    v_mfma_f32_16x16x32_bf16 v[48:51], a[192:195], a[64:67], v[48:51]
    v_mfma_f32_16x16x32_bf16 v[64:67], a[192:195], a[72:75], v[64:67]
    s_waitcnt vmcnt(26)
    s_barrier
    ds_read_b64_tr_b16 a[64:65], v14 offset:36864
    v_mfma_f32_16x16x32_bf16 v[64:67], a[208:211], a[76:79], v[64:67]
    ds_read_b64_tr_b16 a[66:67], v14 offset:38656
    v_mfma_f32_16x16x32_bf16 v[68:71], a[212:215], a[76:79], v[68:71]
    ds_read_b64_tr_b16 a[68:69], v14 offset:44032
    v_mfma_f32_16x16x32_bf16 v[68:71], a[196:199], a[72:75], v[68:71]
    ds_read_b64_tr_b16 a[70:71], v14 offset:45824
    v_mfma_f32_16x16x32_bf16 v[72:75], a[200:203], a[72:75], v[72:75]
    s_add_u32 m0, s63, 36864
    v_mfma_f32_16x16x32_bf16 v[72:75], a[216:219], a[76:79], v[72:75]
    buffer_load_dwordx4 v2, s[8:11], s61 offen offset:0 lds
    v_mfma_f32_16x16x32_bf16 v[76:79], a[220:223], a[76:79], v[76:79]
    v_mfma_f32_16x16x32_bf16 v[76:79], a[204:207], a[72:75], v[76:79]
    s_waitcnt lgkmcnt(0)
    v_mfma_f32_16x16x32_bf16 v[92:95], a[204:207], a[80:83], v[92:95]
    ds_read_b64_tr_b16 a[72:73], v14 offset:51200
    v_mfma_f32_16x16x32_bf16 v[92:95], a[220:223], a[84:87], v[92:95]
    ds_read_b64_tr_b16 a[74:75], v14 offset:52992
    v_mfma_f32_16x16x32_bf16 v[88:91], a[216:219], a[84:87], v[88:91]
    ds_read_b64_tr_b16 a[76:77], v14 offset:58368
    v_mfma_f32_16x16x32_bf16 v[88:91], a[200:203], a[80:83], v[88:91]
    ds_read_b64_tr_b16 a[78:79], v14 offset:60160
    v_mfma_f32_16x16x32_bf16 v[84:87], a[196:199], a[80:83], v[84:87]
    v_mfma_f32_16x16x32_bf16 v[84:87], a[212:215], a[84:87], v[84:87]
    buffer_load_dwordx4 v3, s[8:11], s61 offen offset:1024 lds
    v_mfma_f32_16x16x32_bf16 v[80:83], a[208:211], a[84:87], v[80:83]
    v_mfma_f32_16x16x32_bf16 v[80:83], a[192:195], a[80:83], v[80:83]
    s_waitcnt vmcnt(20)
    v_mfma_f32_16x16x32_bf16 v[96:99], a[64:67], a[224:227], v[96:99]
    ds_read_b64_tr_b16 a[80:81], v14 offset:36896
    v_mfma_f32_16x16x32_bf16 v[96:99], a[68:71], a[240:243], v[96:99]
    ds_read_b64_tr_b16 a[82:83], v14 offset:38688
    v_mfma_f32_16x16x32_bf16 v[100:103], a[68:71], a[244:247], v[100:103]
    ds_read_b64_tr_b16 a[84:85], v14 offset:44064
    v_mfma_f32_16x16x32_bf16 v[100:103], a[64:67], a[228:231], v[100:103]
    ds_read_b64_tr_b16 a[86:87], v14 offset:45856
    v_mfma_f32_16x16x32_bf16 v[104:107], a[64:67], a[232:235], v[104:107]
    buffer_load_dwordx4 v4, s[8:11], s61 offen offset:2048 lds
    v_mfma_f32_16x16x32_bf16 v[104:107], a[68:71], a[248:251], v[104:107]
    v_mfma_f32_16x16x32_bf16 v[108:111], a[68:71], a[252:255], v[108:111]
    buffer_load_dwordx4 v5, s[8:11], s61 offen offset:3072 lds
    v_mfma_f32_16x16x32_bf16 v[108:111], a[64:67], a[236:239], v[108:111]
    s_waitcnt lgkmcnt(0)
    v_mfma_f32_16x16x32_bf16 v[124:127], a[72:75], a[236:239], v[124:127]
    ds_read_b64_tr_b16 a[64:65], v14 offset:51232
    v_mfma_f32_16x16x32_bf16 v[124:127], a[76:79], a[252:255], v[124:127]
    ds_read_b64_tr_b16 a[66:67], v14 offset:53024
    v_mfma_f32_16x16x32_bf16 v[120:123], a[76:79], a[248:251], v[120:123]
    ds_read_b64_tr_b16 a[68:69], v14 offset:58400
    v_mfma_f32_16x16x32_bf16 v[120:123], a[72:75], a[232:235], v[120:123]
    ds_read_b64_tr_b16 a[70:71], v14 offset:60192
    v_mfma_f32_16x16x32_bf16 v[116:119], a[72:75], a[228:231], v[116:119]
    s_add_u32 m0, s63, 40960
    v_mfma_f32_16x16x32_bf16 v[116:119], a[76:79], a[244:247], v[116:119]
    buffer_load_dwordx4 v6, s[8:11], s61 offen offset:0 lds
    v_mfma_f32_16x16x32_bf16 v[112:115], a[76:79], a[240:243], v[112:115]
    v_mfma_f32_16x16x32_bf16 v[112:115], a[72:75], a[224:227], v[112:115]
    v_mfma_f32_16x16x32_bf16 v[128:131], a[80:83], a[224:227], v[128:131]
    ds_read_b64_tr_b16 a[72:73], v14 offset:36928
    v_mfma_f32_16x16x32_bf16 v[128:131], a[84:87], a[240:243], v[128:131]
    ds_read_b64_tr_b16 a[74:75], v14 offset:38720
    v_mfma_f32_16x16x32_bf16 v[132:135], a[84:87], a[244:247], v[132:135]
    ds_read_b64_tr_b16 a[76:77], v14 offset:44096
    v_mfma_f32_16x16x32_bf16 v[132:135], a[80:83], a[228:231], v[132:135]
    ds_read_b64_tr_b16 a[78:79], v14 offset:45888
    v_mfma_f32_16x16x32_bf16 v[136:139], a[80:83], a[232:235], v[136:139]
    v_mfma_f32_16x16x32_bf16 v[136:139], a[84:87], a[248:251], v[136:139]
    buffer_load_dwordx4 v7, s[8:11], s61 offen offset:1024 lds
    v_mfma_f32_16x16x32_bf16 v[140:143], a[84:87], a[252:255], v[140:143]
    v_mfma_f32_16x16x32_bf16 v[140:143], a[80:83], a[236:239], v[140:143]
    s_waitcnt lgkmcnt(0)
    v_mfma_f32_16x16x32_bf16 v[156:159], a[64:67], a[236:239], v[156:159]
    ds_read_b64_tr_b16 a[80:81], v14 offset:51264
    v_mfma_f32_16x16x32_bf16 v[156:159], a[68:71], a[252:255], v[156:159]
    ds_read_b64_tr_b16 a[82:83], v14 offset:53056
    v_mfma_f32_16x16x32_bf16 v[152:155], a[68:71], a[248:251], v[152:155]
    ds_read_b64_tr_b16 a[84:85], v14 offset:58432
    v_mfma_f32_16x16x32_bf16 v[152:155], a[64:67], a[232:235], v[152:155]
    ds_read_b64_tr_b16 a[86:87], v14 offset:60224
    v_mfma_f32_16x16x32_bf16 v[148:151], a[64:67], a[228:231], v[148:151]
    buffer_load_dwordx4 v8, s[8:11], s61 offen offset:2048 lds
    s_add_u32 s61, s61, 458752
    v_mfma_f32_16x16x32_bf16 v[148:151], a[68:71], a[244:247], v[148:151]
    s_add_u32 m0, s64, 36864
    v_mfma_f32_16x16x32_bf16 v[144:147], a[68:71], a[240:243], v[144:147]
    buffer_load_dwordx4 v9, s[12:15], s62 offen offset:0 lds
    v_mfma_f32_16x16x32_bf16 v[144:147], a[64:67], a[224:227], v[144:147]
    v_mfma_f32_16x16x32_bf16 v[160:163], a[72:75], a[224:227], v[160:163]
    ds_read_b64_tr_b16 a[64:65], v14 offset:36960
    v_mfma_f32_16x16x32_bf16 v[160:163], a[76:79], a[240:243], v[160:163]
    ds_read_b64_tr_b16 a[66:67], v14 offset:38752
    v_mfma_f32_16x16x32_bf16 v[164:167], a[76:79], a[244:247], v[164:167]
    ds_read_b64_tr_b16 a[68:69], v14 offset:44128
    v_mfma_f32_16x16x32_bf16 v[164:167], a[72:75], a[228:231], v[164:167]
    ds_read_b64_tr_b16 a[70:71], v14 offset:45920
    v_mfma_f32_16x16x32_bf16 v[168:171], a[72:75], a[232:235], v[168:171]
    v_mfma_f32_16x16x32_bf16 v[168:171], a[76:79], a[248:251], v[168:171]
    buffer_load_dwordx4 v10, s[12:15], s62 offen offset:1024 lds
    s_add_u32 s62, s62, 128
    v_mfma_f32_16x16x32_bf16 v[172:175], a[76:79], a[252:255], v[172:175]
    v_mfma_f32_16x16x32_bf16 v[172:175], a[72:75], a[236:239], v[172:175]
    s_waitcnt lgkmcnt(0)
    v_mfma_f32_16x16x32_bf16 v[188:191], a[80:83], a[236:239], v[188:191]
    ds_read_b64_tr_b16 a[72:73], v14 offset:51296
    v_mfma_f32_16x16x32_bf16 v[188:191], a[84:87], a[252:255], v[188:191]
    ds_read_b64_tr_b16 a[74:75], v14 offset:53088
    v_mfma_f32_16x16x32_bf16 v[184:187], a[84:87], a[248:251], v[184:187]
    ds_read_b64_tr_b16 a[76:77], v14 offset:58464
    v_mfma_f32_16x16x32_bf16 v[184:187], a[80:83], a[232:235], v[184:187]
    ds_read_b64_tr_b16 a[78:79], v14 offset:60256
    v_mfma_f32_16x16x32_bf16 v[180:183], a[80:83], a[228:231], v[180:183]
    v_mfma_f32_16x16x32_bf16 v[180:183], a[84:87], a[244:247], v[180:183]
    buffer_load_dword v31, v21, s[8:11], 0 offen
    v_add_u32 v21, 458752, v21
    v_mfma_f32_16x16x32_bf16 v[176:179], a[84:87], a[240:243], v[176:179]
    v_mfma_f32_16x16x32_bf16 v[176:179], a[80:83], a[224:227], v[176:179]
    v_mfma_f32_16x16x32_bf16 v[192:195], a[64:67], a[224:227], v[192:195]
    ds_read_b64_tr_b16 a[80:81], v14 offset:36992
    v_mfma_f32_16x16x32_bf16 v[192:195], a[68:71], a[240:243], v[192:195]
    ds_read_b64_tr_b16 a[82:83], v14 offset:38784
    v_mfma_f32_16x16x32_bf16 v[196:199], a[68:71], a[244:247], v[196:199]
L_pad1:
    s_cbranch_execz L_pad5
    ds_read_b64_tr_b16 a[84:85], v14 offset:44160
    v_mfma_f32_16x16x32_bf16 v[196:199], a[64:67], a[228:231], v[196:199]
    ds_read_b64_tr_b16 a[86:87], v14 offset:45952
    v_mfma_f32_16x16x32_bf16 v[200:203], a[64:67], a[232:235], v[200:203]
    buffer_load_dwordx4 a[160:163], v1, s[4:7], s60 offen offset:0 sc1
    v_mfma_f32_16x16x32_bf16 v[200:203], a[68:71], a[248:251], v[200:203]
    v_mfma_f32_16x16x32_bf16 v[204:207], a[68:71], a[252:255], v[204:207]
    buffer_load_dwordx4 a[164:167], v1, s[4:7], s60 offen offset:1024 sc1
    v_mfma_f32_16x16x32_bf16 v[204:207], a[64:67], a[236:239], v[204:207]
    s_waitcnt lgkmcnt(0)
    v_mfma_f32_16x16x32_bf16 v[220:223], a[72:75], a[236:239], v[220:223]
    ds_read_b64_tr_b16 a[64:65], v14 offset:51328
    v_mfma_f32_16x16x32_bf16 v[220:223], a[76:79], a[252:255], v[220:223]
    ds_read_b64_tr_b16 a[66:67], v14 offset:53120
    v_mfma_f32_16x16x32_bf16 v[216:219], a[76:79], a[248:251], v[216:219]
    ds_read_b64_tr_b16 a[68:69], v14 offset:58496
    v_mfma_f32_16x16x32_bf16 v[216:219], a[72:75], a[232:235], v[216:219]
    ds_read_b64_tr_b16 a[70:71], v14 offset:60288
    v_mfma_f32_16x16x32_bf16 v[212:215], a[72:75], a[228:231], v[212:215]
    v_mfma_f32_16x16x32_bf16 v[212:215], a[76:79], a[244:247], v[212:215]
    buffer_load_dwordx4 a[168:171], v1, s[4:7], s60 offen offset:2048 sc1
    v_mfma_f32_16x16x32_bf16 v[208:211], a[76:79], a[240:243], v[208:211]
    v_mfma_f32_16x16x32_bf16 v[208:211], a[72:75], a[224:227], v[208:211]
    v_mfma_f32_16x16x32_bf16 v[224:227], a[80:83], a[224:227], v[224:227]
    ds_read_b64_tr_b16 a[72:73], v14 offset:37024
    v_mfma_f32_16x16x32_bf16 v[224:227], a[84:87], a[240:243], v[224:227]
    ds_read_b64_tr_b16 a[74:75], v14 offset:38816
    v_mfma_f32_16x16x32_bf16 v[228:231], a[84:87], a[244:247], v[228:231]
    ds_read_b64_tr_b16 a[76:77], v14 offset:44192
    v_mfma_f32_16x16x32_bf16 v[228:231], a[80:83], a[228:231], v[228:231]
    ds_read_b64_tr_b16 a[78:79], v14 offset:45984
    v_mfma_f32_16x16x32_bf16 v[232:235], a[80:83], a[232:235], v[232:235]
    v_mfma_f32_16x16x32_bf16 v[232:235], a[84:87], a[248:251], v[232:235]
    buffer_load_dwordx4 a[172:175], v1, s[4:7], s60 offen offset:3072 sc1
    s_add_u32 s60, s60, 4096
    v_mfma_f32_16x16x32_bf16 v[236:239], a[84:87], a[252:255], v[236:239]
    v_mfma_f32_16x16x32_bf16 v[236:239], a[80:83], a[236:239], v[236:239]
    s_waitcnt lgkmcnt(0)
    v_mfma_f32_16x16x32_bf16 v[252:255], a[64:67], a[236:239], v[252:255]
    ds_read_b64_tr_b16 a[80:81], v14 offset:51360
    v_mfma_f32_16x16x32_bf16 v[252:255], a[68:71], a[252:255], v[252:255]
    ds_read_b64_tr_b16 a[82:83], v14 offset:53152
    v_mfma_f32_16x16x32_bf16 v[248:251], a[68:71], a[248:251], v[248:251]
    ds_read_b64_tr_b16 a[84:85], v14 offset:58528
    v_mfma_f32_16x16x32_bf16 v[248:251], a[64:67], a[232:235], v[248:251]
    ds_read_b64_tr_b16 a[86:87], v14 offset:60320
    v_mfma_f32_16x16x32_bf16 v[244:247], a[64:67], a[228:231], v[244:247]
    buffer_load_dwordx4 a[176:179], v1, s[4:7], s60 offen offset:0 sc1
    v_mfma_f32_16x16x32_bf16 v[244:247], a[68:71], a[244:247], v[244:247]
    v_mfma_f32_16x16x32_bf16 v[240:243], a[68:71], a[240:243], v[240:243]
    buffer_load_dwordx4 a[180:183], v1, s[4:7], s60 offen offset:1024 sc1
    v_mfma_f32_16x16x32_bf16 v[240:243], a[64:67], a[224:227], v[240:243]
    v_mfma_f32_16x16x32_bf16 a[0:3], a[72:75], a[224:227], a[0:3]
    ds_read_b64_tr_b16 a[64:65], v14 offset:37056
    v_mfma_f32_16x16x32_bf16 a[0:3], a[76:79], a[240:243], a[0:3]
    ds_read_b64_tr_b16 a[66:67], v14 offset:38848
    v_mfma_f32_16x16x32_bf16 a[4:7], a[76:79], a[244:247], a[4:7]
    ds_read_b64_tr_b16 a[68:69], v14 offset:44224
    v_mfma_f32_16x16x32_bf16 a[4:7], a[72:75], a[228:231], a[4:7]
    ds_read_b64_tr_b16 a[70:71], v14 offset:46016
    v_mfma_f32_16x16x32_bf16 a[8:11], a[72:75], a[232:235], a[8:11]
    v_mfma_f32_16x16x32_bf16 a[8:11], a[76:79], a[248:251], a[8:11]
    buffer_load_dwordx4 a[184:187], v1, s[4:7], s60 offen offset:2048 sc1
    v_mfma_f32_16x16x32_bf16 a[12:15], a[76:79], a[252:255], a[12:15]
    v_mfma_f32_16x16x32_bf16 a[12:15], a[72:75], a[236:239], a[12:15]
    s_waitcnt lgkmcnt(0)
    v_mfma_f32_16x16x32_bf16 a[28:31], a[80:83], a[236:239], a[28:31]
    ds_read_b64_tr_b16 a[72:73], v14 offset:51392
    v_mfma_f32_16x16x32_bf16 a[28:31], a[84:87], a[252:255], a[28:31]
    ds_read_b64_tr_b16 a[74:75], v14 offset:53184
    v_mfma_f32_16x16x32_bf16 a[24:27], a[84:87], a[248:251], a[24:27]
    ds_read_b64_tr_b16 a[76:77], v14 offset:58560
    v_mfma_f32_16x16x32_bf16 a[24:27], a[80:83], a[232:235], a[24:27]
    ds_read_b64_tr_b16 a[78:79], v14 offset:60352
    v_mfma_f32_16x16x32_bf16 a[20:23], a[80:83], a[228:231], a[20:23]
    v_mfma_f32_16x16x32_bf16 a[20:23], a[84:87], a[244:247], a[20:23]
    buffer_load_dwordx4 a[188:191], v1, s[4:7], s60 offen offset:3072 sc1
    s_add_u32 s60, s60, 4096
    v_mfma_f32_16x16x32_bf16 a[16:19], a[84:87], a[240:243], a[16:19]
    v_mfma_f32_16x16x32_bf16 a[16:19], a[80:83], a[224:227], a[16:19]
    v_mfma_f32_16x16x32_bf16 a[32:35], a[64:67], a[224:227], a[32:35]
    ds_read_b128 a[80:83], v15 offset:36864
    v_mfma_f32_16x16x32_bf16 a[32:35], a[68:71], a[240:243], a[32:35]
    ds_read_b128 a[84:87], v16 offset:36864
    v_mfma_f32_16x16x32_bf16 a[36:39], a[68:71], a[244:247], a[36:39]
    v_mfma_f32_16x16x32_bf16 a[36:39], a[64:67], a[228:231], a[36:39]
    v_mfma_f32_16x16x32_bf16 a[40:43], a[64:67], a[232:235], a[40:43]
    buffer_load_dword v31, v20, s[20:23], 0 offen
    v_add_u32 v20, s27, v20
    v_mfma_f32_16x16x32_bf16 a[40:43], a[68:71], a[248:251], a[40:43]
    v_mfma_f32_16x16x32_bf16 a[44:47], a[68:71], a[252:255], a[44:47]
    v_mfma_f32_16x16x32_bf16 a[44:47], a[64:67], a[236:239], a[44:47]
    s_waitcnt lgkmcnt(0)
    v_mfma_f32_16x16x32_bf16 a[60:63], a[72:75], a[236:239], a[60:63]
    ds_read_b128 a[64:67], v15 offset:38912
    v_mfma_f32_16x16x32_bf16 a[60:63], a[76:79], a[252:255], a[60:63]
    ds_read_b128 a[68:71], v16 offset:38912
    v_mfma_f32_16x16x32_bf16 a[56:59], a[76:79], a[248:251], a[56:59]
    v_mfma_f32_16x16x32_bf16 a[56:59], a[72:75], a[232:235], a[56:59]
    v_mfma_f32_16x16x32_bf16 a[52:55], a[72:75], a[228:231], a[52:55]
    v_mfma_f32_16x16x32_bf16 a[52:55], a[76:79], a[244:247], a[52:55]
    v_mfma_f32_16x16x32_bf16 a[48:51], a[76:79], a[240:243], a[48:51]
    v_mfma_f32_16x16x32_bf16 a[48:51], a[72:75], a[224:227], a[48:51]
    v_mfma_f32_16x16x32_bf16 v[32:35], a[224:227], a[80:83], v[32:35]
    ds_read_b128 a[72:75], v15 offset:40960
    v_mfma_f32_16x16x32_bf16 v[32:35], a[240:243], a[84:87], v[32:35]
    ds_read_b128 a[76:79], v16 offset:40960
    v_mfma_f32_16x16x32_bf16 v[36:39], a[244:247], a[84:87], v[36:39]
    v_mfma_f32_16x16x32_bf16 v[36:39], a[228:231], a[80:83], v[36:39]
    v_mfma_f32_16x16x32_bf16 v[40:43], a[232:235], a[80:83], v[40:43]
    v_mfma_f32_16x16x32_bf16 v[40:43], a[248:251], a[84:87], v[40:43]
    v_mfma_f32_16x16x32_bf16 v[44:47], a[252:255], a[84:87], v[44:47]
    v_mfma_f32_16x16x32_bf16 v[44:47], a[236:239], a[80:83], v[44:47]
    s_waitcnt lgkmcnt(0)
    v_mfma_f32_16x16x32_bf16 v[60:63], a[236:239], a[64:67], v[60:63]
    ds_read_b128 a[80:83], v15 offset:43008
    v_mfma_f32_16x16x32_bf16 v[60:63], a[252:255], a[68:71], v[60:63]
    ds_read_b128 a[84:87], v16 offset:43008
    v_mfma_f32_16x16x32_bf16 v[56:59], a[248:251], a[68:71], v[56:59]
    v_mfma_f32_16x16x32_bf16 v[56:59], a[232:235], a[64:67], v[56:59]
    v_mfma_f32_16x16x32_bf16 v[52:55], a[228:231], a[64:67], v[52:55]
    v_mfma_f32_16x16x32_bf16 v[52:55], a[244:247], a[68:71], v[52:55]
    v_mfma_f32_16x16x32_bf16 v[48:51], a[240:243], a[68:71], v[48:51]
    v_mfma_f32_16x16x32_bf16 v[48:51], a[224:227], a[64:67], v[48:51]
    v_mfma_f32_16x16x32_bf16 v[64:67], a[224:227], a[72:75], v[64:67]
    s_waitcnt vmcnt(27)
    s_barrier
    ds_read_b64_tr_b16 a[64:65], v11 offset:0
    v_mfma_f32_16x16x32_bf16 v[64:67], a[240:243], a[76:79], v[64:67]
    ds_read_b64_tr_b16 a[66:67], v11 offset:1792
    v_mfma_f32_16x16x32_bf16 v[68:71], a[244:247], a[76:79], v[68:71]
    ds_read_b64_tr_b16 a[68:69], v11 offset:7168
    v_mfma_f32_16x16x32_bf16 v[68:71], a[228:231], a[72:75], v[68:71]
    ds_read_b64_tr_b16 a[70:71], v11 offset:8960
    v_mfma_f32_16x16x32_bf16 v[72:75], a[232:235], a[72:75], v[72:75]
    s_add_u32 m0, s63, 73728
    v_mfma_f32_16x16x32_bf16 v[72:75], a[248:251], a[76:79], v[72:75]
    buffer_load_dwordx4 v2, s[8:11], s61 offen offset:0 lds
    v_mfma_f32_16x16x32_bf16 v[76:79], a[252:255], a[76:79], v[76:79]
    v_mfma_f32_16x16x32_bf16 v[76:79], a[236:239], a[72:75], v[76:79]
    s_waitcnt lgkmcnt(0)
    v_mfma_f32_16x16x32_bf16 v[92:95], a[236:239], a[80:83], v[92:95]
    ds_read_b64_tr_b16 a[72:73], v11 offset:14336
    v_mfma_f32_16x16x32_bf16 v[92:95], a[252:255], a[84:87], v[92:95]
    ds_read_b64_tr_b16 a[74:75], v11 offset:16128
    v_mfma_f32_16x16x32_bf16 v[88:91], a[248:251], a[84:87], v[88:91]
    ds_read_b64_tr_b16 a[76:77], v11 offset:21504
    v_mfma_f32_16x16x32_bf16 v[88:91], a[232:235], a[80:83], v[88:91]
    ds_read_b64_tr_b16 a[78:79], v11 offset:23296
    v_mfma_f32_16x16x32_bf16 v[84:87], a[228:231], a[80:83], v[84:87]
    v_mfma_f32_16x16x32_bf16 v[84:87], a[244:247], a[84:87], v[84:87]
    buffer_load_dwordx4 v3, s[8:11], s61 offen offset:1024 lds
    v_mfma_f32_16x16x32_bf16 v[80:83], a[240:243], a[84:87], v[80:83]
    v_mfma_f32_16x16x32_bf16 v[80:83], a[224:227], a[80:83], v[80:83]
    s_waitcnt vmcnt(21)
    v_mfma_f32_16x16x32_bf16 v[96:99], a[64:67], a[128:131], v[96:99]
    ds_read_b64_tr_b16 a[80:81], v11 offset:32
    v_mfma_f32_16x16x32_bf16 v[96:99], a[68:71], a[144:147], v[96:99]
    ds_read_b64_tr_b16 a[82:83], v11 offset:1824
    v_mfma_f32_16x16x32_bf16 v[100:103], a[68:71], a[148:151], v[100:103]
    ds_read_b64_tr_b16 a[84:85], v11 offset:7200
    v_mfma_f32_16x16x32_bf16 v[100:103], a[64:67], a[132:135], v[100:103]
    ds_read_b64_tr_b16 a[86:87], v11 offset:8992
    v_mfma_f32_16x16x32_bf16 v[104:107], a[64:67], a[136:139], v[104:107]
    buffer_load_dwordx4 v4, s[8:11], s61 offen offset:2048 lds
    v_mfma_f32_16x16x32_bf16 v[104:107], a[68:71], a[152:155], v[104:107]
    v_mfma_f32_16x16x32_bf16 v[108:111], a[68:71], a[156:159], v[108:111]
    buffer_load_dwordx4 v5, s[8:11], s61 offen offset:3072 lds
    v_mfma_f32_16x16x32_bf16 v[108:111], a[64:67], a[140:143], v[108:111]
    s_waitcnt lgkmcnt(0)
    v_mfma_f32_16x16x32_bf16 v[124:127], a[72:75], a[140:143], v[124:127]
    ds_read_b64_tr_b16 a[64:65], v11 offset:14368
    v_mfma_f32_16x16x32_bf16 v[124:127], a[76:79], a[156:159], v[124:127]
    ds_read_b64_tr_b16 a[66:67], v11 offset:16160
    v_mfma_f32_16x16x32_bf16 v[120:123], a[76:79], a[152:155], v[120:123]
    ds_read_b64_tr_b16 a[68:69], v11 offset:21536
    v_mfma_f32_16x16x32_bf16 v[120:123], a[72:75], a[136:139], v[120:123]
    ds_read_b64_tr_b16 a[70:71], v11 offset:23328
    v_mfma_f32_16x16x32_bf16 v[116:119], a[72:75], a[132:135], v[116:119]
    s_add_u32 m0, s63, 77824
    v_mfma_f32_16x16x32_bf16 v[116:119], a[76:79], a[148:151], v[116:119]
    buffer_load_dwordx4 v6, s[8:11], s61 offen offset:0 lds
    v_mfma_f32_16x16x32_bf16 v[112:115], a[76:79], a[144:147], v[112:115]
    v_mfma_f32_16x16x32_bf16 v[112:115], a[72:75], a[128:131], v[112:115]
    v_mfma_f32_16x16x32_bf16 v[128:131], a[80:83], a[128:131], v[128:131]
    ds_read_b64_tr_b16 a[72:73], v11 offset:64
    v_mfma_f32_16x16x32_bf16 v[128:131], a[84:87], a[144:147], v[128:131]
    ds_read_b64_tr_b16 a[74:75], v11 offset:1856
    v_mfma_f32_16x16x32_bf16 v[132:135], a[84:87], a[148:151], v[132:135]
    ds_read_b64_tr_b16 a[76:77], v11 offset:7232
    v_mfma_f32_16x16x32_bf16 v[132:135], a[80:83], a[132:135], v[132:135]
    ds_read_b64_tr_b16 a[78:79], v11 offset:9024
    v_mfma_f32_16x16x32_bf16 v[136:139], a[80:83], a[136:139], v[136:139]
    v_mfma_f32_16x16x32_bf16 v[136:139], a[84:87], a[152:155], v[136:139]
    buffer_load_dwordx4 v7, s[8:11], s61 offen offset:1024 lds
    v_mfma_f32_16x16x32_bf16 v[140:143], a[84:87], a[156:159], v[140:143]
    v_mfma_f32_16x16x32_bf16 v[140:143], a[80:83], a[140:143], v[140:143]
    s_waitcnt lgkmcnt(0)
    v_mfma_f32_16x16x32_bf16 v[156:159], a[64:67], a[140:143], v[156:159]
    ds_read_b64_tr_b16 a[80:81], v11 offset:14400
    v_mfma_f32_16x16x32_bf16 v[156:159], a[68:71], a[156:159], v[156:159]
    ds_read_b64_tr_b16 a[82:83], v11 offset:16192
    v_mfma_f32_16x16x32_bf16 v[152:155], a[68:71], a[152:155], v[152:155]
    ds_read_b64_tr_b16 a[84:85], v11 offset:21568
    v_mfma_f32_16x16x32_bf16 v[152:155], a[64:67], a[136:139], v[152:155]
    ds_read_b64_tr_b16 a[86:87], v11 offset:23360
    v_mfma_f32_16x16x32_bf16 v[148:151], a[64:67], a[132:135], v[148:151]
    buffer_load_dwordx4 v8, s[8:11], s61 offen offset:2048 lds
    s_add_u32 s61, s61, 458752
    v_mfma_f32_16x16x32_bf16 v[148:151], a[68:71], a[148:151], v[148:151]
    s_add_u32 m0, s64, 73728
    v_mfma_f32_16x16x32_bf16 v[144:147], a[68:71], a[144:147], v[144:147]
    buffer_load_dwordx4 v9, s[12:15], s62 offen offset:0 lds
    v_mfma_f32_16x16x32_bf16 v[144:147], a[64:67], a[128:131], v[144:147]
    v_mfma_f32_16x16x32_bf16 v[160:163], a[72:75], a[128:131], v[160:163]
    ds_read_b64_tr_b16 a[64:65], v11 offset:96
    v_mfma_f32_16x16x32_bf16 v[160:163], a[76:79], a[144:147], v[160:163]
    ds_read_b64_tr_b16 a[66:67], v11 offset:1888
    v_mfma_f32_16x16x32_bf16 v[164:167], a[76:79], a[148:151], v[164:167]
    ds_read_b64_tr_b16 a[68:69], v11 offset:7264
    v_mfma_f32_16x16x32_bf16 v[164:167], a[72:75], a[132:135], v[164:167]
    ds_read_b64_tr_b16 a[70:71], v11 offset:9056
    v_mfma_f32_16x16x32_bf16 v[168:171], a[72:75], a[136:139], v[168:171]
    v_mfma_f32_16x16x32_bf16 v[168:171], a[76:79], a[152:155], v[168:171]
    buffer_load_dwordx4 v10, s[12:15], s62 offen offset:1024 lds
    s_add_u32 s62, s62, 128
    v_mfma_f32_16x16x32_bf16 v[172:175], a[76:79], a[156:159], v[172:175]
    v_mfma_f32_16x16x32_bf16 v[172:175], a[72:75], a[140:143], v[172:175]
    s_waitcnt lgkmcnt(0)
    v_mfma_f32_16x16x32_bf16 v[188:191], a[80:83], a[140:143], v[188:191]
    ds_read_b64_tr_b16 a[72:73], v11 offset:14432
    v_mfma_f32_16x16x32_bf16 v[188:191], a[84:87], a[156:159], v[188:191]
    ds_read_b64_tr_b16 a[74:75], v11 offset:16224
    v_mfma_f32_16x16x32_bf16 v[184:187], a[84:87], a[152:155], v[184:187]
    ds_read_b64_tr_b16 a[76:77], v11 offset:21600
    v_mfma_f32_16x16x32_bf16 v[184:187], a[80:83], a[136:139], v[184:187]
    ds_read_b64_tr_b16 a[78:79], v11 offset:23392
    v_mfma_f32_16x16x32_bf16 v[180:183], a[80:83], a[132:135], v[180:183]
    v_mfma_f32_16x16x32_bf16 v[180:183], a[84:87], a[148:151], v[180:183]
    buffer_load_dword v31, v21, s[8:11], 0 offen
    v_add_u32 v21, 458752, v21
    v_mfma_f32_16x16x32_bf16 v[176:179], a[84:87], a[144:147], v[176:179]
    v_mfma_f32_16x16x32_bf16 v[176:179], a[80:83], a[128:131], v[176:179]
    v_mfma_f32_16x16x32_bf16 v[192:195], a[64:67], a[128:131], v[192:195]
    ds_read_b64_tr_b16 a[80:81], v11 offset:128
    v_mfma_f32_16x16x32_bf16 v[192:195], a[68:71], a[144:147], v[192:195]
    ds_read_b64_tr_b16 a[82:83], v11 offset:1920
    v_mfma_f32_16x16x32_bf16 v[196:199], a[68:71], a[148:151], v[196:199]
    ds_read_b64_tr_b16 a[84:85], v11 offset:7296
    v_mfma_f32_16x16x32_bf16 v[196:199], a[64:67], a[132:135], v[196:199]
    ds_read_b64_tr_b16 a[86:87], v11 offset:9088
    v_mfma_f32_16x16x32_bf16 v[200:203], a[64:67], a[136:139], v[200:203]
    buffer_load_dwordx4 a[192:195], v1, s[4:7], s60 offen offset:0 sc1
    v_mfma_f32_16x16x32_bf16 v[200:203], a[68:71], a[152:155], v[200:203]
    v_mfma_f32_16x16x32_bf16 v[204:207], a[68:71], a[156:159], v[204:207]
    buffer_load_dwordx4 a[196:199], v1, s[4:7], s60 offen offset:1024 sc1
    v_mfma_f32_16x16x32_bf16 v[204:207], a[64:67], a[140:143], v[204:207]
    s_waitcnt lgkmcnt(0)
    v_mfma_f32_16x16x32_bf16 v[220:223], a[72:75], a[140:143], v[220:223]
    ds_read_b64_tr_b16 a[64:65], v11 offset:14464
    v_mfma_f32_16x16x32_bf16 v[220:223], a[76:79], a[156:159], v[220:223]
    ds_read_b64_tr_b16 a[66:67], v11 offset:16256
    v_mfma_f32_16x16x32_bf16 v[216:219], a[76:79], a[152:155], v[216:219]
    ds_read_b64_tr_b16 a[68:69], v11 offset:21632
    v_mfma_f32_16x16x32_bf16 v[216:219], a[72:75], a[136:139], v[216:219]
    ds_read_b64_tr_b16 a[70:71], v11 offset:23424
    v_mfma_f32_16x16x32_bf16 v[212:215], a[72:75], a[132:135], v[212:215]
    v_mfma_f32_16x16x32_bf16 v[212:215], a[76:79], a[148:151], v[212:215]
    buffer_load_dwordx4 a[200:203], v1, s[4:7], s60 offen offset:2048 sc1
    v_mfma_f32_16x16x32_bf16 v[208:211], a[76:79], a[144:147], v[208:211]
    v_mfma_f32_16x16x32_bf16 v[208:211], a[72:75], a[128:131], v[208:211]
    v_mfma_f32_16x16x32_bf16 v[224:227], a[80:83], a[128:131], v[224:227]
    ds_read_b64_tr_b16 a[72:73], v11 offset:160
    v_mfma_f32_16x16x32_bf16 v[224:227], a[84:87], a[144:147], v[224:227]
    ds_read_b64_tr_b16 a[74:75], v11 offset:1952
    v_mfma_f32_16x16x32_bf16 v[228:231], a[84:87], a[148:151], v[228:231]
    ds_read_b64_tr_b16 a[76:77], v11 offset:7328
    v_mfma_f32_16x16x32_bf16 v[228:231], a[80:83], a[132:135], v[228:231]
    ds_read_b64_tr_b16 a[78:79], v11 offset:9120
    v_mfma_f32_16x16x32_bf16 v[232:235], a[80:83], a[136:139], v[232:235]
    v_mfma_f32_16x16x32_bf16 v[232:235], a[84:87], a[152:155], v[232:235]
    buffer_load_dwordx4 a[204:207], v1, s[4:7], s60 offen offset:3072 sc1
    s_add_u32 s60, s60, 4096
    v_mfma_f32_16x16x32_bf16 v[236:239], a[84:87], a[156:159], v[236:239]
    v_mfma_f32_16x16x32_bf16 v[236:239], a[80:83], a[140:143], v[236:239]
    s_waitcnt lgkmcnt(0)
    v_mfma_f32_16x16x32_bf16 v[252:255], a[64:67], a[140:143], v[252:255]
    ds_read_b64_tr_b16 a[80:81], v11 offset:14496
    v_mfma_f32_16x16x32_bf16 v[252:255], a[68:71], a[156:159], v[252:255]
    ds_read_b64_tr_b16 a[82:83], v11 offset:16288
    v_mfma_f32_16x16x32_bf16 v[248:251], a[68:71], a[152:155], v[248:251]
    ds_read_b64_tr_b16 a[84:85], v11 offset:21664
    v_mfma_f32_16x16x32_bf16 v[248:251], a[64:67], a[136:139], v[248:251]
    ds_read_b64_tr_b16 a[86:87], v11 offset:23456
    v_mfma_f32_16x16x32_bf16 v[244:247], a[64:67], a[132:135], v[244:247]
    buffer_load_dwordx4 a[208:211], v1, s[4:7], s60 offen offset:0 sc1
    v_mfma_f32_16x16x32_bf16 v[244:247], a[68:71], a[148:151], v[244:247]
    v_mfma_f32_16x16x32_bf16 v[240:243], a[68:71], a[144:147], v[240:243]
    buffer_load_dwordx4 a[212:215], v1, s[4:7], s60 offen offset:1024 sc1
    v_mfma_f32_16x16x32_bf16 v[240:243], a[64:67], a[128:131], v[240:243]
    v_mfma_f32_16x16x32_bf16 a[0:3], a[72:75], a[128:131], a[0:3]
    ds_read_b64_tr_b16 a[64:65], v11 offset:192
    v_mfma_f32_16x16x32_bf16 a[0:3], a[76:79], a[144:147], a[0:3]
    ds_read_b64_tr_b16 a[66:67], v11 offset:1984
    v_mfma_f32_16x16x32_bf16 a[4:7], a[76:79], a[148:151], a[4:7]
    ds_read_b64_tr_b16 a[68:69], v11 offset:7360
    v_mfma_f32_16x16x32_bf16 a[4:7], a[72:75], a[132:135], a[4:7]
    ds_read_b64_tr_b16 a[70:71], v11 offset:9152
    v_mfma_f32_16x16x32_bf16 a[8:11], a[72:75], a[136:139], a[8:11]
    v_mfma_f32_16x16x32_bf16 a[8:11], a[76:79], a[152:155], a[8:11]
    buffer_load_dwordx4 a[216:219], v1, s[4:7], s60 offen offset:2048 sc1
    v_mfma_f32_16x16x32_bf16 a[12:15], a[76:79], a[156:159], a[12:15]
    v_mfma_f32_16x16x32_bf16 a[12:15], a[72:75], a[140:143], a[12:15]
    s_waitcnt lgkmcnt(0)
    v_mfma_f32_16x16x32_bf16 a[28:31], a[80:83], a[140:143], a[28:31]
    ds_read_b64_tr_b16 a[72:73], v11 offset:14528
    v_mfma_f32_16x16x32_bf16 a[28:31], a[84:87], a[156:159], a[28:31]
    ds_read_b64_tr_b16 a[74:75], v11 offset:16320
    v_mfma_f32_16x16x32_bf16 a[24:27], a[84:87], a[152:155], a[24:27]
    ds_read_b64_tr_b16 a[76:77], v11 offset:21696
    v_mfma_f32_16x16x32_bf16 a[24:27], a[80:83], a[136:139], a[24:27]
    ds_read_b64_tr_b16 a[78:79], v11 offset:23488
    v_mfma_f32_16x16x32_bf16 a[20:23], a[80:83], a[132:135], a[20:23]
    v_mfma_f32_16x16x32_bf16 a[20:23], a[84:87], a[148:151], a[20:23]
    buffer_load_dwordx4 a[220:223], v1, s[4:7], s60 offen offset:3072 sc1
    s_add_u32 s60, s60, 4096
    v_mfma_f32_16x16x32_bf16 a[16:19], a[84:87], a[144:147], a[16:19]
    v_mfma_f32_16x16x32_bf16 a[16:19], a[80:83], a[128:131], a[16:19]
    v_mfma_f32_16x16x32_bf16 a[32:35], a[64:67], a[128:131], a[32:35]
    ds_read_b128 a[80:83], v12 offset:0
    v_mfma_f32_16x16x32_bf16 a[32:35], a[68:71], a[144:147], a[32:35]
    ds_read_b128 a[84:87], v13 offset:0
    v_mfma_f32_16x16x32_bf16 a[36:39], a[68:71], a[148:151], a[36:39]
    v_mfma_f32_16x16x32_bf16 a[36:39], a[64:67], a[132:135], a[36:39]
    v_mfma_f32_16x16x32_bf16 a[40:43], a[64:67], a[136:139], a[40:43]
    buffer_load_dword v31, v20, s[20:23], 0 offen
    v_add_u32 v20, s27, v20
    v_mfma_f32_16x16x32_bf16 a[40:43], a[68:71], a[152:155], a[40:43]
    v_mfma_f32_16x16x32_bf16 a[44:47], a[68:71], a[156:159], a[44:47]
    v_mfma_f32_16x16x32_bf16 a[44:47], a[64:67], a[140:143], a[44:47]
    s_waitcnt lgkmcnt(0)
    v_mfma_f32_16x16x32_bf16 a[60:63], a[72:75], a[140:143], a[60:63]
    ds_read_b128 a[64:67], v12 offset:2048
    v_mfma_f32_16x16x32_bf16 a[60:63], a[76:79], a[156:159], a[60:63]
    ds_read_b128 a[68:71], v13 offset:2048
    v_mfma_f32_16x16x32_bf16 a[56:59], a[76:79], a[152:155], a[56:59]
    v_mfma_f32_16x16x32_bf16 a[56:59], a[72:75], a[136:139], a[56:59]
    v_mfma_f32_16x16x32_bf16 a[52:55], a[72:75], a[132:135], a[52:55]
    v_mfma_f32_16x16x32_bf16 a[52:55], a[76:79], a[148:151], a[52:55]
    v_mfma_f32_16x16x32_bf16 a[48:51], a[76:79], a[144:147], a[48:51]
    v_mfma_f32_16x16x32_bf16 a[48:51], a[72:75], a[128:131], a[48:51]
    v_mfma_f32_16x16x32_bf16 v[32:35], a[128:131], a[80:83], v[32:35]
    ds_read_b128 a[72:75], v12 offset:4096
    v_mfma_f32_16x16x32_bf16 v[32:35], a[144:147], a[84:87], v[32:35]
    ds_read_b128 a[76:79], v13 offset:4096
    v_mfma_f32_16x16x32_bf16 v[36:39], a[148:151], a[84:87], v[36:39]
    v_mfma_f32_16x16x32_bf16 v[36:39], a[132:135], a[80:83], v[36:39]
    v_mfma_f32_16x16x32_bf16 v[40:43], a[136:139], a[80:83], v[40:43]
    v_mfma_f32_16x16x32_bf16 v[40:43], a[152:155], a[84:87], v[40:43]
    v_mfma_f32_16x16x32_bf16 v[44:47], a[156:159], a[84:87], v[44:47]
    v_mfma_f32_16x16x32_bf16 v[44:47], a[140:143], a[80:83], v[44:47]
    s_waitcnt lgkmcnt(0)
    v_mfma_f32_16x16x32_bf16 v[60:63], a[140:143], a[64:67], v[60:63]
    ds_read_b128 a[80:83], v12 offset:6144
    v_mfma_f32_16x16x32_bf16 v[60:63], a[156:159], a[68:71], v[60:63]
    ds_read_b128 a[84:87], v13 offset:6144
    v_mfma_f32_16x16x32_bf16 v[56:59], a[152:155], a[68:71], v[56:59]
    v_mfma_f32_16x16x32_bf16 v[56:59], a[136:139], a[64:67], v[56:59]
    v_mfma_f32_16x16x32_bf16 v[52:55], a[132:135], a[64:67], v[52:55]
    v_mfma_f32_16x16x32_bf16 v[52:55], a[148:151], a[68:71], v[52:55]
    v_mfma_f32_16x16x32_bf16 v[48:51], a[144:147], a[68:71], v[48:51]
    v_mfma_f32_16x16x32_bf16 v[48:51], a[128:131], a[64:67], v[48:51]
    v_mfma_f32_16x16x32_bf16 v[64:67], a[128:131], a[72:75], v[64:67]
    s_waitcnt vmcnt(29)
    s_barrier
    ds_read_b64_tr_b16 a[64:65], v11 offset:36864
    v_mfma_f32_16x16x32_bf16 v[64:67], a[144:147], a[76:79], v[64:67]
    ds_read_b64_tr_b16 a[66:67], v11 offset:38656
    v_mfma_f32_16x16x32_bf16 v[68:71], a[148:151], a[76:79], v[68:71]
    ds_read_b64_tr_b16 a[68:69], v11 offset:44032
    v_mfma_f32_16x16x32_bf16 v[68:71], a[132:135], a[72:75], v[68:71]
    ds_read_b64_tr_b16 a[70:71], v11 offset:45824
    v_mfma_f32_16x16x32_bf16 v[72:75], a[136:139], a[72:75], v[72:75]
    s_add_u32 m0, s63, 110592
    v_mfma_f32_16x16x32_bf16 v[72:75], a[152:155], a[76:79], v[72:75]
    buffer_load_dwordx4 v2, s[8:11], s61 offen offset:0 lds
    v_mfma_f32_16x16x32_bf16 v[76:79], a[156:159], a[76:79], v[76:79]
    v_mfma_f32_16x16x32_bf16 v[76:79], a[140:143], a[72:75], v[76:79]
    s_waitcnt lgkmcnt(0)
    v_mfma_f32_16x16x32_bf16 v[92:95], a[140:143], a[80:83], v[92:95]
    ds_read_b64_tr_b16 a[72:73], v11 offset:51200
    v_mfma_f32_16x16x32_bf16 v[92:95], a[156:159], a[84:87], v[92:95]
    ds_read_b64_tr_b16 a[74:75], v11 offset:52992
    v_mfma_f32_16x16x32_bf16 v[88:91], a[152:155], a[84:87], v[88:91]
    ds_read_b64_tr_b16 a[76:77], v11 offset:58368
    v_mfma_f32_16x16x32_bf16 v[88:91], a[136:139], a[80:83], v[88:91]
    ds_read_b64_tr_b16 a[78:79], v11 offset:60160
    v_mfma_f32_16x16x32_bf16 v[84:87], a[132:135], a[80:83], v[84:87]
    v_mfma_f32_16x16x32_bf16 v[84:87], a[148:151], a[84:87], v[84:87]
    buffer_load_dwordx4 v3, s[8:11], s61 offen offset:1024 lds
    v_mfma_f32_16x16x32_bf16 v[80:83], a[144:147], a[84:87], v[80:83]
    v_mfma_f32_16x16x32_bf16 v[80:83], a[128:131], a[80:83], v[80:83]
    s_mov_b32 s70, 2
L_g1_loop:
    s_waitcnt vmcnt(22)
    v_mfma_f32_16x16x32_bf16 v[96:99], a[64:67], a[160:163], v[96:99]
    ds_read_b64_tr_b16 a[80:81], v11 offset:36896
    v_mfma_f32_16x16x32_bf16 v[96:99], a[68:71], a[176:179], v[96:99]
    ds_read_b64_tr_b16 a[82:83], v11 offset:38688
    v_mfma_f32_16x16x32_bf16 v[100:103], a[68:71], a[180:183], v[100:103]
    ds_read_b64_tr_b16 a[84:85], v11 offset:44064
    v_mfma_f32_16x16x32_bf16 v[100:103], a[64:67], a[164:167], v[100:103]
    ds_read_b64_tr_b16 a[86:87], v11 offset:45856
    v_mfma_f32_16x16x32_bf16 v[104:107], a[64:67], a[168:171], v[104:107]
    v_mfma_f32_16x16x32_bf16 v[104:107], a[68:71], a[184:187], v[104:107]
    buffer_load_dword v31, v23, s[12:15], 0 offen
    v_add_u32 v23, 512, v23
    v_mfma_f32_16x16x32_bf16 v[108:111], a[68:71], a[188:191], v[108:111]
    v_mfma_f32_16x16x32_bf16 v[108:111], a[64:67], a[172:175], v[108:111]
    s_waitcnt lgkmcnt(0)
    v_mfma_f32_16x16x32_bf16 v[124:127], a[72:75], a[172:175], v[124:127]
    ds_read_b64_tr_b16 a[64:65], v11 offset:51232
    v_mfma_f32_16x16x32_bf16 v[124:127], a[76:79], a[188:191], v[124:127]
    ds_read_b64_tr_b16 a[66:67], v11 offset:53024
    v_mfma_f32_16x16x32_bf16 v[120:123], a[76:79], a[184:187], v[120:123]
    ds_read_b64_tr_b16 a[68:69], v11 offset:58400
    v_mfma_f32_16x16x32_bf16 v[120:123], a[72:75], a[168:171], v[120:123]
    ds_read_b64_tr_b16 a[70:71], v11 offset:60192
    v_mfma_f32_16x16x32_bf16 v[116:119], a[72:75], a[164:167], v[116:119]
    v_mfma_f32_16x16x32_bf16 v[116:119], a[76:79], a[180:183], v[116:119]
    buffer_load_dwordx4 v4, s[8:11], s61 offen offset:2048 lds
    v_mfma_f32_16x16x32_bf16 v[112:115], a[76:79], a[176:179], v[112:115]
    v_mfma_f32_16x16x32_bf16 v[112:115], a[72:75], a[160:163], v[112:115]
    v_mfma_f32_16x16x32_bf16 v[128:131], a[80:83], a[160:163], v[128:131]
    ds_read_b64_tr_b16 a[72:73], v11 offset:36928
    v_mfma_f32_16x16x32_bf16 v[128:131], a[84:87], a[176:179], v[128:131]
    ds_read_b64_tr_b16 a[74:75], v11 offset:38720
    v_mfma_f32_16x16x32_bf16 v[132:135], a[84:87], a[180:183], v[132:135]
    ds_read_b64_tr_b16 a[76:77], v11 offset:44096
    v_mfma_f32_16x16x32_bf16 v[132:135], a[80:83], a[164:167], v[132:135]
    ds_read_b64_tr_b16 a[78:79], v11 offset:45888
    v_mfma_f32_16x16x32_bf16 v[136:139], a[80:83], a[168:171], v[136:139]
    v_mfma_f32_16x16x32_bf16 v[136:139], a[84:87], a[184:187], v[136:139]
    buffer_load_dwordx4 v5, s[8:11], s61 offen offset:3072 lds
    v_mfma_f32_16x16x32_bf16 v[140:143], a[84:87], a[188:191], v[140:143]
    v_mfma_f32_16x16x32_bf16 v[140:143], a[80:83], a[172:175], v[140:143]
    s_waitcnt lgkmcnt(0)
    v_mfma_f32_16x16x32_bf16 v[156:159], a[64:67], a[172:175], v[156:159]
    ds_read_b64_tr_b16 a[80:81], v11 offset:51264
    v_mfma_f32_16x16x32_bf16 v[156:159], a[68:71], a[188:191], v[156:159]
    ds_read_b64_tr_b16 a[82:83], v11 offset:53056
    v_mfma_f32_16x16x32_bf16 v[152:155], a[68:71], a[184:187], v[152:155]
    ds_read_b64_tr_b16 a[84:85], v11 offset:58432
    v_mfma_f32_16x16x32_bf16 v[152:155], a[64:67], a[168:171], v[152:155]
    ds_read_b64_tr_b16 a[86:87], v11 offset:60224
    v_mfma_f32_16x16x32_bf16 v[148:151], a[64:67], a[164:167], v[148:151]
    s_add_u32 m0, s63, 114688
    v_mfma_f32_16x16x32_bf16 v[148:151], a[68:71], a[180:183], v[148:151]
    buffer_load_dwordx4 v6, s[8:11], s61 offen offset:0 lds
    v_mfma_f32_16x16x32_bf16 v[144:147], a[68:71], a[176:179], v[144:147]
    v_mfma_f32_16x16x32_bf16 v[144:147], a[64:67], a[160:163], v[144:147]
    v_mfma_f32_16x16x32_bf16 v[160:163], a[72:75], a[160:163], v[160:163]
    ds_read_b64_tr_b16 a[64:65], v11 offset:36960
    v_mfma_f32_16x16x32_bf16 v[160:163], a[76:79], a[176:179], v[160:163]
    ds_read_b64_tr_b16 a[66:67], v11 offset:38752
    v_mfma_f32_16x16x32_bf16 v[164:167], a[76:79], a[180:183], v[164:167]
    ds_read_b64_tr_b16 a[68:69], v11 offset:44128
    v_mfma_f32_16x16x32_bf16 v[164:167], a[72:75], a[164:167], v[164:167]
    ds_read_b64_tr_b16 a[70:71], v11 offset:45920
    v_mfma_f32_16x16x32_bf16 v[168:171], a[72:75], a[168:171], v[168:171]
    v_mfma_f32_16x16x32_bf16 v[168:171], a[76:79], a[184:187], v[168:171]
    buffer_load_dwordx4 v7, s[8:11], s61 offen offset:1024 lds
    v_mfma_f32_16x16x32_bf16 v[172:175], a[76:79], a[188:191], v[172:175]
    v_mfma_f32_16x16x32_bf16 v[172:175], a[72:75], a[172:175], v[172:175]
    s_waitcnt lgkmcnt(0)
    v_mfma_f32_16x16x32_bf16 v[188:191], a[80:83], a[172:175], v[188:191]
    ds_read_b64_tr_b16 a[72:73], v11 offset:51296
    v_mfma_f32_16x16x32_bf16 v[188:191], a[84:87], a[188:191], v[188:191]
    ds_read_b64_tr_b16 a[74:75], v11 offset:53088
    v_mfma_f32_16x16x32_bf16 v[184:187], a[84:87], a[184:187], v[184:187]
    ds_read_b64_tr_b16 a[76:77], v11 offset:58464
    v_mfma_f32_16x16x32_bf16 v[184:187], a[80:83], a[168:171], v[184:187]
    ds_read_b64_tr_b16 a[78:79], v11 offset:60256
    v_mfma_f32_16x16x32_bf16 v[180:183], a[80:83], a[164:167], v[180:183]
    v_mfma_f32_16x16x32_bf16 v[180:183], a[84:87], a[180:183], v[180:183]
    buffer_load_dwordx4 v8, s[8:11], s61 offen offset:2048 lds
    s_add_u32 s61, s61, 458752
    v_mfma_f32_16x16x32_bf16 v[176:179], a[84:87], a[176:179], v[176:179]
    v_mfma_f32_16x16x32_bf16 v[176:179], a[80:83], a[160:163], v[176:179]
    v_mfma_f32_16x16x32_bf16 v[192:195], a[64:67], a[160:163], v[192:195]
    ds_read_b64_tr_b16 a[80:81], v11 offset:36992
    v_mfma_f32_16x16x32_bf16 v[192:195], a[68:71], a[176:179], v[192:195]
    ds_read_b64_tr_b16 a[82:83], v11 offset:38784
    v_mfma_f32_16x16x32_bf16 v[196:199], a[68:71], a[180:183], v[196:199]
    ds_read_b64_tr_b16 a[84:85], v11 offset:44160
    v_mfma_f32_16x16x32_bf16 v[196:199], a[64:67], a[164:167], v[196:199]
    ds_read_b64_tr_b16 a[86:87], v11 offset:45952
    v_mfma_f32_16x16x32_bf16 v[200:203], a[64:67], a[168:171], v[200:203]
    s_add_u32 m0, s64, 110592
    v_mfma_f32_16x16x32_bf16 v[200:203], a[68:71], a[184:187], v[200:203]
    buffer_load_dwordx4 v9, s[12:15], s62 offen offset:0 lds
    v_mfma_f32_16x16x32_bf16 v[204:207], a[68:71], a[188:191], v[204:207]
    v_mfma_f32_16x16x32_bf16 v[204:207], a[64:67], a[172:175], v[204:207]
    s_waitcnt lgkmcnt(0)
    v_mfma_f32_16x16x32_bf16 v[220:223], a[72:75], a[172:175], v[220:223]
    ds_read_b64_tr_b16 a[64:65], v11 offset:51328
    v_mfma_f32_16x16x32_bf16 v[220:223], a[76:79], a[188:191], v[220:223]
    ds_read_b64_tr_b16 a[66:67], v11 offset:53120
    v_mfma_f32_16x16x32_bf16 v[216:219], a[76:79], a[184:187], v[216:219]
    ds_read_b64_tr_b16 a[68:69], v11 offset:58496
    v_mfma_f32_16x16x32_bf16 v[216:219], a[72:75], a[168:171], v[216:219]
    ds_read_b64_tr_b16 a[70:71], v11 offset:60288
    v_mfma_f32_16x16x32_bf16 v[212:215], a[72:75], a[164:167], v[212:215]
    v_mfma_f32_16x16x32_bf16 v[212:215], a[76:79], a[180:183], v[212:215]
    buffer_load_dword v31, v21, s[8:11], 0 offen
    v_add_u32 v21, 458752, v21
    v_mfma_f32_16x16x32_bf16 v[208:211], a[76:79], a[176:179], v[208:211]
    v_mfma_f32_16x16x32_bf16 v[208:211], a[72:75], a[160:163], v[208:211]
    v_mfma_f32_16x16x32_bf16 v[224:227], a[80:83], a[160:163], v[224:227]
    ds_read_b64_tr_b16 a[72:73], v11 offset:37024
    v_mfma_f32_16x16x32_bf16 v[224:227], a[84:87], a[176:179], v[224:227]
    ds_read_b64_tr_b16 a[74:75], v11 offset:38816
    v_mfma_f32_16x16x32_bf16 v[228:231], a[84:87], a[180:183], v[228:231]
    ds_read_b64_tr_b16 a[76:77], v11 offset:44192
    v_mfma_f32_16x16x32_bf16 v[228:231], a[80:83], a[164:167], v[228:231]
    ds_read_b64_tr_b16 a[78:79], v11 offset:45984
L_pad2:
    s_cbranch_execz L_pad6
    v_mfma_f32_16x16x32_bf16 v[232:235], a[80:83], a[168:171], v[232:235]
    v_mfma_f32_16x16x32_bf16 v[232:235], a[84:87], a[184:187], v[232:235]
    buffer_load_dwordx4 v10, s[12:15], s62 offen offset:1024 lds
    s_add_u32 s62, s62, 128
    v_mfma_f32_16x16x32_bf16 v[236:239], a[84:87], a[188:191], v[236:239]
    v_mfma_f32_16x16x32_bf16 v[236:239], a[80:83], a[172:175], v[236:239]
    s_waitcnt lgkmcnt(0)
    v_mfma_f32_16x16x32_bf16 v[252:255], a[64:67], a[172:175], v[252:255]
    ds_read_b64_tr_b16 a[80:81], v11 offset:51360
    v_mfma_f32_16x16x32_bf16 v[252:255], a[68:71], a[188:191], v[252:255]
    ds_read_b64_tr_b16 a[82:83], v11 offset:53152
    v_mfma_f32_16x16x32_bf16 v[248:251], a[68:71], a[184:187], v[248:251]
    ds_read_b64_tr_b16 a[84:85], v11 offset:58528
    v_mfma_f32_16x16x32_bf16 v[248:251], a[64:67], a[168:171], v[248:251]
    ds_read_b64_tr_b16 a[86:87], v11 offset:60320
    v_mfma_f32_16x16x32_bf16 v[244:247], a[64:67], a[164:167], v[244:247]
    v_mfma_f32_16x16x32_bf16 v[244:247], a[68:71], a[180:183], v[244:247]
    buffer_load_dwordx4 a[224:227], v1, s[4:7], s60 offen offset:0 sc1
    v_mfma_f32_16x16x32_bf16 v[240:243], a[68:71], a[176:179], v[240:243]
    v_mfma_f32_16x16x32_bf16 v[240:243], a[64:67], a[160:163], v[240:243]
    v_mfma_f32_16x16x32_bf16 a[0:3], a[72:75], a[160:163], a[0:3]
    ds_read_b64_tr_b16 a[64:65], v11 offset:37056
    v_mfma_f32_16x16x32_bf16 a[0:3], a[76:79], a[176:179], a[0:3]
    ds_read_b64_tr_b16 a[66:67], v11 offset:38848
    v_mfma_f32_16x16x32_bf16 a[4:7], a[76:79], a[180:183], a[4:7]
    ds_read_b64_tr_b16 a[68:69], v11 offset:44224
    v_mfma_f32_16x16x32_bf16 a[4:7], a[72:75], a[164:167], a[4:7]
    ds_read_b64_tr_b16 a[70:71], v11 offset:46016
    v_mfma_f32_16x16x32_bf16 a[8:11], a[72:75], a[168:171], a[8:11]
    v_mfma_f32_16x16x32_bf16 a[8:11], a[76:79], a[184:187], a[8:11]
    buffer_load_dwordx4 a[228:231], v1, s[4:7], s60 offen offset:1024 sc1
    v_mfma_f32_16x16x32_bf16 a[12:15], a[76:79], a[188:191], a[12:15]
    v_mfma_f32_16x16x32_bf16 a[12:15], a[72:75], a[172:175], a[12:15]
    s_waitcnt lgkmcnt(0)
    v_mfma_f32_16x16x32_bf16 a[28:31], a[80:83], a[172:175], a[28:31]
    ds_read_b64_tr_b16 a[72:73], v11 offset:51392
    v_mfma_f32_16x16x32_bf16 a[28:31], a[84:87], a[188:191], a[28:31]
    ds_read_b64_tr_b16 a[74:75], v11 offset:53184
    v_mfma_f32_16x16x32_bf16 a[24:27], a[84:87], a[184:187], a[24:27]
    ds_read_b64_tr_b16 a[76:77], v11 offset:58560
    v_mfma_f32_16x16x32_bf16 a[24:27], a[80:83], a[168:171], a[24:27]
    ds_read_b64_tr_b16 a[78:79], v11 offset:60352
    v_mfma_f32_16x16x32_bf16 a[20:23], a[80:83], a[164:167], a[20:23]
    v_mfma_f32_16x16x32_bf16 a[20:23], a[84:87], a[180:183], a[20:23]
    buffer_load_dwordx4 a[232:235], v1, s[4:7], s60 offen offset:2048 sc1
    v_mfma_f32_16x16x32_bf16 a[16:19], a[84:87], a[176:179], a[16:19]
    v_mfma_f32_16x16x32_bf16 a[16:19], a[80:83], a[160:163], a[16:19]
    v_mfma_f32_16x16x32_bf16 a[32:35], a[64:67], a[160:163], a[32:35]
    ds_read_b128 a[80:83], v12 offset:36864
    v_mfma_f32_16x16x32_bf16 a[32:35], a[68:71], a[176:179], a[32:35]
    ds_read_b128 a[84:87], v13 offset:36864
    v_mfma_f32_16x16x32_bf16 a[36:39], a[68:71], a[180:183], a[36:39]
    v_mfma_f32_16x16x32_bf16 a[36:39], a[64:67], a[164:167], a[36:39]
    v_mfma_f32_16x16x32_bf16 a[40:43], a[64:67], a[168:171], a[40:43]
    v_mfma_f32_16x16x32_bf16 a[40:43], a[68:71], a[184:187], a[40:43]
    buffer_load_dwordx4 a[236:239], v1, s[4:7], s60 offen offset:3072 sc1
    s_add_u32 s60, s60, 4096
    v_mfma_f32_16x16x32_bf16 a[44:47], a[68:71], a[188:191], a[44:47]
    v_mfma_f32_16x16x32_bf16 a[44:47], a[64:67], a[172:175], a[44:47]
    s_waitcnt lgkmcnt(0)
    v_mfma_f32_16x16x32_bf16 a[60:63], a[72:75], a[172:175], a[60:63]
    ds_read_b128 a[64:67], v12 offset:38912
    v_mfma_f32_16x16x32_bf16 a[60:63], a[76:79], a[188:191], a[60:63]
    ds_read_b128 a[68:71], v13 offset:38912
    v_mfma_f32_16x16x32_bf16 a[56:59], a[76:79], a[184:187], a[56:59]
    v_mfma_f32_16x16x32_bf16 a[56:59], a[72:75], a[168:171], a[56:59]
    buffer_load_dwordx4 a[240:243], v1, s[4:7], s60 offen offset:0 sc1
    v_mfma_f32_16x16x32_bf16 a[52:55], a[72:75], a[164:167], a[52:55]
    v_mfma_f32_16x16x32_bf16 a[52:55], a[76:79], a[180:183], a[52:55]
    v_mfma_f32_16x16x32_bf16 a[48:51], a[76:79], a[176:179], a[48:51]
    buffer_load_dwordx4 a[244:247], v1, s[4:7], s60 offen offset:1024 sc1
    v_mfma_f32_16x16x32_bf16 a[48:51], a[72:75], a[160:163], a[48:51]
    v_mfma_f32_16x16x32_bf16 v[32:35], a[160:163], a[80:83], v[32:35]
    ds_read_b128 a[72:75], v12 offset:40960
    v_mfma_f32_16x16x32_bf16 v[32:35], a[176:179], a[84:87], v[32:35]
    ds_read_b128 a[76:79], v13 offset:40960
    v_mfma_f32_16x16x32_bf16 v[36:39], a[180:183], a[84:87], v[36:39]
    v_mfma_f32_16x16x32_bf16 v[36:39], a[164:167], a[80:83], v[36:39]
    buffer_load_dwordx4 a[248:251], v1, s[4:7], s60 offen offset:2048 sc1
    v_mfma_f32_16x16x32_bf16 v[40:43], a[168:171], a[80:83], v[40:43]
    v_mfma_f32_16x16x32_bf16 v[40:43], a[184:187], a[84:87], v[40:43]
    v_mfma_f32_16x16x32_bf16 v[44:47], a[188:191], a[84:87], v[44:47]
    buffer_load_dwordx4 a[252:255], v1, s[4:7], s60 offen offset:3072 sc1
    s_add_u32 s60, s60, 4096
    v_mfma_f32_16x16x32_bf16 v[44:47], a[172:175], a[80:83], v[44:47]
    s_waitcnt lgkmcnt(0)
    v_mfma_f32_16x16x32_bf16 v[60:63], a[172:175], a[64:67], v[60:63]
    ds_read_b128 a[80:83], v12 offset:43008
    v_mfma_f32_16x16x32_bf16 v[60:63], a[188:191], a[68:71], v[60:63]
    ds_read_b128 a[84:87], v13 offset:43008
    v_mfma_f32_16x16x32_bf16 v[56:59], a[184:187], a[68:71], v[56:59]
    v_mfma_f32_16x16x32_bf16 v[56:59], a[168:171], a[64:67], v[56:59]
    v_mfma_f32_16x16x32_bf16 v[52:55], a[164:167], a[64:67], v[52:55]
    v_mfma_f32_16x16x32_bf16 v[52:55], a[180:183], a[68:71], v[52:55]
    buffer_load_dword v31, v20, s[20:23], 0 offen
    v_add_u32 v20, s27, v20
    v_mfma_f32_16x16x32_bf16 v[48:51], a[176:179], a[68:71], v[48:51]
    v_mfma_f32_16x16x32_bf16 v[48:51], a[160:163], a[64:67], v[48:51]
    v_mfma_f32_16x16x32_bf16 v[64:67], a[160:163], a[72:75], v[64:67]
    s_waitcnt vmcnt(30)
    s_barrier
    ds_read_b64_tr_b16 a[64:65], v14 offset:0
    v_mfma_f32_16x16x32_bf16 v[64:67], a[176:179], a[76:79], v[64:67]
    ds_read_b64_tr_b16 a[66:67], v14 offset:1792
    v_mfma_f32_16x16x32_bf16 v[68:71], a[180:183], a[76:79], v[68:71]
    ds_read_b64_tr_b16 a[68:69], v14 offset:7168
    v_mfma_f32_16x16x32_bf16 v[68:71], a[164:167], a[72:75], v[68:71]
    ds_read_b64_tr_b16 a[70:71], v14 offset:8960
    v_mfma_f32_16x16x32_bf16 v[72:75], a[168:171], a[72:75], v[72:75]
    s_add_u32 m0, s63, 0
    v_mfma_f32_16x16x32_bf16 v[72:75], a[184:187], a[76:79], v[72:75]
    buffer_load_dwordx4 v2, s[8:11], s61 offen offset:0 lds
    v_mfma_f32_16x16x32_bf16 v[76:79], a[188:191], a[76:79], v[76:79]
    v_mfma_f32_16x16x32_bf16 v[76:79], a[172:175], a[72:75], v[76:79]
    s_waitcnt lgkmcnt(0)
    v_mfma_f32_16x16x32_bf16 v[92:95], a[172:175], a[80:83], v[92:95]
    ds_read_b64_tr_b16 a[72:73], v14 offset:14336
    v_mfma_f32_16x16x32_bf16 v[92:95], a[188:191], a[84:87], v[92:95]
    ds_read_b64_tr_b16 a[74:75], v14 offset:16128
    v_mfma_f32_16x16x32_bf16 v[88:91], a[184:187], a[84:87], v[88:91]
    ds_read_b64_tr_b16 a[76:77], v14 offset:21504
    v_mfma_f32_16x16x32_bf16 v[88:91], a[168:171], a[80:83], v[88:91]
    ds_read_b64_tr_b16 a[78:79], v14 offset:23296
    v_mfma_f32_16x16x32_bf16 v[84:87], a[164:167], a[80:83], v[84:87]
    v_mfma_f32_16x16x32_bf16 v[84:87], a[180:183], a[84:87], v[84:87]
    buffer_load_dwordx4 v3, s[8:11], s61 offen offset:1024 lds
    v_mfma_f32_16x16x32_bf16 v[80:83], a[176:179], a[84:87], v[80:83]
    v_mfma_f32_16x16x32_bf16 v[80:83], a[160:163], a[80:83], v[80:83]
    s_waitcnt vmcnt(23)
    v_mfma_f32_16x16x32_bf16 v[96:99], a[64:67], a[192:195], v[96:99]
    ds_read_b64_tr_b16 a[80:81], v14 offset:32
    v_mfma_f32_16x16x32_bf16 v[96:99], a[68:71], a[208:211], v[96:99]
    ds_read_b64_tr_b16 a[82:83], v14 offset:1824
    v_mfma_f32_16x16x32_bf16 v[100:103], a[68:71], a[212:215], v[100:103]
    ds_read_b64_tr_b16 a[84:85], v14 offset:7200
    v_mfma_f32_16x16x32_bf16 v[100:103], a[64:67], a[196:199], v[100:103]
    ds_read_b64_tr_b16 a[86:87], v14 offset:8992
    v_mfma_f32_16x16x32_bf16 v[104:107], a[64:67], a[200:203], v[104:107]
    v_mfma_f32_16x16x32_bf16 v[104:107], a[68:71], a[216:219], v[104:107]
    buffer_load_dwordx4 v4, s[8:11], s61 offen offset:2048 lds
    v_mfma_f32_16x16x32_bf16 v[108:111], a[68:71], a[220:223], v[108:111]
    v_mfma_f32_16x16x32_bf16 v[108:111], a[64:67], a[204:207], v[108:111]
    s_waitcnt lgkmcnt(0)
    v_mfma_f32_16x16x32_bf16 v[124:127], a[72:75], a[204:207], v[124:127]
    ds_read_b64_tr_b16 a[64:65], v14 offset:14368
    v_mfma_f32_16x16x32_bf16 v[124:127], a[76:79], a[220:223], v[124:127]
    ds_read_b64_tr_b16 a[66:67], v14 offset:16160
    v_mfma_f32_16x16x32_bf16 v[120:123], a[76:79], a[216:219], v[120:123]
    ds_read_b64_tr_b16 a[68:69], v14 offset:21536
    v_mfma_f32_16x16x32_bf16 v[120:123], a[72:75], a[200:203], v[120:123]
    ds_read_b64_tr_b16 a[70:71], v14 offset:23328
    v_mfma_f32_16x16x32_bf16 v[116:119], a[72:75], a[196:199], v[116:119]
    v_mfma_f32_16x16x32_bf16 v[116:119], a[76:79], a[212:215], v[116:119]
    buffer_load_dwordx4 v5, s[8:11], s61 offen offset:3072 lds
    v_mfma_f32_16x16x32_bf16 v[112:115], a[76:79], a[208:211], v[112:115]
    v_mfma_f32_16x16x32_bf16 v[112:115], a[72:75], a[192:195], v[112:115]
    v_mfma_f32_16x16x32_bf16 v[128:131], a[80:83], a[192:195], v[128:131]
    ds_read_b64_tr_b16 a[72:73], v14 offset:64
    v_mfma_f32_16x16x32_bf16 v[128:131], a[84:87], a[208:211], v[128:131]
    ds_read_b64_tr_b16 a[74:75], v14 offset:1856
    v_mfma_f32_16x16x32_bf16 v[132:135], a[84:87], a[212:215], v[132:135]
    ds_read_b64_tr_b16 a[76:77], v14 offset:7232
    v_mfma_f32_16x16x32_bf16 v[132:135], a[80:83], a[196:199], v[132:135]
    ds_read_b64_tr_b16 a[78:79], v14 offset:9024
    v_mfma_f32_16x16x32_bf16 v[136:139], a[80:83], a[200:203], v[136:139]
    s_add_u32 m0, s63, 4096
    v_mfma_f32_16x16x32_bf16 v[136:139], a[84:87], a[216:219], v[136:139]
    buffer_load_dwordx4 v6, s[8:11], s61 offen offset:0 lds
    v_mfma_f32_16x16x32_bf16 v[140:143], a[84:87], a[220:223], v[140:143]
    v_mfma_f32_16x16x32_bf16 v[140:143], a[80:83], a[204:207], v[140:143]
    s_waitcnt lgkmcnt(0)
    v_mfma_f32_16x16x32_bf16 v[156:159], a[64:67], a[204:207], v[156:159]
    ds_read_b64_tr_b16 a[80:81], v14 offset:14400
    v_mfma_f32_16x16x32_bf16 v[156:159], a[68:71], a[220:223], v[156:159]
    ds_read_b64_tr_b16 a[82:83], v14 offset:16192
    v_mfma_f32_16x16x32_bf16 v[152:155], a[68:71], a[216:219], v[152:155]
    ds_read_b64_tr_b16 a[84:85], v14 offset:21568
    v_mfma_f32_16x16x32_bf16 v[152:155], a[64:67], a[200:203], v[152:155]
    ds_read_b64_tr_b16 a[86:87], v14 offset:23360
    v_mfma_f32_16x16x32_bf16 v[148:151], a[64:67], a[196:199], v[148:151]
    v_mfma_f32_16x16x32_bf16 v[148:151], a[68:71], a[212:215], v[148:151]
    buffer_load_dwordx4 v7, s[8:11], s61 offen offset:1024 lds
    v_mfma_f32_16x16x32_bf16 v[144:147], a[68:71], a[208:211], v[144:147]
    v_mfma_f32_16x16x32_bf16 v[144:147], a[64:67], a[192:195], v[144:147]
    v_mfma_f32_16x16x32_bf16 v[160:163], a[72:75], a[192:195], v[160:163]
    ds_read_b64_tr_b16 a[64:65], v14 offset:96
    v_mfma_f32_16x16x32_bf16 v[160:163], a[76:79], a[208:211], v[160:163]
    ds_read_b64_tr_b16 a[66:67], v14 offset:1888
    v_mfma_f32_16x16x32_bf16 v[164:167], a[76:79], a[212:215], v[164:167]
    ds_read_b64_tr_b16 a[68:69], v14 offset:7264
    v_mfma_f32_16x16x32_bf16 v[164:167], a[72:75], a[196:199], v[164:167]
    ds_read_b64_tr_b16 a[70:71], v14 offset:9056
    v_mfma_f32_16x16x32_bf16 v[168:171], a[72:75], a[200:203], v[168:171]
    v_mfma_f32_16x16x32_bf16 v[168:171], a[76:79], a[216:219], v[168:171]
    buffer_load_dwordx4 v8, s[8:11], s61 offen offset:2048 lds
    s_add_u32 s61, s61, 458752
    v_mfma_f32_16x16x32_bf16 v[172:175], a[76:79], a[220:223], v[172:175]
    v_mfma_f32_16x16x32_bf16 v[172:175], a[72:75], a[204:207], v[172:175]
    s_waitcnt lgkmcnt(0)
    v_mfma_f32_16x16x32_bf16 v[188:191], a[80:83], a[204:207], v[188:191]
    ds_read_b64_tr_b16 a[72:73], v14 offset:14432
    v_mfma_f32_16x16x32_bf16 v[188:191], a[84:87], a[220:223], v[188:191]
    ds_read_b64_tr_b16 a[74:75], v14 offset:16224
    v_mfma_f32_16x16x32_bf16 v[184:187], a[84:87], a[216:219], v[184:187]
    ds_read_b64_tr_b16 a[76:77], v14 offset:21600
    v_mfma_f32_16x16x32_bf16 v[184:187], a[80:83], a[200:203], v[184:187]
    ds_read_b64_tr_b16 a[78:79], v14 offset:23392
    v_mfma_f32_16x16x32_bf16 v[180:183], a[80:83], a[196:199], v[180:183]
    s_add_u32 m0, s64, 0
    v_mfma_f32_16x16x32_bf16 v[180:183], a[84:87], a[212:215], v[180:183]
    buffer_load_dwordx4 v9, s[12:15], s62 offen offset:0 lds
    v_mfma_f32_16x16x32_bf16 v[176:179], a[84:87], a[208:211], v[176:179]
    v_mfma_f32_16x16x32_bf16 v[176:179], a[80:83], a[192:195], v[176:179]
    v_mfma_f32_16x16x32_bf16 v[192:195], a[64:67], a[192:195], v[192:195]
    ds_read_b64_tr_b16 a[80:81], v14 offset:128
    v_mfma_f32_16x16x32_bf16 v[192:195], a[68:71], a[208:211], v[192:195]
    ds_read_b64_tr_b16 a[82:83], v14 offset:1920
    v_mfma_f32_16x16x32_bf16 v[196:199], a[68:71], a[212:215], v[196:199]
    ds_read_b64_tr_b16 a[84:85], v14 offset:7296
    v_mfma_f32_16x16x32_bf16 v[196:199], a[64:67], a[196:199], v[196:199]
    ds_read_b64_tr_b16 a[86:87], v14 offset:9088
    v_mfma_f32_16x16x32_bf16 v[200:203], a[64:67], a[200:203], v[200:203]
    v_mfma_f32_16x16x32_bf16 v[200:203], a[68:71], a[216:219], v[200:203]
    buffer_load_dwordx4 v10, s[12:15], s62 offen offset:1024 lds
    s_add_u32 s62, s62, 128
    v_mfma_f32_16x16x32_bf16 v[204:207], a[68:71], a[220:223], v[204:207]
    v_mfma_f32_16x16x32_bf16 v[204:207], a[64:67], a[204:207], v[204:207]
    s_waitcnt lgkmcnt(0)
    v_mfma_f32_16x16x32_bf16 v[220:223], a[72:75], a[204:207], v[220:223]
    ds_read_b64_tr_b16 a[64:65], v14 offset:14464
    v_mfma_f32_16x16x32_bf16 v[220:223], a[76:79], a[220:223], v[220:223]
    ds_read_b64_tr_b16 a[66:67], v14 offset:16256
    v_mfma_f32_16x16x32_bf16 v[216:219], a[76:79], a[216:219], v[216:219]
    ds_read_b64_tr_b16 a[68:69], v14 offset:21632
    v_mfma_f32_16x16x32_bf16 v[216:219], a[72:75], a[200:203], v[216:219]
    ds_read_b64_tr_b16 a[70:71], v14 offset:23424
    v_mfma_f32_16x16x32_bf16 v[212:215], a[72:75], a[196:199], v[212:215]
    v_mfma_f32_16x16x32_bf16 v[212:215], a[76:79], a[212:215], v[212:215]
    buffer_load_dword v31, v21, s[8:11], 0 offen
    v_add_u32 v21, 458752, v21
    v_mfma_f32_16x16x32_bf16 v[208:211], a[76:79], a[208:211], v[208:211]
    v_mfma_f32_16x16x32_bf16 v[208:211], a[72:75], a[192:195], v[208:211]
    v_mfma_f32_16x16x32_bf16 v[224:227], a[80:83], a[192:195], v[224:227]
    ds_read_b64_tr_b16 a[72:73], v14 offset:160
    v_mfma_f32_16x16x32_bf16 v[224:227], a[84:87], a[208:211], v[224:227]
    ds_read_b64_tr_b16 a[74:75], v14 offset:1952
    v_mfma_f32_16x16x32_bf16 v[228:231], a[84:87], a[212:215], v[228:231]
    ds_read_b64_tr_b16 a[76:77], v14 offset:7328
    v_mfma_f32_16x16x32_bf16 v[228:231], a[80:83], a[196:199], v[228:231]
    ds_read_b64_tr_b16 a[78:79], v14 offset:9120
    v_mfma_f32_16x16x32_bf16 v[232:235], a[80:83], a[200:203], v[232:235]
    v_mfma_f32_16x16x32_bf16 v[232:235], a[84:87], a[216:219], v[232:235]
    buffer_load_dwordx4 a[128:131], v1, s[4:7], s60 offen offset:0 sc1
    v_mfma_f32_16x16x32_bf16 v[236:239], a[84:87], a[220:223], v[236:239]
    v_mfma_f32_16x16x32_bf16 v[236:239], a[80:83], a[204:207], v[236:239]
    s_waitcnt lgkmcnt(0)
    v_mfma_f32_16x16x32_bf16 v[252:255], a[64:67], a[204:207], v[252:255]
    ds_read_b64_tr_b16 a[80:81], v14 offset:14496
    v_mfma_f32_16x16x32_bf16 v[252:255], a[68:71], a[220:223], v[252:255]
    ds_read_b64_tr_b16 a[82:83], v14 offset:16288
    v_mfma_f32_16x16x32_bf16 v[248:251], a[68:71], a[216:219], v[248:251]
    ds_read_b64_tr_b16 a[84:85], v14 offset:21664
    v_mfma_f32_16x16x32_bf16 v[248:251], a[64:67], a[200:203], v[248:251]
    ds_read_b64_tr_b16 a[86:87], v14 offset:23456
    v_mfma_f32_16x16x32_bf16 v[244:247], a[64:67], a[196:199], v[244:247]
    v_mfma_f32_16x16x32_bf16 v[244:247], a[68:71], a[212:215], v[244:247]
    buffer_load_dwordx4 a[132:135], v1, s[4:7], s60 offen offset:1024 sc1
    v_mfma_f32_16x16x32_bf16 v[240:243], a[68:71], a[208:211], v[240:243]
    v_mfma_f32_16x16x32_bf16 v[240:243], a[64:67], a[192:195], v[240:243]
    v_mfma_f32_16x16x32_bf16 a[0:3], a[72:75], a[192:195], a[0:3]
    ds_read_b64_tr_b16 a[64:65], v14 offset:192
    v_mfma_f32_16x16x32_bf16 a[0:3], a[76:79], a[208:211], a[0:3]
    ds_read_b64_tr_b16 a[66:67], v14 offset:1984
    v_mfma_f32_16x16x32_bf16 a[4:7], a[76:79], a[212:215], a[4:7]
    ds_read_b64_tr_b16 a[68:69], v14 offset:7360
    v_mfma_f32_16x16x32_bf16 a[4:7], a[72:75], a[196:199], a[4:7]
    ds_read_b64_tr_b16 a[70:71], v14 offset:9152
    v_mfma_f32_16x16x32_bf16 a[8:11], a[72:75], a[200:203], a[8:11]
    v_mfma_f32_16x16x32_bf16 a[8:11], a[76:79], a[216:219], a[8:11]
    buffer_load_dwordx4 a[136:139], v1, s[4:7], s60 offen offset:2048 sc1
    v_mfma_f32_16x16x32_bf16 a[12:15], a[76:79], a[220:223], a[12:15]
    v_mfma_f32_16x16x32_bf16 a[12:15], a[72:75], a[204:207], a[12:15]
    s_waitcnt lgkmcnt(0)
    v_mfma_f32_16x16x32_bf16 a[28:31], a[80:83], a[204:207], a[28:31]
    ds_read_b64_tr_b16 a[72:73], v14 offset:14528
    v_mfma_f32_16x16x32_bf16 a[28:31], a[84:87], a[220:223], a[28:31]
    ds_read_b64_tr_b16 a[74:75], v14 offset:16320
    v_mfma_f32_16x16x32_bf16 a[24:27], a[84:87], a[216:219], a[24:27]
    ds_read_b64_tr_b16 a[76:77], v14 offset:21696
    v_mfma_f32_16x16x32_bf16 a[24:27], a[80:83], a[200:203], a[24:27]
    ds_read_b64_tr_b16 a[78:79], v14 offset:23488
    v_mfma_f32_16x16x32_bf16 a[20:23], a[80:83], a[196:199], a[20:23]
    v_mfma_f32_16x16x32_bf16 a[20:23], a[84:87], a[212:215], a[20:23]
    buffer_load_dwordx4 a[140:143], v1, s[4:7], s60 offen offset:3072 sc1
    s_add_u32 s60, s60, 4096
    v_mfma_f32_16x16x32_bf16 a[16:19], a[84:87], a[208:211], a[16:19]
    v_mfma_f32_16x16x32_bf16 a[16:19], a[80:83], a[192:195], a[16:19]
    v_mfma_f32_16x16x32_bf16 a[32:35], a[64:67], a[192:195], a[32:35]
    ds_read_b128 a[80:83], v15 offset:0
    v_mfma_f32_16x16x32_bf16 a[32:35], a[68:71], a[208:211], a[32:35]
    ds_read_b128 a[84:87], v16 offset:0
    v_mfma_f32_16x16x32_bf16 a[36:39], a[68:71], a[212:215], a[36:39]
    v_mfma_f32_16x16x32_bf16 a[36:39], a[64:67], a[196:199], a[36:39]
    v_mfma_f32_16x16x32_bf16 a[40:43], a[64:67], a[200:203], a[40:43]
    v_mfma_f32_16x16x32_bf16 a[40:43], a[68:71], a[216:219], a[40:43]
    buffer_load_dwordx4 a[144:147], v1, s[4:7], s60 offen offset:0 sc1
    v_mfma_f32_16x16x32_bf16 a[44:47], a[68:71], a[220:223], a[44:47]
    v_mfma_f32_16x16x32_bf16 a[44:47], a[64:67], a[204:207], a[44:47]
    s_waitcnt lgkmcnt(0)
    v_mfma_f32_16x16x32_bf16 a[60:63], a[72:75], a[204:207], a[60:63]
    ds_read_b128 a[64:67], v15 offset:2048
    v_mfma_f32_16x16x32_bf16 a[60:63], a[76:79], a[220:223], a[60:63]
    ds_read_b128 a[68:71], v16 offset:2048
    v_mfma_f32_16x16x32_bf16 a[56:59], a[76:79], a[216:219], a[56:59]
    v_mfma_f32_16x16x32_bf16 a[56:59], a[72:75], a[200:203], a[56:59]
    buffer_load_dwordx4 a[148:151], v1, s[4:7], s60 offen offset:1024 sc1
    v_mfma_f32_16x16x32_bf16 a[52:55], a[72:75], a[196:199], a[52:55]
    v_mfma_f32_16x16x32_bf16 a[52:55], a[76:79], a[212:215], a[52:55]
    v_mfma_f32_16x16x32_bf16 a[48:51], a[76:79], a[208:211], a[48:51]
    buffer_load_dwordx4 a[152:155], v1, s[4:7], s60 offen offset:2048 sc1
    v_mfma_f32_16x16x32_bf16 a[48:51], a[72:75], a[192:195], a[48:51]
    v_mfma_f32_16x16x32_bf16 v[32:35], a[192:195], a[80:83], v[32:35]
    ds_read_b128 a[72:75], v15 offset:4096
    v_mfma_f32_16x16x32_bf16 v[32:35], a[208:211], a[84:87], v[32:35]
    ds_read_b128 a[76:79], v16 offset:4096
    v_mfma_f32_16x16x32_bf16 v[36:39], a[212:215], a[84:87], v[36:39]
    v_mfma_f32_16x16x32_bf16 v[36:39], a[196:199], a[80:83], v[36:39]
    buffer_load_dwordx4 a[156:159], v1, s[4:7], s60 offen offset:3072 sc1
    s_add_u32 s60, s60, 4096
    v_mfma_f32_16x16x32_bf16 v[40:43], a[200:203], a[80:83], v[40:43]
    v_mfma_f32_16x16x32_bf16 v[40:43], a[216:219], a[84:87], v[40:43]
    v_mfma_f32_16x16x32_bf16 v[44:47], a[220:223], a[84:87], v[44:47]
    buffer_load_dword v31, v20, s[20:23], 0 offen
    v_add_u32 v20, s27, v20
    v_mfma_f32_16x16x32_bf16 v[44:47], a[204:207], a[80:83], v[44:47]
    s_waitcnt lgkmcnt(0)
    v_mfma_f32_16x16x32_bf16 v[60:63], a[204:207], a[64:67], v[60:63]
    ds_read_b128 a[80:83], v15 offset:6144
    v_mfma_f32_16x16x32_bf16 v[60:63], a[220:223], a[68:71], v[60:63]
    ds_read_b128 a[84:87], v16 offset:6144
    v_mfma_f32_16x16x32_bf16 v[56:59], a[216:219], a[68:71], v[56:59]
    v_mfma_f32_16x16x32_bf16 v[56:59], a[200:203], a[64:67], v[56:59]
    v_mfma_f32_16x16x32_bf16 v[52:55], a[196:199], a[64:67], v[52:55]
    v_mfma_f32_16x16x32_bf16 v[52:55], a[212:215], a[68:71], v[52:55]
    v_mfma_f32_16x16x32_bf16 v[48:51], a[208:211], a[68:71], v[48:51]
    v_mfma_f32_16x16x32_bf16 v[48:51], a[192:195], a[64:67], v[48:51]
    v_mfma_f32_16x16x32_bf16 v[64:67], a[192:195], a[72:75], v[64:67]
    s_waitcnt vmcnt(28)
    s_barrier
    ds_read_b64_tr_b16 a[64:65], v14 offset:36864
    v_mfma_f32_16x16x32_bf16 v[64:67], a[208:211], a[76:79], v[64:67]
    ds_read_b64_tr_b16 a[66:67], v14 offset:38656
    v_mfma_f32_16x16x32_bf16 v[68:71], a[212:215], a[76:79], v[68:71]
    ds_read_b64_tr_b16 a[68:69], v14 offset:44032
    v_mfma_f32_16x16x32_bf16 v[68:71], a[196:199], a[72:75], v[68:71]
    ds_read_b64_tr_b16 a[70:71], v14 offset:45824
    v_mfma_f32_16x16x32_bf16 v[72:75], a[200:203], a[72:75], v[72:75]
    s_add_u32 m0, s63, 36864
    v_mfma_f32_16x16x32_bf16 v[72:75], a[216:219], a[76:79], v[72:75]
    buffer_load_dwordx4 v2, s[8:11], s61 offen offset:0 lds
    v_mfma_f32_16x16x32_bf16 v[76:79], a[220:223], a[76:79], v[76:79]
    v_mfma_f32_16x16x32_bf16 v[76:79], a[204:207], a[72:75], v[76:79]
    s_waitcnt lgkmcnt(0)
    v_mfma_f32_16x16x32_bf16 v[92:95], a[204:207], a[80:83], v[92:95]
    ds_read_b64_tr_b16 a[72:73], v14 offset:51200
    v_mfma_f32_16x16x32_bf16 v[92:95], a[220:223], a[84:87], v[92:95]
    ds_read_b64_tr_b16 a[74:75], v14 offset:52992
    v_mfma_f32_16x16x32_bf16 v[88:91], a[216:219], a[84:87], v[88:91]
    ds_read_b64_tr_b16 a[76:77], v14 offset:58368
    v_mfma_f32_16x16x32_bf16 v[88:91], a[200:203], a[80:83], v[88:91]
    ds_read_b64_tr_b16 a[78:79], v14 offset:60160
    v_mfma_f32_16x16x32_bf16 v[84:87], a[196:199], a[80:83], v[84:87]
    v_mfma_f32_16x16x32_bf16 v[84:87], a[212:215], a[84:87], v[84:87]
    buffer_load_dwordx4 v3, s[8:11], s61 offen offset:1024 lds
    v_mfma_f32_16x16x32_bf16 v[80:83], a[208:211], a[84:87], v[80:83]
    v_mfma_f32_16x16x32_bf16 v[80:83], a[192:195], a[80:83], v[80:83]
    s_waitcnt vmcnt(22)
    v_mfma_f32_16x16x32_bf16 v[96:99], a[64:67], a[224:227], v[96:99]
    ds_read_b64_tr_b16 a[80:81], v14 offset:36896
    v_mfma_f32_16x16x32_bf16 v[96:99], a[68:71], a[240:243], v[96:99]
    ds_read_b64_tr_b16 a[82:83], v14 offset:38688
    v_mfma_f32_16x16x32_bf16 v[100:103], a[68:71], a[244:247], v[100:103]
    ds_read_b64_tr_b16 a[84:85], v14 offset:44064
    v_mfma_f32_16x16x32_bf16 v[100:103], a[64:67], a[228:231], v[100:103]
    ds_read_b64_tr_b16 a[86:87], v14 offset:45856
    v_mfma_f32_16x16x32_bf16 v[104:107], a[64:67], a[232:235], v[104:107]
    v_mfma_f32_16x16x32_bf16 v[104:107], a[68:71], a[248:251], v[104:107]
    buffer_load_dwordx4 v4, s[8:11], s61 offen offset:2048 lds
    v_mfma_f32_16x16x32_bf16 v[108:111], a[68:71], a[252:255], v[108:111]
    v_mfma_f32_16x16x32_bf16 v[108:111], a[64:67], a[236:239], v[108:111]
    s_waitcnt lgkmcnt(0)
    v_mfma_f32_16x16x32_bf16 v[124:127], a[72:75], a[236:239], v[124:127]
    ds_read_b64_tr_b16 a[64:65], v14 offset:51232
    v_mfma_f32_16x16x32_bf16 v[124:127], a[76:79], a[252:255], v[124:127]
    ds_read_b64_tr_b16 a[66:67], v14 offset:53024
    v_mfma_f32_16x16x32_bf16 v[120:123], a[76:79], a[248:251], v[120:123]
    ds_read_b64_tr_b16 a[68:69], v14 offset:58400
    v_mfma_f32_16x16x32_bf16 v[120:123], a[72:75], a[232:235], v[120:123]
    ds_read_b64_tr_b16 a[70:71], v14 offset:60192
    v_mfma_f32_16x16x32_bf16 v[116:119], a[72:75], a[228:231], v[116:119]
    v_mfma_f32_16x16x32_bf16 v[116:119], a[76:79], a[244:247], v[116:119]
    buffer_load_dwordx4 v5, s[8:11], s61 offen offset:3072 lds
    v_mfma_f32_16x16x32_bf16 v[112:115], a[76:79], a[240:243], v[112:115]
    v_mfma_f32_16x16x32_bf16 v[112:115], a[72:75], a[224:227], v[112:115]
    v_mfma_f32_16x16x32_bf16 v[128:131], a[80:83], a[224:227], v[128:131]
    ds_read_b64_tr_b16 a[72:73], v14 offset:36928
    v_mfma_f32_16x16x32_bf16 v[128:131], a[84:87], a[240:243], v[128:131]
    ds_read_b64_tr_b16 a[74:75], v14 offset:38720
    v_mfma_f32_16x16x32_bf16 v[132:135], a[84:87], a[244:247], v[132:135]
    ds_read_b64_tr_b16 a[76:77], v14 offset:44096
    v_mfma_f32_16x16x32_bf16 v[132:135], a[80:83], a[228:231], v[132:135]
    ds_read_b64_tr_b16 a[78:79], v14 offset:45888
    v_mfma_f32_16x16x32_bf16 v[136:139], a[80:83], a[232:235], v[136:139]
    s_add_u32 m0, s63, 40960
    v_mfma_f32_16x16x32_bf16 v[136:139], a[84:87], a[248:251], v[136:139]
    buffer_load_dwordx4 v6, s[8:11], s61 offen offset:0 lds
    v_mfma_f32_16x16x32_bf16 v[140:143], a[84:87], a[252:255], v[140:143]
    v_mfma_f32_16x16x32_bf16 v[140:143], a[80:83], a[236:239], v[140:143]
    s_waitcnt lgkmcnt(0)
    v_mfma_f32_16x16x32_bf16 v[156:159], a[64:67], a[236:239], v[156:159]
    ds_read_b64_tr_b16 a[80:81], v14 offset:51264
    v_mfma_f32_16x16x32_bf16 v[156:159], a[68:71], a[252:255], v[156:159]
    ds_read_b64_tr_b16 a[82:83], v14 offset:53056
    v_mfma_f32_16x16x32_bf16 v[152:155], a[68:71], a[248:251], v[152:155]
    ds_read_b64_tr_b16 a[84:85], v14 offset:58432
    v_mfma_f32_16x16x32_bf16 v[152:155], a[64:67], a[232:235], v[152:155]
    ds_read_b64_tr_b16 a[86:87], v14 offset:60224
    v_mfma_f32_16x16x32_bf16 v[148:151], a[64:67], a[228:231], v[148:151]
    v_mfma_f32_16x16x32_bf16 v[148:151], a[68:71], a[244:247], v[148:151]
    buffer_load_dwordx4 v7, s[8:11], s61 offen offset:1024 lds
    v_mfma_f32_16x16x32_bf16 v[144:147], a[68:71], a[240:243], v[144:147]
    v_mfma_f32_16x16x32_bf16 v[144:147], a[64:67], a[224:227], v[144:147]
    v_mfma_f32_16x16x32_bf16 v[160:163], a[72:75], a[224:227], v[160:163]
    ds_read_b64_tr_b16 a[64:65], v14 offset:36960
    v_mfma_f32_16x16x32_bf16 v[160:163], a[76:79], a[240:243], v[160:163]
    ds_read_b64_tr_b16 a[66:67], v14 offset:38752
    v_mfma_f32_16x16x32_bf16 v[164:167], a[76:79], a[244:247], v[164:167]
    ds_read_b64_tr_b16 a[68:69], v14 offset:44128
    v_mfma_f32_16x16x32_bf16 v[164:167], a[72:75], a[228:231], v[164:167]
    ds_read_b64_tr_b16 a[70:71], v14 offset:45920
    v_mfma_f32_16x16x32_bf16 v[168:171], a[72:75], a[232:235], v[168:171]
    v_mfma_f32_16x16x32_bf16 v[168:171], a[76:79], a[248:251], v[168:171]
    buffer_load_dwordx4 v8, s[8:11], s61 offen offset:2048 lds
    s_add_u32 s61, s61, 458752
    v_mfma_f32_16x16x32_bf16 v[172:175], a[76:79], a[252:255], v[172:175]
    v_mfma_f32_16x16x32_bf16 v[172:175], a[72:75], a[236:239], v[172:175]
    s_waitcnt lgkmcnt(0)
    v_mfma_f32_16x16x32_bf16 v[188:191], a[80:83], a[236:239], v[188:191]
    ds_read_b64_tr_b16 a[72:73], v14 offset:51296
    v_mfma_f32_16x16x32_bf16 v[188:191], a[84:87], a[252:255], v[188:191]
    ds_read_b64_tr_b16 a[74:75], v14 offset:53088
    v_mfma_f32_16x16x32_bf16 v[184:187], a[84:87], a[248:251], v[184:187]
    ds_read_b64_tr_b16 a[76:77], v14 offset:58464
    v_mfma_f32_16x16x32_bf16 v[184:187], a[80:83], a[232:235], v[184:187]
    ds_read_b64_tr_b16 a[78:79], v14 offset:60256
    v_mfma_f32_16x16x32_bf16 v[180:183], a[80:83], a[228:231], v[180:183]
    s_add_u32 m0, s64, 36864
    v_mfma_f32_16x16x32_bf16 v[180:183], a[84:87], a[244:247], v[180:183]
    buffer_load_dwordx4 v9, s[12:15], s62 offen offset:0 lds
    v_mfma_f32_16x16x32_bf16 v[176:179], a[84:87], a[240:243], v[176:179]
    v_mfma_f32_16x16x32_bf16 v[176:179], a[80:83], a[224:227], v[176:179]
    v_mfma_f32_16x16x32_bf16 v[192:195], a[64:67], a[224:227], v[192:195]
    ds_read_b64_tr_b16 a[80:81], v14 offset:36992
    v_mfma_f32_16x16x32_bf16 v[192:195], a[68:71], a[240:243], v[192:195]
    ds_read_b64_tr_b16 a[82:83], v14 offset:38784
    v_mfma_f32_16x16x32_bf16 v[196:199], a[68:71], a[244:247], v[196:199]
    ds_read_b64_tr_b16 a[84:85], v14 offset:44160
    v_mfma_f32_16x16x32_bf16 v[196:199], a[64:67], a[228:231], v[196:199]
    ds_read_b64_tr_b16 a[86:87], v14 offset:45952
    v_mfma_f32_16x16x32_bf16 v[200:203], a[64:67], a[232:235], v[200:203]
    v_mfma_f32_16x16x32_bf16 v[200:203], a[68:71], a[248:251], v[200:203]
    buffer_load_dwordx4 v10, s[12:15], s62 offen offset:1024 lds
    s_add_u32 s62, s62, 128
    v_mfma_f32_16x16x32_bf16 v[204:207], a[68:71], a[252:255], v[204:207]
    v_mfma_f32_16x16x32_bf16 v[204:207], a[64:67], a[236:239], v[204:207]
    s_waitcnt lgkmcnt(0)
    v_mfma_f32_16x16x32_bf16 v[220:223], a[72:75], a[236:239], v[220:223]
    ds_read_b64_tr_b16 a[64:65], v14 offset:51328
    v_mfma_f32_16x16x32_bf16 v[220:223], a[76:79], a[252:255], v[220:223]
    ds_read_b64_tr_b16 a[66:67], v14 offset:53120
    v_mfma_f32_16x16x32_bf16 v[216:219], a[76:79], a[248:251], v[216:219]
    ds_read_b64_tr_b16 a[68:69], v14 offset:58496
    v_mfma_f32_16x16x32_bf16 v[216:219], a[72:75], a[232:235], v[216:219]
    ds_read_b64_tr_b16 a[70:71], v14 offset:60288
    v_mfma_f32_16x16x32_bf16 v[212:215], a[72:75], a[228:231], v[212:215]
    v_mfma_f32_16x16x32_bf16 v[212:215], a[76:79], a[244:247], v[212:215]
    buffer_load_dword v31, v21, s[8:11], 0 offen
    v_add_u32 v21, 458752, v21
    v_mfma_f32_16x16x32_bf16 v[208:211], a[76:79], a[240:243], v[208:211]
    v_mfma_f32_16x16x32_bf16 v[208:211], a[72:75], a[224:227], v[208:211]
    v_mfma_f32_16x16x32_bf16 v[224:227], a[80:83], a[224:227], v[224:227]
    ds_read_b64_tr_b16 a[72:73], v14 offset:37024
    v_mfma_f32_16x16x32_bf16 v[224:227], a[84:87], a[240:243], v[224:227]
    ds_read_b64_tr_b16 a[74:75], v14 offset:38816
    v_mfma_f32_16x16x32_bf16 v[228:231], a[84:87], a[244:247], v[228:231]
    ds_read_b64_tr_b16 a[76:77], v14 offset:44192
    v_mfma_f32_16x16x32_bf16 v[228:231], a[80:83], a[228:231], v[228:231]
    ds_read_b64_tr_b16 a[78:79], v14 offset:45984
    v_mfma_f32_16x16x32_bf16 v[232:235], a[80:83], a[232:235], v[232:235]
    v_mfma_f32_16x16x32_bf16 v[232:235], a[84:87], a[248:251], v[232:235]
    buffer_load_dwordx4 a[160:163], v1, s[4:7], s60 offen offset:0 sc1
    v_mfma_f32_16x16x32_bf16 v[236:239], a[84:87], a[252:255], v[236:239]
    v_mfma_f32_16x16x32_bf16 v[236:239], a[80:83], a[236:239], v[236:239]
    s_waitcnt lgkmcnt(0)
    v_mfma_f32_16x16x32_bf16 v[252:255], a[64:67], a[236:239], v[252:255]
    ds_read_b64_tr_b16 a[80:81], v14 offset:51360
    v_mfma_f32_16x16x32_bf16 v[252:255], a[68:71], a[252:255], v[252:255]
    ds_read_b64_tr_b16 a[82:83], v14 offset:53152
    v_mfma_f32_16x16x32_bf16 v[248:251], a[68:71], a[248:251], v[248:251]
    ds_read_b64_tr_b16 a[84:85], v14 offset:58528
    v_mfma_f32_16x16x32_bf16 v[248:251], a[64:67], a[232:235], v[248:251]
    ds_read_b64_tr_b16 a[86:87], v14 offset:60320
    v_mfma_f32_16x16x32_bf16 v[244:247], a[64:67], a[228:231], v[244:247]
    v_mfma_f32_16x16x32_bf16 v[244:247], a[68:71], a[244:247], v[244:247]
    buffer_load_dwordx4 a[164:167], v1, s[4:7], s60 offen offset:1024 sc1
    v_mfma_f32_16x16x32_bf16 v[240:243], a[68:71], a[240:243], v[240:243]
    v_mfma_f32_16x16x32_bf16 v[240:243], a[64:67], a[224:227], v[240:243]
    v_mfma_f32_16x16x32_bf16 a[0:3], a[72:75], a[224:227], a[0:3]
    ds_read_b64_tr_b16 a[64:65], v14 offset:37056
    v_mfma_f32_16x16x32_bf16 a[0:3], a[76:79], a[240:243], a[0:3]
    ds_read_b64_tr_b16 a[66:67], v14 offset:38848
    v_mfma_f32_16x16x32_bf16 a[4:7], a[76:79], a[244:247], a[4:7]
    ds_read_b64_tr_b16 a[68:69], v14 offset:44224
    v_mfma_f32_16x16x32_bf16 a[4:7], a[72:75], a[228:231], a[4:7]
    ds_read_b64_tr_b16 a[70:71], v14 offset:46016
    v_mfma_f32_16x16x32_bf16 a[8:11], a[72:75], a[232:235], a[8:11]
L_pad3:
    s_cbranch_execz L_pad7
    v_mfma_f32_16x16x32_bf16 a[8:11], a[76:79], a[248:251], a[8:11]
    buffer_load_dwordx4 a[168:171], v1, s[4:7], s60 offen offset:2048 sc1
    v_mfma_f32_16x16x32_bf16 a[12:15], a[76:79], a[252:255], a[12:15]
    v_mfma_f32_16x16x32_bf16 a[12:15], a[72:75], a[236:239], a[12:15]
    s_waitcnt lgkmcnt(0)
    v_mfma_f32_16x16x32_bf16 a[28:31], a[80:83], a[236:239], a[28:31]
    ds_read_b64_tr_b16 a[72:73], v14 offset:51392
    v_mfma_f32_16x16x32_bf16 a[28:31], a[84:87], a[252:255], a[28:31]
    ds_read_b64_tr_b16 a[74:75], v14 offset:53184
    v_mfma_f32_16x16x32_bf16 a[24:27], a[84:87], a[248:251], a[24:27]
    ds_read_b64_tr_b16 a[76:77], v14 offset:58560
    v_mfma_f32_16x16x32_bf16 a[24:27], a[80:83], a[232:235], a[24:27]
    ds_read_b64_tr_b16 a[78:79], v14 offset:60352
    v_mfma_f32_16x16x32_bf16 a[20:23], a[80:83], a[228:231], a[20:23]
    v_mfma_f32_16x16x32_bf16 a[20:23], a[84:87], a[244:247], a[20:23]
    buffer_load_dwordx4 a[172:175], v1, s[4:7], s60 offen offset:3072 sc1
    s_add_u32 s60, s60, 4096
    v_mfma_f32_16x16x32_bf16 a[16:19], a[84:87], a[240:243], a[16:19]
    v_mfma_f32_16x16x32_bf16 a[16:19], a[80:83], a[224:227], a[16:19]
    v_mfma_f32_16x16x32_bf16 a[32:35], a[64:67], a[224:227], a[32:35]
    ds_read_b128 a[80:83], v15 offset:36864
    v_mfma_f32_16x16x32_bf16 a[32:35], a[68:71], a[240:243], a[32:35]
    ds_read_b128 a[84:87], v16 offset:36864
    v_mfma_f32_16x16x32_bf16 a[36:39], a[68:71], a[244:247], a[36:39]
    v_mfma_f32_16x16x32_bf16 a[36:39], a[64:67], a[228:231], a[36:39]
    v_mfma_f32_16x16x32_bf16 a[40:43], a[64:67], a[232:235], a[40:43]
    v_mfma_f32_16x16x32_bf16 a[40:43], a[68:71], a[248:251], a[40:43]
    buffer_load_dwordx4 a[176:179], v1, s[4:7], s60 offen offset:0 sc1
    v_mfma_f32_16x16x32_bf16 a[44:47], a[68:71], a[252:255], a[44:47]
    v_mfma_f32_16x16x32_bf16 a[44:47], a[64:67], a[236:239], a[44:47]
    s_waitcnt lgkmcnt(0)
    v_mfma_f32_16x16x32_bf16 a[60:63], a[72:75], a[236:239], a[60:63]
    ds_read_b128 a[64:67], v15 offset:38912
    v_mfma_f32_16x16x32_bf16 a[60:63], a[76:79], a[252:255], a[60:63]
    ds_read_b128 a[68:71], v16 offset:38912
    v_mfma_f32_16x16x32_bf16 a[56:59], a[76:79], a[248:251], a[56:59]
    v_mfma_f32_16x16x32_bf16 a[56:59], a[72:75], a[232:235], a[56:59]
    buffer_load_dwordx4 a[180:183], v1, s[4:7], s60 offen offset:1024 sc1
    v_mfma_f32_16x16x32_bf16 a[52:55], a[72:75], a[228:231], a[52:55]
    v_mfma_f32_16x16x32_bf16 a[52:55], a[76:79], a[244:247], a[52:55]
    v_mfma_f32_16x16x32_bf16 a[48:51], a[76:79], a[240:243], a[48:51]
    buffer_load_dwordx4 a[184:187], v1, s[4:7], s60 offen offset:2048 sc1
    v_mfma_f32_16x16x32_bf16 a[48:51], a[72:75], a[224:227], a[48:51]
    v_mfma_f32_16x16x32_bf16 v[32:35], a[224:227], a[80:83], v[32:35]
    ds_read_b128 a[72:75], v15 offset:40960
    v_mfma_f32_16x16x32_bf16 v[32:35], a[240:243], a[84:87], v[32:35]
    ds_read_b128 a[76:79], v16 offset:40960
    v_mfma_f32_16x16x32_bf16 v[36:39], a[244:247], a[84:87], v[36:39]
    v_mfma_f32_16x16x32_bf16 v[36:39], a[228:231], a[80:83], v[36:39]
    buffer_load_dwordx4 a[188:191], v1, s[4:7], s60 offen offset:3072 sc1
    s_add_u32 s60, s60, 4096
    v_mfma_f32_16x16x32_bf16 v[40:43], a[232:235], a[80:83], v[40:43]
    v_mfma_f32_16x16x32_bf16 v[40:43], a[248:251], a[84:87], v[40:43]
    v_mfma_f32_16x16x32_bf16 v[44:47], a[252:255], a[84:87], v[44:47]
    buffer_load_dword v31, v20, s[20:23], 0 offen
    v_add_u32 v20, s27, v20
    v_mfma_f32_16x16x32_bf16 v[44:47], a[236:239], a[80:83], v[44:47]
    s_waitcnt lgkmcnt(0)
    v_mfma_f32_16x16x32_bf16 v[60:63], a[236:239], a[64:67], v[60:63]
    ds_read_b128 a[80:83], v15 offset:43008
    v_mfma_f32_16x16x32_bf16 v[60:63], a[252:255], a[68:71], v[60:63]
    ds_read_b128 a[84:87], v16 offset:43008
    v_mfma_f32_16x16x32_bf16 v[56:59], a[248:251], a[68:71], v[56:59]
    v_mfma_f32_16x16x32_bf16 v[56:59], a[232:235], a[64:67], v[56:59]
    v_mfma_f32_16x16x32_bf16 v[52:55], a[228:231], a[64:67], v[52:55]
    v_mfma_f32_16x16x32_bf16 v[52:55], a[244:247], a[68:71], v[52:55]
    v_mfma_f32_16x16x32_bf16 v[48:51], a[240:243], a[68:71], v[48:51]
    v_mfma_f32_16x16x32_bf16 v[48:51], a[224:227], a[64:67], v[48:51]
    v_mfma_f32_16x16x32_bf16 v[64:67], a[224:227], a[72:75], v[64:67]
    s_waitcnt vmcnt(29)
    s_barrier
    ds_read_b64_tr_b16 a[64:65], v11 offset:0
    v_mfma_f32_16x16x32_bf16 v[64:67], a[240:243], a[76:79], v[64:67]
    ds_read_b64_tr_b16 a[66:67], v11 offset:1792
    v_mfma_f32_16x16x32_bf16 v[68:71], a[244:247], a[76:79], v[68:71]
    ds_read_b64_tr_b16 a[68:69], v11 offset:7168
    v_mfma_f32_16x16x32_bf16 v[68:71], a[228:231], a[72:75], v[68:71]
    ds_read_b64_tr_b16 a[70:71], v11 offset:8960
    v_mfma_f32_16x16x32_bf16 v[72:75], a[232:235], a[72:75], v[72:75]
    s_add_u32 m0, s63, 73728
    v_mfma_f32_16x16x32_bf16 v[72:75], a[248:251], a[76:79], v[72:75]
    buffer_load_dwordx4 v2, s[8:11], s61 offen offset:0 lds
    v_mfma_f32_16x16x32_bf16 v[76:79], a[252:255], a[76:79], v[76:79]
    v_mfma_f32_16x16x32_bf16 v[76:79], a[236:239], a[72:75], v[76:79]
    s_waitcnt lgkmcnt(0)
    v_mfma_f32_16x16x32_bf16 v[92:95], a[236:239], a[80:83], v[92:95]
    ds_read_b64_tr_b16 a[72:73], v11 offset:14336
    v_mfma_f32_16x16x32_bf16 v[92:95], a[252:255], a[84:87], v[92:95]
    ds_read_b64_tr_b16 a[74:75], v11 offset:16128
    v_mfma_f32_16x16x32_bf16 v[88:91], a[248:251], a[84:87], v[88:91]
    ds_read_b64_tr_b16 a[76:77], v11 offset:21504
    v_mfma_f32_16x16x32_bf16 v[88:91], a[232:235], a[80:83], v[88:91]
    ds_read_b64_tr_b16 a[78:79], v11 offset:23296
    v_mfma_f32_16x16x32_bf16 v[84:87], a[228:231], a[80:83], v[84:87]
    v_mfma_f32_16x16x32_bf16 v[84:87], a[244:247], a[84:87], v[84:87]
    buffer_load_dwordx4 v3, s[8:11], s61 offen offset:1024 lds
    v_mfma_f32_16x16x32_bf16 v[80:83], a[240:243], a[84:87], v[80:83]
    v_mfma_f32_16x16x32_bf16 v[80:83], a[224:227], a[80:83], v[80:83]
    s_waitcnt vmcnt(22)
    v_mfma_f32_16x16x32_bf16 v[96:99], a[64:67], a[128:131], v[96:99]
    ds_read_b64_tr_b16 a[80:81], v11 offset:32
    v_mfma_f32_16x16x32_bf16 v[96:99], a[68:71], a[144:147], v[96:99]
    ds_read_b64_tr_b16 a[82:83], v11 offset:1824
    v_mfma_f32_16x16x32_bf16 v[100:103], a[68:71], a[148:151], v[100:103]
    ds_read_b64_tr_b16 a[84:85], v11 offset:7200
    v_mfma_f32_16x16x32_bf16 v[100:103], a[64:67], a[132:135], v[100:103]
    ds_read_b64_tr_b16 a[86:87], v11 offset:8992
    v_mfma_f32_16x16x32_bf16 v[104:107], a[64:67], a[136:139], v[104:107]
    v_mfma_f32_16x16x32_bf16 v[104:107], a[68:71], a[152:155], v[104:107]
    buffer_load_dwordx4 v4, s[8:11], s61 offen offset:2048 lds
    v_mfma_f32_16x16x32_bf16 v[108:111], a[68:71], a[156:159], v[108:111]
    v_mfma_f32_16x16x32_bf16 v[108:111], a[64:67], a[140:143], v[108:111]
    s_waitcnt lgkmcnt(0)
    v_mfma_f32_16x16x32_bf16 v[124:127], a[72:75], a[140:143], v[124:127]
    ds_read_b64_tr_b16 a[64:65], v11 offset:14368
    v_mfma_f32_16x16x32_bf16 v[124:127], a[76:79], a[156:159], v[124:127]
    ds_read_b64_tr_b16 a[66:67], v11 offset:16160
    v_mfma_f32_16x16x32_bf16 v[120:123], a[76:79], a[152:155], v[120:123]
    ds_read_b64_tr_b16 a[68:69], v11 offset:21536
    v_mfma_f32_16x16x32_bf16 v[120:123], a[72:75], a[136:139], v[120:123]
    ds_read_b64_tr_b16 a[70:71], v11 offset:23328
    v_mfma_f32_16x16x32_bf16 v[116:119], a[72:75], a[132:135], v[116:119]
    v_mfma_f32_16x16x32_bf16 v[116:119], a[76:79], a[148:151], v[116:119]
    buffer_load_dwordx4 v5, s[8:11], s61 offen offset:3072 lds
    v_mfma_f32_16x16x32_bf16 v[112:115], a[76:79], a[144:147], v[112:115]
    v_mfma_f32_16x16x32_bf16 v[112:115], a[72:75], a[128:131], v[112:115]
    v_mfma_f32_16x16x32_bf16 v[128:131], a[80:83], a[128:131], v[128:131]
    ds_read_b64_tr_b16 a[72:73], v11 offset:64
    v_mfma_f32_16x16x32_bf16 v[128:131], a[84:87], a[144:147], v[128:131]
    ds_read_b64_tr_b16 a[74:75], v11 offset:1856
    v_mfma_f32_16x16x32_bf16 v[132:135], a[84:87], a[148:151], v[132:135]
    ds_read_b64_tr_b16 a[76:77], v11 offset:7232
    v_mfma_f32_16x16x32_bf16 v[132:135], a[80:83], a[132:135], v[132:135]
    ds_read_b64_tr_b16 a[78:79], v11 offset:9024
    v_mfma_f32_16x16x32_bf16 v[136:139], a[80:83], a[136:139], v[136:139]
    s_add_u32 m0, s63, 77824
    v_mfma_f32_16x16x32_bf16 v[136:139], a[84:87], a[152:155], v[136:139]
    buffer_load_dwordx4 v6, s[8:11], s61 offen offset:0 lds
    v_mfma_f32_16x16x32_bf16 v[140:143], a[84:87], a[156:159], v[140:143]
    v_mfma_f32_16x16x32_bf16 v[140:143], a[80:83], a[140:143], v[140:143]
    s_waitcnt lgkmcnt(0)
    v_mfma_f32_16x16x32_bf16 v[156:159], a[64:67], a[140:143], v[156:159]
    ds_read_b64_tr_b16 a[80:81], v11 offset:14400
    v_mfma_f32_16x16x32_bf16 v[156:159], a[68:71], a[156:159], v[156:159]
    ds_read_b64_tr_b16 a[82:83], v11 offset:16192
    v_mfma_f32_16x16x32_bf16 v[152:155], a[68:71], a[152:155], v[152:155]
    ds_read_b64_tr_b16 a[84:85], v11 offset:21568
    v_mfma_f32_16x16x32_bf16 v[152:155], a[64:67], a[136:139], v[152:155]
    ds_read_b64_tr_b16 a[86:87], v11 offset:23360
    v_mfma_f32_16x16x32_bf16 v[148:151], a[64:67], a[132:135], v[148:151]
    v_mfma_f32_16x16x32_bf16 v[148:151], a[68:71], a[148:151], v[148:151]
    buffer_load_dwordx4 v7, s[8:11], s61 offen offset:1024 lds
    v_mfma_f32_16x16x32_bf16 v[144:147], a[68:71], a[144:147], v[144:147]
    v_mfma_f32_16x16x32_bf16 v[144:147], a[64:67], a[128:131], v[144:147]
    v_mfma_f32_16x16x32_bf16 v[160:163], a[72:75], a[128:131], v[160:163]
    ds_read_b64_tr_b16 a[64:65], v11 offset:96
    v_mfma_f32_16x16x32_bf16 v[160:163], a[76:79], a[144:147], v[160:163]
    ds_read_b64_tr_b16 a[66:67], v11 offset:1888
    v_mfma_f32_16x16x32_bf16 v[164:167], a[76:79], a[148:151], v[164:167]
    ds_read_b64_tr_b16 a[68:69], v11 offset:7264
    v_mfma_f32_16x16x32_bf16 v[164:167], a[72:75], a[132:135], v[164:167]
    ds_read_b64_tr_b16 a[70:71], v11 offset:9056
    v_mfma_f32_16x16x32_bf16 v[168:171], a[72:75], a[136:139], v[168:171]
    v_mfma_f32_16x16x32_bf16 v[168:171], a[76:79], a[152:155], v[168:171]
    buffer_load_dwordx4 v8, s[8:11], s61 offen offset:2048 lds
    s_add_u32 s61, s61, 458752
    v_mfma_f32_16x16x32_bf16 v[172:175], a[76:79], a[156:159], v[172:175]
    v_mfma_f32_16x16x32_bf16 v[172:175], a[72:75], a[140:143], v[172:175]
    s_waitcnt lgkmcnt(0)
    v_mfma_f32_16x16x32_bf16 v[188:191], a[80:83], a[140:143], v[188:191]
    ds_read_b64_tr_b16 a[72:73], v11 offset:14432
    v_mfma_f32_16x16x32_bf16 v[188:191], a[84:87], a[156:159], v[188:191]
    ds_read_b64_tr_b16 a[74:75], v11 offset:16224
    v_mfma_f32_16x16x32_bf16 v[184:187], a[84:87], a[152:155], v[184:187]
    ds_read_b64_tr_b16 a[76:77], v11 offset:21600
    v_mfma_f32_16x16x32_bf16 v[184:187], a[80:83], a[136:139], v[184:187]
    ds_read_b64_tr_b16 a[78:79], v11 offset:23392
    v_mfma_f32_16x16x32_bf16 v[180:183], a[80:83], a[132:135], v[180:183]
    s_add_u32 m0, s64, 73728
    v_mfma_f32_16x16x32_bf16 v[180:183], a[84:87], a[148:151], v[180:183]
    buffer_load_dwordx4 v9, s[12:15], s62 offen offset:0 lds
    v_mfma_f32_16x16x32_bf16 v[176:179], a[84:87], a[144:147], v[176:179]
    v_mfma_f32_16x16x32_bf16 v[176:179], a[80:83], a[128:131], v[176:179]
    v_mfma_f32_16x16x32_bf16 v[192:195], a[64:67], a[128:131], v[192:195]
    ds_read_b64_tr_b16 a[80:81], v11 offset:128
    v_mfma_f32_16x16x32_bf16 v[192:195], a[68:71], a[144:147], v[192:195]
    ds_read_b64_tr_b16 a[82:83], v11 offset:1920
    v_mfma_f32_16x16x32_bf16 v[196:199], a[68:71], a[148:151], v[196:199]
    ds_read_b64_tr_b16 a[84:85], v11 offset:7296
    v_mfma_f32_16x16x32_bf16 v[196:199], a[64:67], a[132:135], v[196:199]
    ds_read_b64_tr_b16 a[86:87], v11 offset:9088
    v_mfma_f32_16x16x32_bf16 v[200:203], a[64:67], a[136:139], v[200:203]
    v_mfma_f32_16x16x32_bf16 v[200:203], a[68:71], a[152:155], v[200:203]
    buffer_load_dwordx4 v10, s[12:15], s62 offen offset:1024 lds
    s_add_u32 s62, s62, 128
    v_mfma_f32_16x16x32_bf16 v[204:207], a[68:71], a[156:159], v[204:207]
    v_mfma_f32_16x16x32_bf16 v[204:207], a[64:67], a[140:143], v[204:207]
    s_waitcnt lgkmcnt(0)
    v_mfma_f32_16x16x32_bf16 v[220:223], a[72:75], a[140:143], v[220:223]
    ds_read_b64_tr_b16 a[64:65], v11 offset:14464
    v_mfma_f32_16x16x32_bf16 v[220:223], a[76:79], a[156:159], v[220:223]
    ds_read_b64_tr_b16 a[66:67], v11 offset:16256
    v_mfma_f32_16x16x32_bf16 v[216:219], a[76:79], a[152:155], v[216:219]
    ds_read_b64_tr_b16 a[68:69], v11 offset:21632
    v_mfma_f32_16x16x32_bf16 v[216:219], a[72:75], a[136:139], v[216:219]
    ds_read_b64_tr_b16 a[70:71], v11 offset:23424
    v_mfma_f32_16x16x32_bf16 v[212:215], a[72:75], a[132:135], v[212:215]
    v_mfma_f32_16x16x32_bf16 v[212:215], a[76:79], a[148:151], v[212:215]
    buffer_load_dword v31, v21, s[8:11], 0 offen
    v_add_u32 v21, 458752, v21
    v_mfma_f32_16x16x32_bf16 v[208:211], a[76:79], a[144:147], v[208:211]
    v_mfma_f32_16x16x32_bf16 v[208:211], a[72:75], a[128:131], v[208:211]
    v_mfma_f32_16x16x32_bf16 v[224:227], a[80:83], a[128:131], v[224:227]
    ds_read_b64_tr_b16 a[72:73], v11 offset:160
    v_mfma_f32_16x16x32_bf16 v[224:227], a[84:87], a[144:147], v[224:227]
    ds_read_b64_tr_b16 a[74:75], v11 offset:1952
    v_mfma_f32_16x16x32_bf16 v[228:231], a[84:87], a[148:151], v[228:231]
    ds_read_b64_tr_b16 a[76:77], v11 offset:7328
    v_mfma_f32_16x16x32_bf16 v[228:231], a[80:83], a[132:135], v[228:231]
    ds_read_b64_tr_b16 a[78:79], v11 offset:9120
    v_mfma_f32_16x16x32_bf16 v[232:235], a[80:83], a[136:139], v[232:235]
    v_mfma_f32_16x16x32_bf16 v[232:235], a[84:87], a[152:155], v[232:235]
    buffer_load_dwordx4 a[192:195], v1, s[4:7], s60 offen offset:0 sc1
    v_mfma_f32_16x16x32_bf16 v[236:239], a[84:87], a[156:159], v[236:239]
    v_mfma_f32_16x16x32_bf16 v[236:239], a[80:83], a[140:143], v[236:239]
    s_waitcnt lgkmcnt(0)
    v_mfma_f32_16x16x32_bf16 v[252:255], a[64:67], a[140:143], v[252:255]
    ds_read_b64_tr_b16 a[80:81], v11 offset:14496
    v_mfma_f32_16x16x32_bf16 v[252:255], a[68:71], a[156:159], v[252:255]
    ds_read_b64_tr_b16 a[82:83], v11 offset:16288
    v_mfma_f32_16x16x32_bf16 v[248:251], a[68:71], a[152:155], v[248:251]
    ds_read_b64_tr_b16 a[84:85], v11 offset:21664
    v_mfma_f32_16x16x32_bf16 v[248:251], a[64:67], a[136:139], v[248:251]
    ds_read_b64_tr_b16 a[86:87], v11 offset:23456
    v_mfma_f32_16x16x32_bf16 v[244:247], a[64:67], a[132:135], v[244:247]
    v_mfma_f32_16x16x32_bf16 v[244:247], a[68:71], a[148:151], v[244:247]
    buffer_load_dwordx4 a[196:199], v1, s[4:7], s60 offen offset:1024 sc1
    v_mfma_f32_16x16x32_bf16 v[240:243], a[68:71], a[144:147], v[240:243]
    v_mfma_f32_16x16x32_bf16 v[240:243], a[64:67], a[128:131], v[240:243]
    v_mfma_f32_16x16x32_bf16 a[0:3], a[72:75], a[128:131], a[0:3]
    ds_read_b64_tr_b16 a[64:65], v11 offset:192
    v_mfma_f32_16x16x32_bf16 a[0:3], a[76:79], a[144:147], a[0:3]
    ds_read_b64_tr_b16 a[66:67], v11 offset:1984
    v_mfma_f32_16x16x32_bf16 a[4:7], a[76:79], a[148:151], a[4:7]
    ds_read_b64_tr_b16 a[68:69], v11 offset:7360
    v_mfma_f32_16x16x32_bf16 a[4:7], a[72:75], a[132:135], a[4:7]
    ds_read_b64_tr_b16 a[70:71], v11 offset:9152
    v_mfma_f32_16x16x32_bf16 a[8:11], a[72:75], a[136:139], a[8:11]
    v_mfma_f32_16x16x32_bf16 a[8:11], a[76:79], a[152:155], a[8:11]
    buffer_load_dwordx4 a[200:203], v1, s[4:7], s60 offen offset:2048 sc1
    v_mfma_f32_16x16x32_bf16 a[12:15], a[76:79], a[156:159], a[12:15]
    v_mfma_f32_16x16x32_bf16 a[12:15], a[72:75], a[140:143], a[12:15]
    s_waitcnt lgkmcnt(0)
    v_mfma_f32_16x16x32_bf16 a[28:31], a[80:83], a[140:143], a[28:31]
    ds_read_b64_tr_b16 a[72:73], v11 offset:14528
    v_mfma_f32_16x16x32_bf16 a[28:31], a[84:87], a[156:159], a[28:31]
    ds_read_b64_tr_b16 a[74:75], v11 offset:16320
    v_mfma_f32_16x16x32_bf16 a[24:27], a[84:87], a[152:155], a[24:27]
    ds_read_b64_tr_b16 a[76:77], v11 offset:21696
    v_mfma_f32_16x16x32_bf16 a[24:27], a[80:83], a[136:139], a[24:27]
    ds_read_b64_tr_b16 a[78:79], v11 offset:23488
    v_mfma_f32_16x16x32_bf16 a[20:23], a[80:83], a[132:135], a[20:23]
    v_mfma_f32_16x16x32_bf16 a[20:23], a[84:87], a[148:151], a[20:23]
    buffer_load_dwordx4 a[204:207], v1, s[4:7], s60 offen offset:3072 sc1
    s_add_u32 s60, s60, 4096
    v_mfma_f32_16x16x32_bf16 a[16:19], a[84:87], a[144:147], a[16:19]
    v_mfma_f32_16x16x32_bf16 a[16:19], a[80:83], a[128:131], a[16:19]
    v_mfma_f32_16x16x32_bf16 a[32:35], a[64:67], a[128:131], a[32:35]
    ds_read_b128 a[80:83], v12 offset:0
    v_mfma_f32_16x16x32_bf16 a[32:35], a[68:71], a[144:147], a[32:35]
    ds_read_b128 a[84:87], v13 offset:0
    v_mfma_f32_16x16x32_bf16 a[36:39], a[68:71], a[148:151], a[36:39]
    v_mfma_f32_16x16x32_bf16 a[36:39], a[64:67], a[132:135], a[36:39]
    v_mfma_f32_16x16x32_bf16 a[40:43], a[64:67], a[136:139], a[40:43]
    v_mfma_f32_16x16x32_bf16 a[40:43], a[68:71], a[152:155], a[40:43]
    buffer_load_dwordx4 a[208:211], v1, s[4:7], s60 offen offset:0 sc1
    v_mfma_f32_16x16x32_bf16 a[44:47], a[68:71], a[156:159], a[44:47]
    v_mfma_f32_16x16x32_bf16 a[44:47], a[64:67], a[140:143], a[44:47]
    s_waitcnt lgkmcnt(0)
    v_mfma_f32_16x16x32_bf16 a[60:63], a[72:75], a[140:143], a[60:63]
    ds_read_b128 a[64:67], v12 offset:2048
    v_mfma_f32_16x16x32_bf16 a[60:63], a[76:79], a[156:159], a[60:63]
    ds_read_b128 a[68:71], v13 offset:2048
    v_mfma_f32_16x16x32_bf16 a[56:59], a[76:79], a[152:155], a[56:59]
    v_mfma_f32_16x16x32_bf16 a[56:59], a[72:75], a[136:139], a[56:59]
    buffer_load_dwordx4 a[212:215], v1, s[4:7], s60 offen offset:1024 sc1
    v_mfma_f32_16x16x32_bf16 a[52:55], a[72:75], a[132:135], a[52:55]
    v_mfma_f32_16x16x32_bf16 a[52:55], a[76:79], a[148:151], a[52:55]
    v_mfma_f32_16x16x32_bf16 a[48:51], a[76:79], a[144:147], a[48:51]
    buffer_load_dwordx4 a[216:219], v1, s[4:7], s60 offen offset:2048 sc1
    v_mfma_f32_16x16x32_bf16 a[48:51], a[72:75], a[128:131], a[48:51]
    v_mfma_f32_16x16x32_bf16 v[32:35], a[128:131], a[80:83], v[32:35]
    ds_read_b128 a[72:75], v12 offset:4096
    v_mfma_f32_16x16x32_bf16 v[32:35], a[144:147], a[84:87], v[32:35]
    ds_read_b128 a[76:79], v13 offset:4096
    v_mfma_f32_16x16x32_bf16 v[36:39], a[148:151], a[84:87], v[36:39]
    v_mfma_f32_16x16x32_bf16 v[36:39], a[132:135], a[80:83], v[36:39]
    buffer_load_dwordx4 a[220:223], v1, s[4:7], s60 offen offset:3072 sc1
    s_add_u32 s60, s60, 4096
    v_mfma_f32_16x16x32_bf16 v[40:43], a[136:139], a[80:83], v[40:43]
    v_mfma_f32_16x16x32_bf16 v[40:43], a[152:155], a[84:87], v[40:43]
    v_mfma_f32_16x16x32_bf16 v[44:47], a[156:159], a[84:87], v[44:47]
    buffer_load_dword v31, v20, s[20:23], 0 offen
    v_add_u32 v20, s27, v20
    v_mfma_f32_16x16x32_bf16 v[44:47], a[140:143], a[80:83], v[44:47]
    s_waitcnt lgkmcnt(0)
    v_mfma_f32_16x16x32_bf16 v[60:63], a[140:143], a[64:67], v[60:63]
    ds_read_b128 a[80:83], v12 offset:6144
    v_mfma_f32_16x16x32_bf16 v[60:63], a[156:159], a[68:71], v[60:63]
    ds_read_b128 a[84:87], v13 offset:6144
    v_mfma_f32_16x16x32_bf16 v[56:59], a[152:155], a[68:71], v[56:59]
    v_mfma_f32_16x16x32_bf16 v[56:59], a[136:139], a[64:67], v[56:59]
    v_mfma_f32_16x16x32_bf16 v[52:55], a[132:135], a[64:67], v[52:55]
    v_mfma_f32_16x16x32_bf16 v[52:55], a[148:151], a[68:71], v[52:55]
    v_mfma_f32_16x16x32_bf16 v[48:51], a[144:147], a[68:71], v[48:51]
    v_mfma_f32_16x16x32_bf16 v[48:51], a[128:131], a[64:67], v[48:51]
    v_mfma_f32_16x16x32_bf16 v[64:67], a[128:131], a[72:75], v[64:67]
    s_waitcnt vmcnt(29)
    s_barrier
    ds_read_b64_tr_b16 a[64:65], v11 offset:36864
    v_mfma_f32_16x16x32_bf16 v[64:67], a[144:147], a[76:79], v[64:67]
    ds_read_b64_tr_b16 a[66:67], v11 offset:38656
    v_mfma_f32_16x16x32_bf16 v[68:71], a[148:151], a[76:79], v[68:71]
    ds_read_b64_tr_b16 a[68:69], v11 offset:44032
    v_mfma_f32_16x16x32_bf16 v[68:71], a[132:135], a[72:75], v[68:71]
    ds_read_b64_tr_b16 a[70:71], v11 offset:45824
    v_mfma_f32_16x16x32_bf16 v[72:75], a[136:139], a[72:75], v[72:75]
    s_add_u32 m0, s63, 110592
    v_mfma_f32_16x16x32_bf16 v[72:75], a[152:155], a[76:79], v[72:75]
    buffer_load_dwordx4 v2, s[8:11], s61 offen offset:0 lds
    v_mfma_f32_16x16x32_bf16 v[76:79], a[156:159], a[76:79], v[76:79]
    v_mfma_f32_16x16x32_bf16 v[76:79], a[140:143], a[72:75], v[76:79]
    s_waitcnt lgkmcnt(0)
    v_mfma_f32_16x16x32_bf16 v[92:95], a[140:143], a[80:83], v[92:95]
    ds_read_b64_tr_b16 a[72:73], v11 offset:51200
    v_mfma_f32_16x16x32_bf16 v[92:95], a[156:159], a[84:87], v[92:95]
    ds_read_b64_tr_b16 a[74:75], v11 offset:52992
    v_mfma_f32_16x16x32_bf16 v[88:91], a[152:155], a[84:87], v[88:91]
    ds_read_b64_tr_b16 a[76:77], v11 offset:58368
    v_mfma_f32_16x16x32_bf16 v[88:91], a[136:139], a[80:83], v[88:91]
    ds_read_b64_tr_b16 a[78:79], v11 offset:60160
    v_mfma_f32_16x16x32_bf16 v[84:87], a[132:135], a[80:83], v[84:87]
    v_mfma_f32_16x16x32_bf16 v[84:87], a[148:151], a[84:87], v[84:87]
    buffer_load_dwordx4 v3, s[8:11], s61 offen offset:1024 lds
    v_mfma_f32_16x16x32_bf16 v[80:83], a[144:147], a[84:87], v[80:83]
    v_mfma_f32_16x16x32_bf16 v[80:83], a[128:131], a[80:83], v[80:83]
    s_sub_u32 s70, s70, 1
    s_cmp_lg_u32 s70, 0
    s_cbranch_scc1 L_g1_loop
    s_waitcnt vmcnt(22)
    v_mfma_f32_16x16x32_bf16 v[96:99], a[64:67], a[160:163], v[96:99]
    ds_read_b64_tr_b16 a[80:81], v11 offset:36896
    v_mfma_f32_16x16x32_bf16 v[96:99], a[68:71], a[176:179], v[96:99]
    ds_read_b64_tr_b16 a[82:83], v11 offset:38688
    v_mfma_f32_16x16x32_bf16 v[100:103], a[68:71], a[180:183], v[100:103]
    ds_read_b64_tr_b16 a[84:85], v11 offset:44064
    v_mfma_f32_16x16x32_bf16 v[100:103], a[64:67], a[164:167], v[100:103]
    ds_read_b64_tr_b16 a[86:87], v11 offset:45856
    v_mfma_f32_16x16x32_bf16 v[104:107], a[64:67], a[168:171], v[104:107]
    buffer_load_dwordx4 v4, s[8:11], s61 offen offset:2048 lds
    v_mfma_f32_16x16x32_bf16 v[104:107], a[68:71], a[184:187], v[104:107]
    v_mfma_f32_16x16x32_bf16 v[108:111], a[68:71], a[188:191], v[108:111]
    buffer_load_dwordx4 v5, s[8:11], s61 offen offset:3072 lds
    v_mfma_f32_16x16x32_bf16 v[108:111], a[64:67], a[172:175], v[108:111]
    s_waitcnt lgkmcnt(0)
    v_mfma_f32_16x16x32_bf16 v[124:127], a[72:75], a[172:175], v[124:127]
    ds_read_b64_tr_b16 a[64:65], v11 offset:51232
    v_mfma_f32_16x16x32_bf16 v[124:127], a[76:79], a[188:191], v[124:127]
    ds_read_b64_tr_b16 a[66:67], v11 offset:53024
    v_mfma_f32_16x16x32_bf16 v[120:123], a[76:79], a[184:187], v[120:123]
    ds_read_b64_tr_b16 a[68:69], v11 offset:58400
    v_mfma_f32_16x16x32_bf16 v[120:123], a[72:75], a[168:171], v[120:123]
    ds_read_b64_tr_b16 a[70:71], v11 offset:60192
    v_mfma_f32_16x16x32_bf16 v[116:119], a[72:75], a[164:167], v[116:119]
    s_add_u32 m0, s63, 114688
    v_mfma_f32_16x16x32_bf16 v[116:119], a[76:79], a[180:183], v[116:119]
    buffer_load_dwordx4 v6, s[8:11], s61 offen offset:0 lds
    v_mfma_f32_16x16x32_bf16 v[112:115], a[76:79], a[176:179], v[112:115]
    v_mfma_f32_16x16x32_bf16 v[112:115], a[72:75], a[160:163], v[112:115]
    v_mfma_f32_16x16x32_bf16 v[128:131], a[80:83], a[160:163], v[128:131]
    s_waitcnt vmcnt(15)
    s_barrier
    ds_read_b64_tr_b16 a[72:73], v14 offset:0
    v_mfma_f32_16x16x32_bf16 v[128:131], a[84:87], a[176:179], v[128:131]
    ds_read_b64_tr_b16 a[74:75], v14 offset:1792
    v_mfma_f32_16x16x32_bf16 v[132:135], a[84:87], a[180:183], v[132:135]
    ds_read_b64_tr_b16 a[76:77], v14 offset:7168
    v_mfma_f32_16x16x32_bf16 v[132:135], a[80:83], a[164:167], v[132:135]
    ds_read_b64_tr_b16 a[78:79], v14 offset:8960
    v_mfma_f32_16x16x32_bf16 v[136:139], a[80:83], a[168:171], v[136:139]
    buffer_load_dwordx4 v7, s[8:11], s61 offen offset:1024 lds
    v_mfma_f32_16x16x32_bf16 v[136:139], a[84:87], a[184:187], v[136:139]
    v_mfma_f32_16x16x32_bf16 v[140:143], a[84:87], a[188:191], v[140:143]
    buffer_load_dwordx4 v8, s[8:11], s61 offen offset:2048 lds
    s_add_u32 s61, s61, 458752
    v_mfma_f32_16x16x32_bf16 v[140:143], a[80:83], a[172:175], v[140:143]
    s_waitcnt lgkmcnt(0)
    v_mfma_f32_16x16x32_bf16 v[156:159], a[64:67], a[172:175], v[156:159]
    ds_read_b64_tr_b16 a[80:81], v14 offset:14336
    v_mfma_f32_16x16x32_bf16 v[156:159], a[68:71], a[188:191], v[156:159]
    ds_read_b64_tr_b16 a[82:83], v14 offset:16128
    v_mfma_f32_16x16x32_bf16 v[152:155], a[68:71], a[184:187], v[152:155]
    ds_read_b64_tr_b16 a[84:85], v14 offset:21504
    v_mfma_f32_16x16x32_bf16 v[152:155], a[64:67], a[168:171], v[152:155]
    ds_read_b64_tr_b16 a[86:87], v14 offset:23296
    v_mfma_f32_16x16x32_bf16 v[148:151], a[64:67], a[164:167], v[148:151]
    s_add_u32 m0, s64, 110592
    v_mfma_f32_16x16x32_bf16 v[148:151], a[68:71], a[180:183], v[148:151]
    buffer_load_dwordx4 v9, s[12:15], s62 offen offset:0 lds
    v_mfma_f32_16x16x32_bf16 v[144:147], a[68:71], a[176:179], v[144:147]
    v_mfma_f32_16x16x32_bf16 v[144:147], a[64:67], a[160:163], v[144:147]
    s_waitcnt vmcnt(9)
    v_mfma_f32_16x16x32_bf16 v[96:99], a[72:75], a[192:195], v[96:99]
    ds_read_b64_tr_b16 a[64:65], v14 offset:32
    v_mfma_f32_16x16x32_bf16 v[96:99], a[76:79], a[208:211], v[96:99]
    ds_read_b64_tr_b16 a[66:67], v14 offset:1824
    v_mfma_f32_16x16x32_bf16 v[100:103], a[76:79], a[212:215], v[100:103]
    ds_read_b64_tr_b16 a[68:69], v14 offset:7200
    v_mfma_f32_16x16x32_bf16 v[100:103], a[72:75], a[196:199], v[100:103]
    ds_read_b64_tr_b16 a[70:71], v14 offset:8992
    v_mfma_f32_16x16x32_bf16 v[104:107], a[72:75], a[200:203], v[104:107]
    buffer_load_dwordx4 v10, s[12:15], s62 offen offset:1024 lds
    s_add_u32 s62, s62, 128
    v_mfma_f32_16x16x32_bf16 v[104:107], a[76:79], a[216:219], v[104:107]
    v_mfma_f32_16x16x32_bf16 v[108:111], a[76:79], a[220:223], v[108:111]
    buffer_load_dwordx4 a[224:227], v1, s[4:7], s60 offen offset:0 sc1
    v_mfma_f32_16x16x32_bf16 v[108:111], a[72:75], a[204:207], v[108:111]
    s_waitcnt lgkmcnt(0)
    v_mfma_f32_16x16x32_bf16 v[124:127], a[80:83], a[204:207], v[124:127]
    ds_read_b64_tr_b16 a[72:73], v14 offset:14368
    s_mov_b64 s[42:43], s[80:81]
    v_mfma_f32_16x16x32_bf16 v[124:127], a[84:87], a[220:223], v[124:127]
    ds_read_b64_tr_b16 a[74:75], v14 offset:16160
    s_and_b32 s65, s56, 3
    v_mfma_f32_16x16x32_bf16 v[120:123], a[84:87], a[216:219], v[120:123]
    ds_read_b64_tr_b16 a[76:77], v14 offset:21536
    s_xor_b32 s79, s58, s65
    v_mfma_f32_16x16x32_bf16 v[120:123], a[80:83], a[200:203], v[120:123]
    ds_read_b64_tr_b16 a[78:79], v14 offset:23328
    s_lshl_b32 s65, s79, 2
    v_mfma_f32_16x16x32_bf16 v[116:119], a[80:83], a[196:199], v[116:119]
    v_lshrrev_b32 v17, 4, v0
    v_and_b32 v18, 15, v0
    v_mfma_f32_16x16x32_bf16 v[116:119], a[84:87], a[212:215], v[116:119]
    buffer_load_dwordx4 a[228:231], v1, s[4:7], s60 offen offset:1024 sc1
    v_mfma_f32_16x16x32_bf16 v[112:115], a[84:87], a[208:211], v[112:115]
    v_lshlrev_b32 v19, 1, v17
    v_xor_b32 v18, v18, v19
    v_mfma_f32_16x16x32_bf16 v[112:115], a[80:83], a[192:195], v[112:115]
    v_xor_b32 v18, s65, v18
    v_lshlrev_b32 v19, 11, v17
    v_mfma_f32_16x16x32_bf16 v[128:131], a[64:67], a[192:195], v[128:131]
    ds_read_b64_tr_b16 a[80:81], v11 offset:36928
    v_lshl_add_u32 v2, v18, 4, v19
    v_mfma_f32_16x16x32_bf16 v[128:131], a[68:71], a[208:211], v[128:131]
    ds_read_b64_tr_b16 a[82:83], v11 offset:38720
    v_xor_b32 v3, 128, v2
    v_mfma_f32_16x16x32_bf16 v[132:135], a[68:71], a[212:215], v[132:135]
    ds_read_b64_tr_b16 a[84:85], v11 offset:44096
    v_add_u32 v4, 14336, v2
    v_mfma_f32_16x16x32_bf16 v[132:135], a[64:67], a[196:199], v[132:135]
    ds_read_b64_tr_b16 a[86:87], v11 offset:45888
    v_add_u32 v5, 21504, v3
    v_mfma_f32_16x16x32_bf16 v[136:139], a[64:67], a[200:203], v[136:139]
    buffer_load_dwordx4 a[232:235], v1, s[4:7], s60 offen offset:2048 sc1
    v_mfma_f32_16x16x32_bf16 v[136:139], a[68:71], a[216:219], v[136:139]
    v_add_u32 v3, 7168, v3
    s_mul_i32 s61, s58, 1835008
    v_mfma_f32_16x16x32_bf16 v[140:143], a[68:71], a[220:223], v[140:143]
    buffer_load_dwordx4 a[236:239], v1, s[4:7], s60 offen offset:3072 sc1
    s_add_u32 s60, s60, 4096
    v_mfma_f32_16x16x32_bf16 v[140:143], a[64:67], a[204:207], v[140:143]
    s_lshl_b32 s65, s83, 15
    s_add_u32 s61, s61, s65
    s_waitcnt lgkmcnt(0)
    v_mfma_f32_16x16x32_bf16 v[156:159], a[72:75], a[204:207], v[156:159]
    ds_read_b64_tr_b16 a[64:65], v11 offset:51264
    s_lshl_b32 s65, s59, 8
    v_mfma_f32_16x16x32_bf16 v[156:159], a[76:79], a[220:223], v[156:159]
    ds_read_b64_tr_b16 a[66:67], v11 offset:53056
    s_add_u32 s61, s61, s65
    v_mfma_f32_16x16x32_bf16 v[152:155], a[76:79], a[216:219], v[152:155]
    ds_read_b64_tr_b16 a[68:69], v11 offset:58432
    s_and_b32 s14, s56, 3
    v_mfma_f32_16x16x32_bf16 v[152:155], a[72:75], a[200:203], v[152:155]
    ds_read_b64_tr_b16 a[70:71], v11 offset:60224
    s_lshl_b32 s14, s14, 1
    v_mfma_f32_16x16x32_bf16 v[148:151], a[72:75], a[196:199], v[148:151]
    s_xor_b32 s14, s14, s59
    s_and_b32 s14, s14, 0
    v_mfma_f32_16x16x32_bf16 v[148:151], a[76:79], a[212:215], v[148:151]
    buffer_load_dwordx4 a[240:243], v1, s[4:7], s60 offen offset:0 sc1
    s_lshr_b32 s15, s14, 1
    v_mfma_f32_16x16x32_bf16 v[144:147], a[76:79], a[208:211], v[144:147]
    s_xor_b32 s12, s15, s82
    s_xor_b32 s13, s12, 2
    v_mfma_f32_16x16x32_bf16 v[144:147], a[72:75], a[192:195], v[144:147]
    s_mul_i32 s12, s12, 458752
    s_mul_i32 s13, s13, 458752
    v_mfma_f32_16x16x32_bf16 v[160:163], a[80:83], a[160:163], v[160:163]
    ds_read_b64_tr_b16 a[72:73], v11 offset:36960
    s_add_u32 s65, s61, 196608
    v_mfma_f32_16x16x32_bf16 v[160:163], a[84:87], a[176:179], v[160:163]
    ds_read_b64_tr_b16 a[74:75], v11 offset:38752
    s_add_u32 s12, s12, s65
    v_mfma_f32_16x16x32_bf16 v[164:167], a[84:87], a[180:183], v[164:167]
    ds_read_b64_tr_b16 a[76:77], v11 offset:44128
    s_add_u32 s13, s13, s65
    v_mfma_f32_16x16x32_bf16 v[164:167], a[80:83], a[164:167], v[164:167]
    ds_read_b64_tr_b16 a[78:79], v11 offset:45920
    s_xor_b32 s65, s14, s82
    v_mfma_f32_16x16x32_bf16 v[168:171], a[80:83], a[168:171], v[168:171]
    buffer_load_dwordx4 a[244:247], v1, s[4:7], s60 offen offset:1024 sc1
    s_and_b32 s65, s65, 1
    v_mfma_f32_16x16x32_bf16 v[168:171], a[84:87], a[184:187], v[168:171]
    s_lshl_b32 s65, s65, 18
    s_add_u32 s61, s61, s65
    v_mfma_f32_16x16x32_bf16 v[172:175], a[84:87], a[188:191], v[172:175]
    buffer_load_dwordx4 a[248:251], v1, s[4:7], s60 offen offset:2048 sc1
    s_mul_i32 s8, s15, 458752
    v_mfma_f32_16x16x32_bf16 v[172:175], a[80:83], a[172:175], v[172:175]
    s_xor_b32 s9, s15, 1
    s_mul_i32 s9, s9, 458752
    s_waitcnt lgkmcnt(0)
    v_mfma_f32_16x16x32_bf16 v[188:191], a[64:67], a[172:175], v[188:191]
    ds_read_b64_tr_b16 a[80:81], v11 offset:51296
    s_xor_b32 s10, s15, 2
    v_mfma_f32_16x16x32_bf16 v[188:191], a[68:71], a[188:191], v[188:191]
    ds_read_b64_tr_b16 a[82:83], v11 offset:53088
    s_mul_i32 s10, s10, 458752
    v_mfma_f32_16x16x32_bf16 v[184:187], a[68:71], a[184:187], v[184:187]
    ds_read_b64_tr_b16 a[84:85], v11 offset:58464
    s_xor_b32 s11, s15, 3
    v_mfma_f32_16x16x32_bf16 v[184:187], a[64:67], a[168:171], v[184:187]
    ds_read_b64_tr_b16 a[86:87], v11 offset:60256
    s_mul_i32 s11, s11, 458752
    v_mfma_f32_16x16x32_bf16 v[180:183], a[64:67], a[164:167], v[180:183]
    s_add_u32 s8, s8, s61
    s_add_u32 s9, s9, s61
    v_mfma_f32_16x16x32_bf16 v[180:183], a[68:71], a[180:183], v[180:183]
    buffer_load_dwordx4 a[252:255], v1, s[4:7], s60 offen offset:3072 sc1
    s_add_u32 s60, s60, 4096
    v_mfma_f32_16x16x32_bf16 v[176:179], a[68:71], a[176:179], v[176:179]
    s_add_u32 s10, s10, s61
L_pad4:
    s_cbranch_execz L_pad8
    s_add_u32 s11, s11, s61
    v_mfma_f32_16x16x32_bf16 v[176:179], a[64:67], a[160:163], v[176:179]
    s_lshl_b32 s63, s3, 12
    s_xor_b32 s62, s3, s79
    v_mfma_f32_16x16x32_bf16 v[192:195], a[72:75], a[160:163], v[192:195]
    ds_read_b64_tr_b16 a[64:65], v14 offset:64
    s_lshl_b32 s65, s59, 2
    v_mfma_f32_16x16x32_bf16 v[192:195], a[76:79], a[176:179], v[192:195]
    ds_read_b64_tr_b16 a[66:67], v14 offset:1856
    s_add_u32 s62, s62, s65
    v_mfma_f32_16x16x32_bf16 v[196:199], a[76:79], a[180:183], v[196:199]
    ds_read_b64_tr_b16 a[68:69], v14 offset:7232
    s_add_u32 s79, s79, s65
    v_mfma_f32_16x16x32_bf16 v[196:199], a[72:75], a[164:167], v[196:199]
    ds_read_b64_tr_b16 a[70:71], v14 offset:9024
    s_lshl_b32 s62, s62, 16
    v_mfma_f32_16x16x32_bf16 v[200:203], a[72:75], a[168:171], v[200:203]
    buffer_load_dword v22, v26, s[4:7], 0 offen sc1
    s_lshl2_add_u32 s65, s58, s15
    v_mfma_f32_16x16x32_bf16 v[200:203], a[76:79], a[184:187], v[200:203]
    s_lshl_b32 s65, s65, 7
    s_add_u32 s62, s62, s65
    v_mfma_f32_16x16x32_bf16 v[204:207], a[76:79], a[188:191], v[204:207]
    s_mov_b32 s26, 7340032
    s_mov_b32 s27, 0x20000
    v_mfma_f32_16x16x32_bf16 v[204:207], a[72:75], a[172:175], v[204:207]
    s_mov_b32 s30, 2097152
    s_mov_b32 s31, 0x20000
    s_waitcnt lgkmcnt(0)
    v_mfma_f32_16x16x32_bf16 v[220:223], a[80:83], a[172:175], v[220:223]
    ds_read_b64_tr_b16 a[72:73], v14 offset:14400
    s_mov_b32 s34, 2097152
    v_mfma_f32_16x16x32_bf16 v[220:223], a[84:87], a[188:191], v[220:223]
    ds_read_b64_tr_b16 a[74:75], v14 offset:16192
    s_mov_b32 s35, 0x20000
    v_mfma_f32_16x16x32_bf16 v[216:219], a[84:87], a[184:187], v[216:219]
    ds_read_b64_tr_b16 a[76:77], v14 offset:21568
    s_mov_b32 s38, 8388608
    v_mfma_f32_16x16x32_bf16 v[216:219], a[80:83], a[168:171], v[216:219]
    ds_read_b64_tr_b16 a[78:79], v14 offset:23360
    s_mov_b32 s39, 0x20000
    v_mfma_f32_16x16x32_bf16 v[212:215], a[80:83], a[164:167], v[212:215]
    s_mul_i32 s73, s73, 184320
    s_add_u32 s73, s73, 5242880
    v_mfma_f32_16x16x32_bf16 v[212:215], a[84:87], a[180:183], v[212:215]
    s_lshl_b32 s65, s59, 12
    s_add_u32 s20, s73, s65
    v_mfma_f32_16x16x32_bf16 v[208:211], a[84:87], a[176:179], v[208:211]
    s_add_u32 s21, s20, 32768
    s_add_u32 s22, s20, 65536
    v_mfma_f32_16x16x32_bf16 v[208:211], a[80:83], a[160:163], v[208:211]
    s_lshr_b32 s65, s59, 1
    s_lshl_b32 s23, s65, 12
    v_mfma_f32_16x16x32_bf16 v[160:163], a[64:67], a[192:195], v[160:163]
    s_waitcnt vmcnt(9)
    s_barrier
    ds_read_b64_tr_b16 a[80:81], v14 offset:36864
    v_mfma_f32_16x16x32_bf16 v[160:163], a[68:71], a[208:211], v[160:163]
    ds_read_b64_tr_b16 a[82:83], v14 offset:38656
    s_add_u32 s23, s23, s73
    v_mfma_f32_16x16x32_bf16 v[164:167], a[68:71], a[212:215], v[164:167]
    ds_read_b64_tr_b16 a[84:85], v14 offset:44032
    s_and_b32 s70, s59, 1
    v_mfma_f32_16x16x32_bf16 v[164:167], a[64:67], a[196:199], v[164:167]
    ds_read_b64_tr_b16 a[86:87], v14 offset:45824
    s_lshl_b32 s70, s70, 10
    v_mfma_f32_16x16x32_bf16 v[168:171], a[64:67], a[200:203], v[168:171]
    s_add_u32 s23, s23, s70
    s_add_u32 s23, s23, 98304
    v_mfma_f32_16x16x32_bf16 v[168:171], a[68:71], a[216:219], v[168:171]
    s_lshl_b32 s65, s65, 14
    s_lshl2_add_u32 s80, s70, s65
    v_mfma_f32_16x16x32_bf16 v[172:175], a[68:71], a[220:223], v[172:175]
    s_add_u32 s80, s80, s73
    s_add_u32 s80, s80, 114688
    v_mfma_f32_16x16x32_bf16 v[172:175], a[64:67], a[204:207], v[172:175]
    s_mov_b32 s52, 0xbfb8aa3b
    s_mov_b32 s53, 0xbfb8aa3b
    s_waitcnt lgkmcnt(0)
    v_mfma_f32_16x16x32_bf16 v[188:191], a[72:75], a[204:207], v[188:191]
    ds_read_b64_tr_b16 a[64:65], v14 offset:51200
    s_lshl_b32 s54, s79, 6
    v_mfma_f32_16x16x32_bf16 v[188:191], a[76:79], a[220:223], v[188:191]
    ds_read_b64_tr_b16 a[66:67], v14 offset:52992
    s_mul_i32 s81, s72, 135168
    v_mfma_f32_16x16x32_bf16 v[184:187], a[76:79], a[216:219], v[184:187]
    ds_read_b64_tr_b16 a[68:69], v14 offset:58368
    s_lshl_b32 s65, s79, 12
    v_mfma_f32_16x16x32_bf16 v[184:187], a[72:75], a[200:203], v[184:187]
    ds_read_b64_tr_b16 a[70:71], v14 offset:60160
    s_add_u32 s81, s81, s65
    v_mfma_f32_16x16x32_bf16 v[180:183], a[72:75], a[196:199], v[180:183]
    s_lshl_b32 s55, s72, 17
    s_add_u32 s55, s55, s54
    v_mfma_f32_16x16x32_bf16 v[180:183], a[76:79], a[212:215], v[180:183]
    s_lshl_b32 s78, s3, 12
    s_add_u32 s78, s78, 147456
    v_mfma_f32_16x16x32_bf16 v[176:179], a[76:79], a[208:211], v[176:179]
    v_bfe_u32 v18, v0, 2, 2
    v_lshl_add_u32 v18, v17, 4, v18
    v_mfma_f32_16x16x32_bf16 v[176:179], a[72:75], a[192:195], v[176:179]
    v_and_b32 v19, 3, v0
    v_lshlrev_b32 v19, 4, v19
    s_waitcnt vmcnt(1)
    v_mfma_f32_16x16x32_bf16 v[96:99], a[80:83], a[224:227], v[96:99]
    ds_read_b64_tr_b16 a[72:73], v14 offset:36896
    v_lshl_add_u32 v6, v18, 11, v19
    v_mfma_f32_16x16x32_bf16 v[96:99], a[84:87], a[240:243], v[96:99]
    ds_read_b64_tr_b16 a[74:75], v14 offset:38688
    s_add_u32 s70, s73, 114688
    v_mfma_f32_16x16x32_bf16 v[100:103], a[84:87], a[244:247], v[100:103]
    ds_read_b64_tr_b16 a[76:77], v14 offset:44064
    s_lshl_b32 s64, s14, 13
    v_mfma_f32_16x16x32_bf16 v[100:103], a[80:83], a[228:231], v[100:103]
    ds_read_b64_tr_b16 a[78:79], v14 offset:45856
    s_lshl_b32 s15, s15, 12
    v_mfma_f32_16x16x32_bf16 v[104:107], a[80:83], a[232:235], v[104:107]
    s_mov_b64 s[40:41], s[28:29]
    s_bitcmp1_b32 s14, 0
    s_cselect_b64 s[28:29], s[32:33], s[28:29]
    s_cselect_b64 s[32:33], s[40:41], s[32:33]
    s_lshl_b32 s14, s14, 12
    v_mfma_f32_16x16x32_bf16 v[104:107], a[84:87], a[248:251], v[104:107]
    s_mov_b64 s[40:41], s[42:43]
    s_mov_b32 s42, 4194304
    v_mfma_f32_16x16x32_bf16 v[108:111], a[84:87], a[252:255], v[108:111]
    s_mov_b32 s43, 0x20000
    s_lshl_b32 s65, s57, 11
    s_add_u32 s65, s65, 29360128
    s_add_u32 s44, s4, s65
    s_addc_u32 s45, s5, 0
    v_mfma_f32_16x16x32_bf16 v[108:111], a[80:83], a[236:239], v[108:111]
    s_waitcnt lgkmcnt(0)
    v_mfma_f32_16x16x32_bf16 v[124:127], a[64:67], a[236:239], v[124:127]
    ds_read_b64_tr_b16 a[80:81], v14 offset:51232
    v_mfma_f32_16x16x32_bf16 v[124:127], a[68:71], a[252:255], v[124:127]
    ds_read_b64_tr_b16 a[82:83], v14 offset:53024
    v_mfma_f32_16x16x32_bf16 v[120:123], a[68:71], a[248:251], v[120:123]
    ds_read_b64_tr_b16 a[84:85], v14 offset:58400
    v_mfma_f32_16x16x32_bf16 v[120:123], a[64:67], a[232:235], v[120:123]
    ds_read_b64_tr_b16 a[86:87], v14 offset:60192
    v_mfma_f32_16x16x32_bf16 v[116:119], a[64:67], a[228:231], v[116:119]
    v_mfma_f32_16x16x32_bf16 v[116:119], a[68:71], a[244:247], v[116:119]
    v_mfma_f32_16x16x32_bf16 v[112:115], a[68:71], a[240:243], v[112:115]
    v_mfma_f32_16x16x32_bf16 v[112:115], a[64:67], a[224:227], v[112:115]
    v_mfma_f32_16x16x32_bf16 v[128:131], a[72:75], a[224:227], v[128:131]
    ds_read_b64_tr_b16 a[64:65], v14 offset:96
    s_waitcnt vmcnt(0)
    v_mfma_f32_16x16x32_bf16 v[128:131], a[76:79], a[240:243], v[128:131]
    ds_read_b64_tr_b16 a[66:67], v14 offset:1888
    v_cmp_ne_u32 vcc, 1, v22
    s_cbranch_vccnz L_far3
L_back3:
    v_mfma_f32_16x16x32_bf16 v[132:135], a[76:79], a[244:247], v[132:135]
    ds_read_b64_tr_b16 a[68:69], v14 offset:7264
    v_mfma_f32_16x16x32_bf16 v[132:135], a[72:75], a[228:231], v[132:135]
    ds_read_b64_tr_b16 a[70:71], v14 offset:9056
    s_add_u32 m0, s63, 0
    s_add_u32 s61, s8, 0
    v_mfma_f32_16x16x32_bf16 v[136:139], a[72:75], a[232:235], v[136:139]
    buffer_load_dwordx4 v2, s[24:27], s61 offen offset:0 lds
    v_mfma_f32_16x16x32_bf16 v[136:139], a[76:79], a[248:251], v[136:139]
    v_mfma_f32_16x16x32_bf16 v[140:143], a[76:79], a[252:255], v[140:143]
    buffer_load_dwordx4 v3, s[24:27], s61 offen offset:1024 lds
    v_mfma_f32_16x16x32_bf16 v[140:143], a[72:75], a[236:239], v[140:143]
    s_waitcnt lgkmcnt(0)
    v_mfma_f32_16x16x32_bf16 v[156:159], a[80:83], a[236:239], v[156:159]
    ds_read_b64_tr_b16 a[72:73], v14 offset:14432
    v_mfma_f32_16x16x32_bf16 v[156:159], a[84:87], a[252:255], v[156:159]
    ds_read_b64_tr_b16 a[74:75], v14 offset:16224
    v_mfma_f32_16x16x32_bf16 v[152:155], a[84:87], a[248:251], v[152:155]
    ds_read_b64_tr_b16 a[76:77], v14 offset:21600
    v_mfma_f32_16x16x32_bf16 v[152:155], a[80:83], a[232:235], v[152:155]
    ds_read_b64_tr_b16 a[78:79], v14 offset:23392
    v_mfma_f32_16x16x32_bf16 v[148:151], a[80:83], a[228:231], v[148:151]
    v_mfma_f32_16x16x32_bf16 v[148:151], a[84:87], a[244:247], v[148:151]
    buffer_load_dwordx4 v4, s[24:27], s61 offen offset:2048 lds
    v_mfma_f32_16x16x32_bf16 v[144:147], a[84:87], a[240:243], v[144:147]
    v_mfma_f32_16x16x32_bf16 v[144:147], a[80:83], a[224:227], v[144:147]
    v_mfma_f32_16x16x32_bf16 v[192:195], a[64:67], a[192:195], v[192:195]
    ds_read_b64_tr_b16 a[80:81], v14 offset:36928
    v_mfma_f32_16x16x32_bf16 v[192:195], a[68:71], a[208:211], v[192:195]
    ds_read_b64_tr_b16 a[82:83], v14 offset:38720
    v_mfma_f32_16x16x32_bf16 v[196:199], a[68:71], a[212:215], v[196:199]
    ds_read_b64_tr_b16 a[84:85], v14 offset:44096
    v_mfma_f32_16x16x32_bf16 v[196:199], a[64:67], a[196:199], v[196:199]
    ds_read_b64_tr_b16 a[86:87], v14 offset:45888
    v_mfma_f32_16x16x32_bf16 v[200:203], a[64:67], a[200:203], v[200:203]
    buffer_load_dwordx4 v5, s[24:27], s61 offen offset:3072 lds
    v_mfma_f32_16x16x32_bf16 v[200:203], a[68:71], a[216:219], v[200:203]
    s_add_u32 m0, s63, 16384
    s_add_u32 s61, s9, 0
    v_mfma_f32_16x16x32_bf16 v[204:207], a[68:71], a[220:223], v[204:207]
    buffer_load_dwordx4 v2, s[24:27], s61 offen offset:0 lds
    v_mfma_f32_16x16x32_bf16 v[204:207], a[64:67], a[204:207], v[204:207]
    s_waitcnt lgkmcnt(0)
    v_mfma_f32_16x16x32_bf16 v[220:223], a[72:75], a[204:207], v[220:223]
    ds_read_b64_tr_b16 a[64:65], v14 offset:51264
    v_mul_f32 v112, v96, v112
    v_mfma_f32_16x16x32_bf16 v[220:223], a[76:79], a[220:223], v[220:223]
    ds_read_b64_tr_b16 a[66:67], v14 offset:53056
    v_mul_f32 v96, s52, v96
    v_mfma_f32_16x16x32_bf16 v[216:219], a[76:79], a[216:219], v[216:219]
    ds_read_b64_tr_b16 a[68:69], v14 offset:58432
    v_mul_f32 v113, v97, v113
    v_mfma_f32_16x16x32_bf16 v[216:219], a[72:75], a[200:203], v[216:219]
    ds_read_b64_tr_b16 a[70:71], v14 offset:60224
    v_mul_f32 v97, s52, v97
    v_mfma_f32_16x16x32_bf16 v[212:215], a[72:75], a[196:199], v[212:215]
    v_exp_f32 v96, v96
    v_mfma_f32_16x16x32_bf16 v[212:215], a[76:79], a[212:215], v[212:215]
    buffer_load_dwordx4 v3, s[24:27], s61 offen offset:1024 lds
    v_mfma_f32_16x16x32_bf16 v[208:211], a[76:79], a[208:211], v[208:211]
    v_exp_f32 v97, v97
    v_mfma_f32_16x16x32_bf16 v[208:211], a[72:75], a[192:195], v[208:211]
    v_mul_f32 v114, v98, v114
    v_mul_f32 v98, s52, v98
    v_mfma_f32_16x16x32_bf16 v[160:163], a[80:83], a[224:227], v[160:163]
    ds_read_b64_tr_b16 a[72:73], v14 offset:36960
    v_mul_f32 v115, v99, v115
    v_mfma_f32_16x16x32_bf16 v[160:163], a[84:87], a[240:243], v[160:163]
    ds_read_b64_tr_b16 a[74:75], v14 offset:38752
    v_mul_f32 v99, s52, v99
    v_mfma_f32_16x16x32_bf16 v[164:167], a[84:87], a[244:247], v[164:167]
    ds_read_b64_tr_b16 a[76:77], v14 offset:44128
    v_mul_f32 v144, v128, v144
    v_mfma_f32_16x16x32_bf16 v[164:167], a[80:83], a[228:231], v[164:167]
    ds_read_b64_tr_b16 a[78:79], v14 offset:45920
    v_mul_f32 v128, s52, v128
    v_mfma_f32_16x16x32_bf16 v[168:171], a[80:83], a[232:235], v[168:171]
    buffer_load_dwordx4 v4, s[24:27], s61 offen offset:2048 lds
    v_mfma_f32_16x16x32_bf16 v[168:171], a[84:87], a[248:251], v[168:171]
    v_exp_f32 v98, v98
    v_mfma_f32_16x16x32_bf16 v[172:175], a[84:87], a[252:255], v[172:175]
    buffer_load_dwordx4 v5, s[24:27], s61 offen offset:3072 lds
    v_mfma_f32_16x16x32_bf16 v[172:175], a[80:83], a[236:239], v[172:175]
    v_exp_f32 v99, v99
    s_waitcnt lgkmcnt(0)
    v_mfma_f32_16x16x32_bf16 v[188:191], a[64:67], a[236:239], v[188:191]
    ds_read_b64_tr_b16 a[80:81], v14 offset:51296
    v_mul_f32 v145, v129, v145
    v_mfma_f32_16x16x32_bf16 v[188:191], a[68:71], a[252:255], v[188:191]
    ds_read_b64_tr_b16 a[82:83], v14 offset:53088
    v_mul_f32 v129, s52, v129
    v_mfma_f32_16x16x32_bf16 v[184:187], a[68:71], a[248:251], v[184:187]
    ds_read_b64_tr_b16 a[84:85], v14 offset:58464
    v_mul_f32 v146, v130, v146
    v_mfma_f32_16x16x32_bf16 v[184:187], a[64:67], a[232:235], v[184:187]
    ds_read_b64_tr_b16 a[86:87], v14 offset:60256
    v_mul_f32 v130, s52, v130
    v_mfma_f32_16x16x32_bf16 v[180:183], a[64:67], a[228:231], v[180:183]
    s_mov_b32 m0, s78
    v_exp_f32 v128, v128
    v_mfma_f32_16x16x32_bf16 v[180:183], a[68:71], a[244:247], v[180:183]
    buffer_load_dwordx4 v6, s[40:43], s55 offen offset:0 lds
    s_add_u32 s55, s55, 7168
    v_mfma_f32_16x16x32_bf16 v[176:179], a[68:71], a[240:243], v[176:179]
    v_exp_f32 v129, v129
    v_mfma_f32_16x16x32_bf16 v[176:179], a[64:67], a[224:227], v[176:179]
    v_exp_f32 v130, v130
    v_mfma_f32_16x16x32_bf16 v[192:195], a[72:75], a[224:227], v[192:195]
    ds_read_b128 a[64:67], v12 offset:36864
    v_mul_f32 v147, v131, v147
    v_mfma_f32_16x16x32_bf16 v[192:195], a[76:79], a[240:243], v[192:195]
    ds_read_b128 a[68:71], v13 offset:36864
    v_mul_f32 v131, s52, v131
    v_mfma_f32_16x16x32_bf16 v[196:199], a[76:79], a[244:247], v[196:199]
    v_exp_f32 v131, v131
    v_mfma_f32_16x16x32_bf16 v[196:199], a[72:75], a[228:231], v[196:199]
    v_add_f32 v96, 1.0, v96
    v_add_f32 v97, 1.0, v97
    v_mfma_f32_16x16x32_bf16 v[200:203], a[72:75], a[232:235], v[200:203]
    v_rcp_f32 v96, v96
    v_mfma_f32_16x16x32_bf16 v[200:203], a[76:79], a[248:251], v[200:203]
    buffer_load_dwordx4 v6, s[40:43], s55 offen offset:1024 lds
    s_add_u32 s55, s55, 7168
    v_mfma_f32_16x16x32_bf16 v[204:207], a[76:79], a[252:255], v[204:207]
    v_rcp_f32 v97, v97
    v_mfma_f32_16x16x32_bf16 v[204:207], a[72:75], a[236:239], v[204:207]
    v_add_f32 v98, 1.0, v98
    v_add_f32 v99, 1.0, v99
    s_waitcnt lgkmcnt(0)
    v_mfma_f32_16x16x32_bf16 v[220:223], a[80:83], a[236:239], v[220:223]
    ds_read_b128 a[72:75], v12 offset:38912
    v_add_f32 v128, 1.0, v128
    v_mfma_f32_16x16x32_bf16 v[220:223], a[84:87], a[252:255], v[220:223]
    ds_read_b128 a[76:79], v13 offset:38912
    v_add_f32 v129, 1.0, v129
    v_mfma_f32_16x16x32_bf16 v[216:219], a[84:87], a[248:251], v[216:219]
    v_rcp_f32 v98, v98
    v_mfma_f32_16x16x32_bf16 v[216:219], a[80:83], a[232:235], v[216:219]
    v_rcp_f32 v99, v99
    v_mfma_f32_16x16x32_bf16 v[212:215], a[80:83], a[228:231], v[212:215]
    v_rcp_f32 v128, v128
    v_mfma_f32_16x16x32_bf16 v[212:215], a[84:87], a[244:247], v[212:215]
    buffer_load_dwordx4 v6, s[40:43], s55 offen offset:2048 lds
    s_add_u32 s55, s55, 7168
    v_mfma_f32_16x16x32_bf16 v[208:211], a[84:87], a[240:243], v[208:211]
    v_rcp_f32 v129, v129
    v_mfma_f32_16x16x32_bf16 v[208:211], a[80:83], a[224:227], v[208:211]
    v_add_f32 v130, 1.0, v130
    v_add_f32 v131, 1.0, v131
    v_mfma_f32_16x16x32_bf16 v[32:35], a[160:163], a[64:67], v[32:35]
    ds_read_b128 a[80:83], v12 offset:40960
    v_mul_f32 v112, v112, v96
    v_mfma_f32_16x16x32_bf16 v[32:35], a[176:179], a[68:71], v[32:35]
    ds_read_b128 a[84:87], v13 offset:40960
    v_mul_f32 v113, v113, v97
    v_mfma_f32_16x16x32_bf16 v[36:39], a[180:183], a[68:71], v[36:39]
    v_rcp_f32 v130, v130
    v_mfma_f32_16x16x32_bf16 v[36:39], a[164:167], a[64:67], v[36:39]
    v_rcp_f32 v131, v131
    v_mfma_f32_16x16x32_bf16 v[40:43], a[168:171], a[64:67], v[40:43]
    v_mul_f32 v114, v114, v98
    v_mul_f32 v115, v115, v99
    v_mfma_f32_16x16x32_bf16 v[40:43], a[184:187], a[68:71], v[40:43]
    buffer_load_dwordx4 v6, s[40:43], s55 offen offset:3072 lds
    s_add_u32 s55, s55, 7168
    v_mfma_f32_16x16x32_bf16 v[44:47], a[188:191], a[68:71], v[44:47]
    v_mul_f32 v144, v144, v128
    v_mul_f32 v145, v145, v129
    v_mfma_f32_16x16x32_bf16 v[44:47], a[172:175], a[64:67], v[44:47]
    v_mul_f32 v146, v146, v130
    v_mul_f32 v147, v147, v131
    s_waitcnt lgkmcnt(0)
    v_mfma_f32_16x16x32_bf16 v[60:63], a[172:175], a[72:75], v[60:63]
    ds_read_b128 a[64:67], v12 offset:43008
    v_cvt_pk_bf16_f32 v96, v112, v113
    v_mfma_f32_16x16x32_bf16 v[60:63], a[188:191], a[76:79], v[60:63]
    ds_read_b128 a[68:71], v13 offset:43008
    v_cvt_pk_bf16_f32 v97, v114, v115
    v_mfma_f32_16x16x32_bf16 v[56:59], a[184:187], a[76:79], v[56:59]
    v_cvt_pk_bf16_f32 v98, v144, v145
    v_cvt_pk_bf16_f32 v99, v146, v147
    v_mfma_f32_16x16x32_bf16 v[56:59], a[168:171], a[72:75], v[56:59]
    buffer_store_dwordx4 v[96:99], v1, s[4:7], s20 offen offset:0 sc1
    v_mfma_f32_16x16x32_bf16 v[52:55], a[164:167], a[72:75], v[52:55]
    v_mul_f32 v116, v100, v116
    v_mul_f32 v100, s52, v100
    v_mfma_f32_16x16x32_bf16 v[52:55], a[180:183], a[76:79], v[52:55]
    v_exp_f32 v100, v100
    v_mfma_f32_16x16x32_bf16 v[48:51], a[176:179], a[76:79], v[48:51]
    v_mul_f32 v117, v101, v117
    v_mul_f32 v101, s52, v101
    v_mfma_f32_16x16x32_bf16 v[48:51], a[160:163], a[72:75], v[48:51]
    v_exp_f32 v101, v101
    v_mfma_f32_16x16x32_bf16 v[64:67], a[160:163], a[80:83], v[64:67]
    ds_read_b128 a[72:75], v15 offset:0
    v_mul_f32 v118, v102, v118
    v_mfma_f32_16x16x32_bf16 v[64:67], a[176:179], a[84:87], v[64:67]
    ds_read_b128 a[76:79], v16 offset:0
    v_mul_f32 v102, s52, v102
    v_mfma_f32_16x16x32_bf16 v[68:71], a[180:183], a[84:87], v[68:71]
    v_exp_f32 v102, v102
    v_mfma_f32_16x16x32_bf16 v[68:71], a[164:167], a[80:83], v[68:71]
    v_mul_f32 v119, v103, v119
    v_mul_f32 v103, s52, v103
    v_mfma_f32_16x16x32_bf16 v[72:75], a[168:171], a[80:83], v[72:75]
    v_exp_f32 v103, v103
    v_mfma_f32_16x16x32_bf16 v[72:75], a[184:187], a[84:87], v[72:75]
    v_mul_f32 v148, v132, v148
    v_mul_f32 v132, s52, v132
    v_mfma_f32_16x16x32_bf16 v[76:79], a[188:191], a[84:87], v[76:79]
    v_exp_f32 v132, v132
    v_mfma_f32_16x16x32_bf16 v[76:79], a[172:175], a[80:83], v[76:79]
    v_mul_f32 v149, v133, v149
    v_mul_f32 v133, s52, v133
    s_waitcnt lgkmcnt(0)
    v_mfma_f32_16x16x32_bf16 v[92:95], a[172:175], a[64:67], v[92:95]
    ds_read_b128 a[80:83], v15 offset:2048
    v_mul_f32 v150, v134, v150
    v_mfma_f32_16x16x32_bf16 v[92:95], a[188:191], a[68:71], v[92:95]
    ds_read_b128 a[84:87], v16 offset:2048
    v_mul_f32 v134, s52, v134
    v_mfma_f32_16x16x32_bf16 v[88:91], a[184:187], a[68:71], v[88:91]
    v_exp_f32 v133, v133
    v_mfma_f32_16x16x32_bf16 v[88:91], a[168:171], a[64:67], v[88:91]
    v_exp_f32 v134, v134
    v_mfma_f32_16x16x32_bf16 v[84:87], a[164:167], a[64:67], v[84:87]
    v_mul_f32 v151, v135, v151
    v_mul_f32 v135, s52, v135
    v_mfma_f32_16x16x32_bf16 v[84:87], a[180:183], a[68:71], v[84:87]
    v_exp_f32 v135, v135
    v_mfma_f32_16x16x32_bf16 v[80:83], a[176:179], a[68:71], v[80:83]
    v_add_f32 v100, 1.0, v100
    v_add_f32 v101, 1.0, v101
    v_mfma_f32_16x16x32_bf16 v[80:83], a[160:163], a[64:67], v[80:83]
    v_rcp_f32 v100, v100
    v_mfma_f32_16x16x32_bf16 v[32:35], a[192:195], a[72:75], v[32:35]
    ds_read_b128 a[64:67], v15 offset:4096
    v_add_f32 v102, 1.0, v102
    v_mfma_f32_16x16x32_bf16 v[32:35], a[208:211], a[76:79], v[32:35]
    ds_read_b128 a[68:71], v16 offset:4096
    v_add_f32 v103, 1.0, v103
    v_mfma_f32_16x16x32_bf16 v[36:39], a[212:215], a[76:79], v[36:39]
    v_rcp_f32 v101, v101
    v_mfma_f32_16x16x32_bf16 v[36:39], a[196:199], a[72:75], v[36:39]
    v_rcp_f32 v102, v102
    v_mfma_f32_16x16x32_bf16 v[40:43], a[200:203], a[72:75], v[40:43]
    v_rcp_f32 v103, v103
    v_mfma_f32_16x16x32_bf16 v[40:43], a[216:219], a[76:79], v[40:43]
    v_add_f32 v132, 1.0, v132
    v_add_f32 v133, 1.0, v133
    v_mfma_f32_16x16x32_bf16 v[44:47], a[220:223], a[76:79], v[44:47]
    v_rcp_f32 v132, v132
    v_mfma_f32_16x16x32_bf16 v[44:47], a[204:207], a[72:75], v[44:47]
    v_rcp_f32 v133, v133
    s_waitcnt lgkmcnt(0)
    v_mfma_f32_16x16x32_bf16 v[60:63], a[204:207], a[80:83], v[60:63]
    ds_read_b128 a[72:75], v15 offset:6144
    v_add_f32 v134, 1.0, v134
    v_mfma_f32_16x16x32_bf16 v[60:63], a[220:223], a[84:87], v[60:63]
    ds_read_b128 a[76:79], v16 offset:6144
    v_add_f32 v135, 1.0, v135
    v_mfma_f32_16x16x32_bf16 v[56:59], a[216:219], a[84:87], v[56:59]
    v_rcp_f32 v134, v134
    v_mfma_f32_16x16x32_bf16 v[56:59], a[200:203], a[80:83], v[56:59]
    v_rcp_f32 v135, v135
    v_mfma_f32_16x16x32_bf16 v[52:55], a[196:199], a[80:83], v[52:55]
    v_mul_f32 v116, v116, v100
    v_mul_f32 v117, v117, v101
    v_mfma_f32_16x16x32_bf16 v[52:55], a[212:215], a[84:87], v[52:55]
    v_mul_f32 v118, v118, v102
    v_mul_f32 v119, v119, v103
    v_mfma_f32_16x16x32_bf16 v[48:51], a[208:211], a[84:87], v[48:51]
    v_mul_f32 v148, v148, v132
    v_mul_f32 v149, v149, v133
    v_mfma_f32_16x16x32_bf16 v[48:51], a[192:195], a[80:83], v[48:51]
    v_mul_f32 v150, v150, v134
    v_mul_f32 v151, v151, v135
    v_mfma_f32_16x16x32_bf16 v[64:67], a[192:195], a[64:67], v[64:67]
    ds_read_b128 a[80:83], v15 offset:36864
    v_cvt_pk_bf16_f32 v100, v116, v117
    v_mfma_f32_16x16x32_bf16 v[64:67], a[208:211], a[68:71], v[64:67]
    ds_read_b128 a[84:87], v16 offset:36864
    v_cvt_pk_bf16_f32 v101, v118, v119
    v_mfma_f32_16x16x32_bf16 v[68:71], a[212:215], a[68:71], v[68:71]
    v_cvt_pk_bf16_f32 v102, v148, v149
    v_cvt_pk_bf16_f32 v103, v150, v151
    v_mfma_f32_16x16x32_bf16 v[68:71], a[196:199], a[64:67], v[68:71]
    buffer_store_dwordx4 v[100:103], v1, s[4:7], s20 offen offset:1024 sc1
    v_mfma_f32_16x16x32_bf16 v[72:75], a[200:203], a[64:67], v[72:75]
    v_mul_f32 v120, v104, v120
    v_mul_f32 v104, s52, v104
    v_mfma_f32_16x16x32_bf16 v[72:75], a[216:219], a[68:71], v[72:75]
    v_exp_f32 v104, v104
    v_mfma_f32_16x16x32_bf16 v[76:79], a[220:223], a[68:71], v[76:79]
    v_mul_f32 v121, v105, v121
    v_mul_f32 v105, s52, v105
    v_mfma_f32_16x16x32_bf16 v[76:79], a[204:207], a[64:67], v[76:79]
    v_exp_f32 v105, v105
    s_waitcnt lgkmcnt(0)
    v_mfma_f32_16x16x32_bf16 v[92:95], a[204:207], a[72:75], v[92:95]
    ds_read_b128 a[64:67], v15 offset:38912
    v_mul_f32 v122, v106, v122
    v_mfma_f32_16x16x32_bf16 v[92:95], a[220:223], a[76:79], v[92:95]
    ds_read_b128 a[68:71], v16 offset:38912
    v_mul_f32 v106, s52, v106
    v_mfma_f32_16x16x32_bf16 v[88:91], a[216:219], a[76:79], v[88:91]
    v_exp_f32 v106, v106
    v_mfma_f32_16x16x32_bf16 v[88:91], a[200:203], a[72:75], v[88:91]
    v_mul_f32 v123, v107, v123
    v_mul_f32 v107, s52, v107
    v_mfma_f32_16x16x32_bf16 v[84:87], a[196:199], a[72:75], v[84:87]
    v_exp_f32 v107, v107
    v_mfma_f32_16x16x32_bf16 v[84:87], a[212:215], a[76:79], v[84:87]
    v_mul_f32 v152, v136, v152
    v_mul_f32 v136, s52, v136
    v_mfma_f32_16x16x32_bf16 v[80:83], a[208:211], a[76:79], v[80:83]
    v_exp_f32 v136, v136
    v_mfma_f32_16x16x32_bf16 v[80:83], a[192:195], a[72:75], v[80:83]
    v_mul_f32 v153, v137, v153
    v_mul_f32 v137, s52, v137
    v_mfma_f32_16x16x32_bf16 v[32:35], a[224:227], a[80:83], v[32:35]
    ds_read_b128 a[72:75], v15 offset:40960
    v_mul_f32 v154, v138, v154
    v_mfma_f32_16x16x32_bf16 v[32:35], a[240:243], a[84:87], v[32:35]
    ds_read_b128 a[76:79], v16 offset:40960
    v_mul_f32 v138, s52, v138
    v_mfma_f32_16x16x32_bf16 v[36:39], a[244:247], a[84:87], v[36:39]
    v_exp_f32 v137, v137
    v_mfma_f32_16x16x32_bf16 v[36:39], a[228:231], a[80:83], v[36:39]
    v_exp_f32 v138, v138
    v_mfma_f32_16x16x32_bf16 v[40:43], a[232:235], a[80:83], v[40:43]
    v_mul_f32 v155, v139, v155
    v_mul_f32 v139, s52, v139
    v_mfma_f32_16x16x32_bf16 v[40:43], a[248:251], a[84:87], v[40:43]
    v_exp_f32 v139, v139
    v_mfma_f32_16x16x32_bf16 v[44:47], a[252:255], a[84:87], v[44:47]
    v_add_f32 v104, 1.0, v104
    v_add_f32 v105, 1.0, v105
    v_mfma_f32_16x16x32_bf16 v[44:47], a[236:239], a[80:83], v[44:47]
    v_rcp_f32 v104, v104
    s_waitcnt lgkmcnt(0)
    v_mfma_f32_16x16x32_bf16 v[60:63], a[236:239], a[64:67], v[60:63]
    ds_read_b128 a[80:83], v15 offset:43008
    v_add_f32 v106, 1.0, v106
    v_mfma_f32_16x16x32_bf16 v[60:63], a[252:255], a[68:71], v[60:63]
    ds_read_b128 a[84:87], v16 offset:43008
    v_add_f32 v107, 1.0, v107
    v_mfma_f32_16x16x32_bf16 v[56:59], a[248:251], a[68:71], v[56:59]
    v_rcp_f32 v105, v105
    v_mfma_f32_16x16x32_bf16 v[56:59], a[232:235], a[64:67], v[56:59]
    v_rcp_f32 v106, v106
    v_mfma_f32_16x16x32_bf16 v[52:55], a[228:231], a[64:67], v[52:55]
    v_rcp_f32 v107, v107
    v_mfma_f32_16x16x32_bf16 v[52:55], a[244:247], a[68:71], v[52:55]
    v_add_f32 v136, 1.0, v136
    v_add_f32 v137, 1.0, v137
    v_mfma_f32_16x16x32_bf16 v[48:51], a[240:243], a[68:71], v[48:51]
    v_rcp_f32 v136, v136
    v_mfma_f32_16x16x32_bf16 v[48:51], a[224:227], a[64:67], v[48:51]
    v_rcp_f32 v137, v137
    v_mfma_f32_16x16x32_bf16 v[64:67], a[224:227], a[72:75], v[64:67]
    ds_read_b64_tr_b16 a[64:65], v11 offset:36992
    v_add_f32 v138, 1.0, v138
    v_mfma_f32_16x16x32_bf16 v[64:67], a[240:243], a[76:79], v[64:67]
    ds_read_b64_tr_b16 a[66:67], v11 offset:38784
    v_add_f32 v139, 1.0, v139
    v_mfma_f32_16x16x32_bf16 v[68:71], a[244:247], a[76:79], v[68:71]
    ds_read_b64_tr_b16 a[68:69], v11 offset:44160
    v_mul_f32 v120, v120, v104
    v_mfma_f32_16x16x32_bf16 v[68:71], a[228:231], a[72:75], v[68:71]
    ds_read_b64_tr_b16 a[70:71], v11 offset:45952
    v_mul_f32 v121, v121, v105
    v_mfma_f32_16x16x32_bf16 v[72:75], a[232:235], a[72:75], v[72:75]
    v_rcp_f32 v138, v138
    v_mfma_f32_16x16x32_bf16 v[72:75], a[248:251], a[76:79], v[72:75]
    v_rcp_f32 v139, v139
    v_mfma_f32_16x16x32_bf16 v[76:79], a[252:255], a[76:79], v[76:79]
    v_mul_f32 v122, v122, v106
    v_mul_f32 v123, v123, v107
    v_mfma_f32_16x16x32_bf16 v[76:79], a[236:239], a[72:75], v[76:79]
    v_mul_f32 v152, v152, v136
    v_mul_f32 v153, v153, v137
    s_waitcnt lgkmcnt(0)
    v_mfma_f32_16x16x32_bf16 v[92:95], a[236:239], a[80:83], v[92:95]
    ds_read_b64_tr_b16 a[72:73], v11 offset:51328
    v_mul_f32 v154, v154, v138
    v_mfma_f32_16x16x32_bf16 v[92:95], a[252:255], a[84:87], v[92:95]
    ds_read_b64_tr_b16 a[74:75], v11 offset:53120
    v_mul_f32 v155, v155, v139
    v_mfma_f32_16x16x32_bf16 v[88:91], a[248:251], a[84:87], v[88:91]
    ds_read_b64_tr_b16 a[76:77], v11 offset:58496
    v_cvt_pk_bf16_f32 v104, v120, v121
    v_mfma_f32_16x16x32_bf16 v[88:91], a[232:235], a[80:83], v[88:91]
    ds_read_b64_tr_b16 a[78:79], v11 offset:60288
    v_cvt_pk_bf16_f32 v105, v122, v123
    v_mfma_f32_16x16x32_bf16 v[84:87], a[228:231], a[80:83], v[84:87]
    v_cvt_pk_bf16_f32 v106, v152, v153
    v_cvt_pk_bf16_f32 v107, v154, v155
    v_mfma_f32_16x16x32_bf16 v[84:87], a[244:247], a[84:87], v[84:87]
    buffer_store_dwordx4 v[104:107], v1, s[4:7], s20 offen offset:2048 sc1
    v_mfma_f32_16x16x32_bf16 v[80:83], a[240:243], a[84:87], v[80:83]
    v_mul_f32 v124, v108, v124
    v_mul_f32 v108, s52, v108
    v_mfma_f32_16x16x32_bf16 v[80:83], a[224:227], a[80:83], v[80:83]
    v_exp_f32 v108, v108
    v_mfma_f32_16x16x32_bf16 v[224:227], a[64:67], a[160:163], v[224:227]
    ds_read_b64_tr_b16 a[80:81], v11 offset:37024
    v_mul_f32 v125, v109, v125
    v_mfma_f32_16x16x32_bf16 v[224:227], a[68:71], a[176:179], v[224:227]
    ds_read_b64_tr_b16 a[82:83], v11 offset:38816
    v_mul_f32 v109, s52, v109
    v_mfma_f32_16x16x32_bf16 v[228:231], a[68:71], a[180:183], v[228:231]
    ds_read_b64_tr_b16 a[84:85], v11 offset:44192
    v_mul_f32 v126, v110, v126
    v_mfma_f32_16x16x32_bf16 v[228:231], a[64:67], a[164:167], v[228:231]
    ds_read_b64_tr_b16 a[86:87], v11 offset:45984
    v_mul_f32 v110, s52, v110
    v_mfma_f32_16x16x32_bf16 v[232:235], a[64:67], a[168:171], v[232:235]
    v_exp_f32 v109, v109
    v_mfma_f32_16x16x32_bf16 v[232:235], a[68:71], a[184:187], v[232:235]
    v_exp_f32 v110, v110
    v_mfma_f32_16x16x32_bf16 v[236:239], a[68:71], a[188:191], v[236:239]
    v_mul_f32 v127, v111, v127
    v_mul_f32 v111, s52, v111
    v_mfma_f32_16x16x32_bf16 v[236:239], a[64:67], a[172:175], v[236:239]
    v_exp_f32 v111, v111
    s_waitcnt lgkmcnt(0)
    v_mfma_f32_16x16x32_bf16 v[252:255], a[72:75], a[172:175], v[252:255]
    ds_read_b64_tr_b16 a[64:65], v11 offset:51360
    v_mul_f32 v156, v140, v156
    v_mfma_f32_16x16x32_bf16 v[252:255], a[76:79], a[188:191], v[252:255]
    ds_read_b64_tr_b16 a[66:67], v11 offset:53152
    v_mul_f32 v140, s52, v140
    v_mfma_f32_16x16x32_bf16 v[248:251], a[76:79], a[184:187], v[248:251]
    ds_read_b64_tr_b16 a[68:69], v11 offset:58528
    v_mul_f32 v157, v141, v157
    v_mfma_f32_16x16x32_bf16 v[248:251], a[72:75], a[168:171], v[248:251]
    ds_read_b64_tr_b16 a[70:71], v11 offset:60320
    v_mul_f32 v141, s52, v141
    v_mfma_f32_16x16x32_bf16 v[244:247], a[72:75], a[164:167], v[244:247]
    v_exp_f32 v140, v140
    v_mfma_f32_16x16x32_bf16 v[244:247], a[76:79], a[180:183], v[244:247]
    v_exp_f32 v141, v141
    v_mfma_f32_16x16x32_bf16 v[240:243], a[76:79], a[176:179], v[240:243]
    v_mul_f32 v158, v142, v158
    v_mul_f32 v142, s52, v142
    v_mfma_f32_16x16x32_bf16 v[240:243], a[72:75], a[160:163], v[240:243]
    v_exp_f32 v142, v142
    v_mfma_f32_16x16x32_bf16 a[0:3], a[80:83], a[160:163], a[0:3]
    ds_read_b64_tr_b16 a[72:73], v14 offset:128
    v_mul_f32 v159, v143, v159
    v_mfma_f32_16x16x32_bf16 a[0:3], a[84:87], a[176:179], a[0:3]
    ds_read_b64_tr_b16 a[74:75], v14 offset:1920
    v_mul_f32 v143, s52, v143
    v_mfma_f32_16x16x32_bf16 a[4:7], a[84:87], a[180:183], a[4:7]
    ds_read_b64_tr_b16 a[76:77], v14 offset:7296
    v_add_f32 v108, 1.0, v108
    v_mfma_f32_16x16x32_bf16 a[4:7], a[80:83], a[164:167], a[4:7]
    ds_read_b64_tr_b16 a[78:79], v14 offset:9088
    v_add_f32 v109, 1.0, v109
    v_mfma_f32_16x16x32_bf16 a[8:11], a[80:83], a[168:171], a[8:11]
    v_exp_f32 v143, v143
    v_mfma_f32_16x16x32_bf16 a[8:11], a[84:87], a[184:187], a[8:11]
    v_rcp_f32 v108, v108
    v_mfma_f32_16x16x32_bf16 a[12:15], a[84:87], a[188:191], a[12:15]
    v_rcp_f32 v109, v109
    v_mfma_f32_16x16x32_bf16 a[12:15], a[80:83], a[172:175], a[12:15]
    v_add_f32 v110, 1.0, v110
    v_add_f32 v111, 1.0, v111
    s_waitcnt lgkmcnt(0)
    v_mfma_f32_16x16x32_bf16 a[28:31], a[64:67], a[172:175], a[28:31]
    ds_read_b64_tr_b16 a[80:81], v14 offset:14464
    v_add_f32 v140, 1.0, v140
    v_mfma_f32_16x16x32_bf16 a[28:31], a[68:71], a[188:191], a[28:31]
    ds_read_b64_tr_b16 a[82:83], v14 offset:16256
    v_add_f32 v141, 1.0, v141
    v_mfma_f32_16x16x32_bf16 a[24:27], a[68:71], a[184:187], a[24:27]
    ds_read_b64_tr_b16 a[84:85], v14 offset:21632
    v_add_f32 v142, 1.0, v142
    v_mfma_f32_16x16x32_bf16 a[24:27], a[64:67], a[168:171], a[24:27]
    ds_read_b64_tr_b16 a[86:87], v14 offset:23424
L_pad5:
    s_cbranch_execz L_pad9
    v_add_f32 v143, 1.0, v143
    v_mfma_f32_16x16x32_bf16 a[20:23], a[64:67], a[164:167], a[20:23]
    v_rcp_f32 v110, v110
    v_mfma_f32_16x16x32_bf16 a[20:23], a[68:71], a[180:183], a[20:23]
    v_rcp_f32 v111, v111
    v_mfma_f32_16x16x32_bf16 a[16:19], a[68:71], a[176:179], a[16:19]
    v_rcp_f32 v140, v140
    v_mfma_f32_16x16x32_bf16 a[16:19], a[64:67], a[160:163], a[16:19]
    v_rcp_f32 v141, v141
    v_mfma_f32_16x16x32_bf16 v[224:227], a[72:75], a[192:195], v[224:227]
    ds_read_b64_tr_b16 a[64:65], v14 offset:160
    v_mul_f32 v124, v124, v108
    v_mfma_f32_16x16x32_bf16 v[224:227], a[76:79], a[208:211], v[224:227]
    ds_read_b64_tr_b16 a[66:67], v14 offset:1952
    v_mul_f32 v125, v125, v109
    v_mfma_f32_16x16x32_bf16 v[228:231], a[76:79], a[212:215], v[228:231]
    ds_read_b64_tr_b16 a[68:69], v14 offset:7328
    v_mul_f32 v126, v126, v110
    v_mfma_f32_16x16x32_bf16 v[228:231], a[72:75], a[196:199], v[228:231]
    ds_read_b64_tr_b16 a[70:71], v14 offset:9120
    v_mul_f32 v127, v127, v111
    v_mfma_f32_16x16x32_bf16 v[232:235], a[72:75], a[200:203], v[232:235]
    v_rcp_f32 v142, v142
    v_mfma_f32_16x16x32_bf16 v[232:235], a[76:79], a[216:219], v[232:235]
    v_rcp_f32 v143, v143
    v_mfma_f32_16x16x32_bf16 v[236:239], a[76:79], a[220:223], v[236:239]
    v_mul_f32 v156, v156, v140
    v_mul_f32 v157, v157, v141
    v_mfma_f32_16x16x32_bf16 v[236:239], a[72:75], a[204:207], v[236:239]
    v_mul_f32 v158, v158, v142
    v_mul_f32 v159, v159, v143
    s_waitcnt lgkmcnt(0)
    v_mfma_f32_16x16x32_bf16 v[252:255], a[80:83], a[204:207], v[252:255]
    ds_read_b64_tr_b16 a[72:73], v14 offset:14496
    v_cvt_pk_bf16_f32 v108, v124, v125
    v_mfma_f32_16x16x32_bf16 v[252:255], a[84:87], a[220:223], v[252:255]
    ds_read_b64_tr_b16 a[74:75], v14 offset:16288
    v_cvt_pk_bf16_f32 v109, v126, v127
    v_mfma_f32_16x16x32_bf16 v[248:251], a[84:87], a[216:219], v[248:251]
    ds_read_b64_tr_b16 a[76:77], v14 offset:21664
    v_cvt_pk_bf16_f32 v110, v156, v157
    v_mfma_f32_16x16x32_bf16 v[248:251], a[80:83], a[200:203], v[248:251]
    ds_read_b64_tr_b16 a[78:79], v14 offset:23456
    v_cvt_pk_bf16_f32 v111, v158, v159
    v_mfma_f32_16x16x32_bf16 v[244:247], a[80:83], a[196:199], v[244:247]
    buffer_store_dwordx4 v[108:111], v1, s[4:7], s20 offen offset:3072 sc1
    v_mfma_f32_16x16x32_bf16 v[244:247], a[84:87], a[212:215], v[244:247]
    v_mul_f32 v176, v160, v176
    v_mul_f32 v160, s52, v160
    v_mfma_f32_16x16x32_bf16 v[240:243], a[84:87], a[208:211], v[240:243]
    v_exp_f32 v160, v160
    v_mfma_f32_16x16x32_bf16 v[240:243], a[80:83], a[192:195], v[240:243]
    v_mul_f32 v177, v161, v177
    v_mul_f32 v161, s52, v161
    v_mfma_f32_16x16x32_bf16 a[0:3], a[64:67], a[192:195], a[0:3]
    ds_read_b64_tr_b16 a[80:81], v14 offset:36992
    v_mul_f32 v178, v162, v178
    v_mfma_f32_16x16x32_bf16 a[0:3], a[68:71], a[208:211], a[0:3]
    ds_read_b64_tr_b16 a[82:83], v14 offset:38784
    v_mul_f32 v162, s52, v162
    v_mfma_f32_16x16x32_bf16 a[4:7], a[68:71], a[212:215], a[4:7]
    ds_read_b64_tr_b16 a[84:85], v14 offset:44160
    v_mul_f32 v179, v163, v179
    v_mfma_f32_16x16x32_bf16 a[4:7], a[64:67], a[196:199], a[4:7]
    ds_read_b64_tr_b16 a[86:87], v14 offset:45952
    v_mul_f32 v163, s52, v163
    v_mfma_f32_16x16x32_bf16 a[8:11], a[64:67], a[200:203], a[8:11]
    v_exp_f32 v161, v161
    v_mfma_f32_16x16x32_bf16 a[8:11], a[68:71], a[216:219], a[8:11]
    v_exp_f32 v162, v162
    v_mfma_f32_16x16x32_bf16 a[12:15], a[68:71], a[220:223], a[12:15]
    v_exp_f32 v163, v163
    v_mfma_f32_16x16x32_bf16 a[12:15], a[64:67], a[204:207], a[12:15]
    v_mul_f32 v208, v192, v208
    v_mul_f32 v192, s52, v192
    s_waitcnt lgkmcnt(0)
    v_mfma_f32_16x16x32_bf16 a[28:31], a[72:75], a[204:207], a[28:31]
    ds_read_b64_tr_b16 a[64:65], v14 offset:51328
    v_mul_f32 v209, v193, v209
    v_mfma_f32_16x16x32_bf16 a[28:31], a[76:79], a[220:223], a[28:31]
    ds_read_b64_tr_b16 a[66:67], v14 offset:53120
    v_mul_f32 v193, s52, v193
    v_mfma_f32_16x16x32_bf16 a[24:27], a[76:79], a[216:219], a[24:27]
    ds_read_b64_tr_b16 a[68:69], v14 offset:58496
    v_mul_f32 v210, v194, v210
    v_mfma_f32_16x16x32_bf16 a[24:27], a[72:75], a[200:203], a[24:27]
    ds_read_b64_tr_b16 a[70:71], v14 offset:60288
    v_mul_f32 v194, s52, v194
    v_mfma_f32_16x16x32_bf16 a[20:23], a[72:75], a[196:199], a[20:23]
    v_exp_f32 v192, v192
    v_mfma_f32_16x16x32_bf16 a[20:23], a[76:79], a[212:215], a[20:23]
    v_exp_f32 v193, v193
    v_mfma_f32_16x16x32_bf16 a[16:19], a[76:79], a[208:211], a[16:19]
    v_exp_f32 v194, v194
    v_mfma_f32_16x16x32_bf16 a[16:19], a[72:75], a[192:195], a[16:19]
    v_mul_f32 v211, v195, v211
    v_mul_f32 v195, s52, v195
    v_mfma_f32_16x16x32_bf16 v[224:227], a[80:83], a[224:227], v[224:227]
    ds_read_b64_tr_b16 a[72:73], v14 offset:37024
    v_add_f32 v160, 1.0, v160
    v_mfma_f32_16x16x32_bf16 v[224:227], a[84:87], a[240:243], v[224:227]
    ds_read_b64_tr_b16 a[74:75], v14 offset:38816
    v_add_f32 v161, 1.0, v161
    v_mfma_f32_16x16x32_bf16 v[228:231], a[84:87], a[244:247], v[228:231]
    ds_read_b64_tr_b16 a[76:77], v14 offset:44192
    v_add_f32 v162, 1.0, v162
    v_mfma_f32_16x16x32_bf16 v[228:231], a[80:83], a[228:231], v[228:231]
    ds_read_b64_tr_b16 a[78:79], v14 offset:45984
    v_add_f32 v163, 1.0, v163
    v_mfma_f32_16x16x32_bf16 v[232:235], a[80:83], a[232:235], v[232:235]
    v_exp_f32 v195, v195
    v_mfma_f32_16x16x32_bf16 v[232:235], a[84:87], a[248:251], v[232:235]
    v_rcp_f32 v160, v160
    v_mfma_f32_16x16x32_bf16 v[236:239], a[84:87], a[252:255], v[236:239]
    v_rcp_f32 v161, v161
    v_mfma_f32_16x16x32_bf16 v[236:239], a[80:83], a[236:239], v[236:239]
    v_rcp_f32 v162, v162
    s_waitcnt lgkmcnt(0)
    v_mfma_f32_16x16x32_bf16 v[252:255], a[64:67], a[236:239], v[252:255]
    ds_read_b64_tr_b16 a[80:81], v14 offset:51360
    v_add_f32 v192, 1.0, v192
    v_mfma_f32_16x16x32_bf16 v[252:255], a[68:71], a[252:255], v[252:255]
    ds_read_b64_tr_b16 a[82:83], v14 offset:53152
    v_add_f32 v193, 1.0, v193
    v_mfma_f32_16x16x32_bf16 v[248:251], a[68:71], a[248:251], v[248:251]
    ds_read_b64_tr_b16 a[84:85], v14 offset:58528
    v_add_f32 v194, 1.0, v194
    v_mfma_f32_16x16x32_bf16 v[248:251], a[64:67], a[232:235], v[248:251]
    ds_read_b64_tr_b16 a[86:87], v14 offset:60320
    v_add_f32 v195, 1.0, v195
    v_mfma_f32_16x16x32_bf16 v[244:247], a[64:67], a[228:231], v[244:247]
    v_rcp_f32 v163, v163
    v_mfma_f32_16x16x32_bf16 v[244:247], a[68:71], a[244:247], v[244:247]
    v_rcp_f32 v192, v192
    v_mfma_f32_16x16x32_bf16 v[240:243], a[68:71], a[240:243], v[240:243]
    v_rcp_f32 v193, v193
    v_mfma_f32_16x16x32_bf16 v[240:243], a[64:67], a[224:227], v[240:243]
    v_rcp_f32 v194, v194
    v_mfma_f32_16x16x32_bf16 a[0:3], a[72:75], a[224:227], a[0:3]
    ds_read_b64_tr_b16 a[64:65], v11 offset:37056
    v_mul_f32 v176, v176, v160
    v_mfma_f32_16x16x32_bf16 a[0:3], a[76:79], a[240:243], a[0:3]
    ds_read_b64_tr_b16 a[66:67], v11 offset:38848
    v_mul_f32 v177, v177, v161
    v_mfma_f32_16x16x32_bf16 a[4:7], a[76:79], a[244:247], a[4:7]
    ds_read_b64_tr_b16 a[68:69], v11 offset:44224
    v_mul_f32 v178, v178, v162
    v_mfma_f32_16x16x32_bf16 a[4:7], a[72:75], a[228:231], a[4:7]
    ds_read_b64_tr_b16 a[70:71], v11 offset:46016
    v_mul_f32 v179, v179, v163
    v_mfma_f32_16x16x32_bf16 a[8:11], a[72:75], a[232:235], a[8:11]
    v_rcp_f32 v195, v195
    v_mfma_f32_16x16x32_bf16 a[8:11], a[76:79], a[248:251], a[8:11]
    v_mul_f32 v208, v208, v192
    v_mul_f32 v209, v209, v193
    v_mfma_f32_16x16x32_bf16 a[12:15], a[76:79], a[252:255], a[12:15]
    v_mul_f32 v210, v210, v194
    v_mul_f32 v211, v211, v195
    v_mfma_f32_16x16x32_bf16 a[12:15], a[72:75], a[236:239], a[12:15]
    v_cvt_pk_bf16_f32 v160, v176, v177
    v_cvt_pk_bf16_f32 v161, v178, v179
    s_waitcnt lgkmcnt(0)
    v_mfma_f32_16x16x32_bf16 a[28:31], a[80:83], a[236:239], a[28:31]
    v_mov_b32 v19, 1
    s_waitcnt vmcnt(0)
    buffer_store_dword v19, v28, s[4:7], s75 offen offset:0 sc1
    ds_read_b64_tr_b16 a[72:73], v11 offset:51392
    v_mfma_f32_16x16x32_bf16 a[28:31], a[84:87], a[252:255], a[28:31]
    ds_read_b64_tr_b16 a[74:75], v11 offset:53184
    v_cvt_pk_bf16_f32 v162, v208, v209
    v_mfma_f32_16x16x32_bf16 a[24:27], a[84:87], a[248:251], a[24:27]
    ds_read_b64_tr_b16 a[76:77], v11 offset:58560
    v_cvt_pk_bf16_f32 v163, v210, v211
    v_mfma_f32_16x16x32_bf16 a[24:27], a[80:83], a[232:235], a[24:27]
    ds_read_b64_tr_b16 a[78:79], v11 offset:60352
    v_mul_f32 v180, v164, v180
    v_mfma_f32_16x16x32_bf16 a[20:23], a[80:83], a[228:231], a[20:23]
    buffer_store_dwordx4 v[160:163], v1, s[4:7], s21 offen offset:0 sc1
    v_mfma_f32_16x16x32_bf16 a[20:23], a[84:87], a[244:247], a[20:23]
    v_mul_f32 v164, s52, v164
    v_mul_f32 v181, v165, v181
    v_mfma_f32_16x16x32_bf16 a[16:19], a[84:87], a[240:243], a[16:19]
    v_exp_f32 v164, v164
    v_mfma_f32_16x16x32_bf16 a[16:19], a[80:83], a[224:227], a[16:19]
    v_mul_f32 v165, s52, v165
    v_mul_f32 v182, v166, v182
    v_mfma_f32_16x16x32_bf16 a[32:35], a[64:67], a[160:163], a[32:35]
    ds_read_b64_tr_b16 a[80:81], v14 offset:192
    v_mul_f32 v166, s52, v166
    v_mfma_f32_16x16x32_bf16 a[32:35], a[68:71], a[176:179], a[32:35]
    ds_read_b64_tr_b16 a[82:83], v14 offset:1984
    v_mul_f32 v183, v167, v183
    v_mfma_f32_16x16x32_bf16 a[36:39], a[68:71], a[180:183], a[36:39]
    ds_read_b64_tr_b16 a[84:85], v14 offset:7360
    v_mul_f32 v167, s52, v167
    v_mfma_f32_16x16x32_bf16 a[36:39], a[64:67], a[164:167], a[36:39]
    ds_read_b64_tr_b16 a[86:87], v14 offset:9152
    v_mul_f32 v212, v196, v212
    v_mfma_f32_16x16x32_bf16 a[40:43], a[64:67], a[168:171], a[40:43]
    v_exp_f32 v165, v165
    v_mfma_f32_16x16x32_bf16 a[40:43], a[68:71], a[184:187], a[40:43]
    v_exp_f32 v166, v166
    v_mfma_f32_16x16x32_bf16 a[44:47], a[68:71], a[188:191], a[44:47]
    v_exp_f32 v167, v167
    v_mfma_f32_16x16x32_bf16 a[44:47], a[64:67], a[172:175], a[44:47]
    v_mul_f32 v196, s52, v196
    v_mul_f32 v213, v197, v213
    s_waitcnt lgkmcnt(0)
    v_mfma_f32_16x16x32_bf16 a[60:63], a[72:75], a[172:175], a[60:63]
    ds_read_b64_tr_b16 a[64:65], v14 offset:14528
    v_mul_f32 v197, s52, v197
    v_mfma_f32_16x16x32_bf16 a[60:63], a[76:79], a[188:191], a[60:63]
    ds_read_b64_tr_b16 a[66:67], v14 offset:16320
    v_mul_f32 v214, v198, v214
    v_mfma_f32_16x16x32_bf16 a[56:59], a[76:79], a[184:187], a[56:59]
    ds_read_b64_tr_b16 a[68:69], v14 offset:21696
    v_mul_f32 v198, s52, v198
    v_mfma_f32_16x16x32_bf16 a[56:59], a[72:75], a[168:171], a[56:59]
    ds_read_b64_tr_b16 a[70:71], v14 offset:23488
    v_mul_f32 v215, v199, v215
    v_mfma_f32_16x16x32_bf16 a[52:55], a[72:75], a[164:167], a[52:55]
    v_exp_f32 v196, v196
    v_mfma_f32_16x16x32_bf16 a[52:55], a[76:79], a[180:183], a[52:55]
    v_exp_f32 v197, v197
    v_mfma_f32_16x16x32_bf16 a[48:51], a[76:79], a[176:179], a[48:51]
    v_exp_f32 v198, v198
    v_mfma_f32_16x16x32_bf16 a[48:51], a[72:75], a[160:163], a[48:51]
    v_mul_f32 v199, s52, v199
    v_add_f32 v164, 1.0, v164
    v_mfma_f32_16x16x32_bf16 a[32:35], a[80:83], a[192:195], a[32:35]
    ds_read_b64_tr_b16 a[72:73], v14 offset:37056
    v_add_f32 v165, 1.0, v165
    v_mfma_f32_16x16x32_bf16 a[32:35], a[84:87], a[208:211], a[32:35]
    ds_read_b64_tr_b16 a[74:75], v14 offset:38848
    v_add_f32 v166, 1.0, v166
    v_mfma_f32_16x16x32_bf16 a[36:39], a[84:87], a[212:215], a[36:39]
    ds_read_b64_tr_b16 a[76:77], v14 offset:44224
    v_add_f32 v167, 1.0, v167
    v_mfma_f32_16x16x32_bf16 a[36:39], a[80:83], a[196:199], a[36:39]
    ds_read_b64_tr_b16 a[78:79], v14 offset:46016
    v_add_f32 v196, 1.0, v196
    v_mfma_f32_16x16x32_bf16 a[40:43], a[80:83], a[200:203], a[40:43]
    v_exp_f32 v199, v199
    v_mfma_f32_16x16x32_bf16 a[40:43], a[84:87], a[216:219], a[40:43]
    v_rcp_f32 v164, v164
    v_mfma_f32_16x16x32_bf16 a[44:47], a[84:87], a[220:223], a[44:47]
    v_rcp_f32 v165, v165
    v_mfma_f32_16x16x32_bf16 a[44:47], a[80:83], a[204:207], a[44:47]
    v_rcp_f32 v166, v166
    s_waitcnt lgkmcnt(0)
    v_mfma_f32_16x16x32_bf16 a[60:63], a[64:67], a[204:207], a[60:63]
    ds_read_b64_tr_b16 a[80:81], v14 offset:51392
    v_add_f32 v197, 1.0, v197
    v_mfma_f32_16x16x32_bf16 a[60:63], a[68:71], a[220:223], a[60:63]
    ds_read_b64_tr_b16 a[82:83], v14 offset:53184
    v_add_f32 v198, 1.0, v198
    v_mfma_f32_16x16x32_bf16 a[56:59], a[68:71], a[216:219], a[56:59]
    ds_read_b64_tr_b16 a[84:85], v14 offset:58560
    v_add_f32 v199, 1.0, v199
    v_mfma_f32_16x16x32_bf16 a[56:59], a[64:67], a[200:203], a[56:59]
    ds_read_b64_tr_b16 a[86:87], v14 offset:60352
    v_mul_f32 v180, v180, v164
    v_mfma_f32_16x16x32_bf16 a[52:55], a[64:67], a[196:199], a[52:55]
    v_rcp_f32 v167, v167
    v_mfma_f32_16x16x32_bf16 a[52:55], a[68:71], a[212:215], a[52:55]
    v_rcp_f32 v196, v196
    v_mfma_f32_16x16x32_bf16 a[48:51], a[68:71], a[208:211], a[48:51]
    v_rcp_f32 v197, v197
    v_mfma_f32_16x16x32_bf16 a[48:51], a[64:67], a[192:195], a[48:51]
    v_rcp_f32 v198, v198
    v_mfma_f32_16x16x32_bf16 a[32:35], a[72:75], a[224:227], a[32:35]
    v_rcp_f32 v199, v199
    v_mfma_f32_16x16x32_bf16 a[32:35], a[76:79], a[240:243], a[32:35]
    v_mul_f32 v181, v181, v165
    v_mul_f32 v182, v182, v166
    v_mfma_f32_16x16x32_bf16 a[36:39], a[76:79], a[244:247], a[36:39]
    v_mul_f32 v183, v183, v167
    v_mul_f32 v212, v212, v196
    v_mfma_f32_16x16x32_bf16 a[36:39], a[72:75], a[228:231], a[36:39]
    v_mul_f32 v213, v213, v197
    v_mul_f32 v214, v214, v198
    v_mfma_f32_16x16x32_bf16 a[40:43], a[72:75], a[232:235], a[40:43]
    v_mul_f32 v215, v215, v199
    v_cvt_pk_bf16_f32 v164, v180, v181
    v_mfma_f32_16x16x32_bf16 a[40:43], a[76:79], a[248:251], a[40:43]
    v_cvt_pk_bf16_f32 v165, v182, v183
    v_cvt_pk_bf16_f32 v166, v212, v213
    v_mfma_f32_16x16x32_bf16 a[44:47], a[76:79], a[252:255], a[44:47]
    v_cvt_pk_bf16_f32 v167, v214, v215
    v_mul_f32 v184, v168, v184
    v_mfma_f32_16x16x32_bf16 a[44:47], a[72:75], a[236:239], a[44:47]
    buffer_store_dwordx4 v[164:167], v1, s[4:7], s21 offen offset:1024 sc1
    s_waitcnt lgkmcnt(0)
    v_mfma_f32_16x16x32_bf16 a[60:63], a[80:83], a[236:239], a[60:63]
    v_mul_f32 v168, s52, v168
    v_mul_f32 v185, v169, v185
    v_mfma_f32_16x16x32_bf16 a[60:63], a[84:87], a[252:255], a[60:63]
    v_exp_f32 v168, v168
    v_mfma_f32_16x16x32_bf16 a[56:59], a[84:87], a[248:251], a[56:59]
    v_mul_f32 v169, s52, v169
    v_mul_f32 v186, v170, v186
    v_mfma_f32_16x16x32_bf16 a[56:59], a[80:83], a[232:235], a[56:59]
    v_exp_f32 v169, v169
    v_mfma_f32_16x16x32_bf16 a[52:55], a[80:83], a[228:231], a[52:55]
    v_mul_f32 v170, s52, v170
    v_mul_f32 v187, v171, v187
    v_mfma_f32_16x16x32_bf16 a[52:55], a[84:87], a[244:247], a[52:55]
    v_exp_f32 v170, v170
    v_mfma_f32_16x16x32_bf16 a[48:51], a[84:87], a[240:243], a[48:51]
    v_mul_f32 v171, s52, v171
    v_mul_f32 v216, v200, v216
    v_mfma_f32_16x16x32_bf16 a[48:51], a[80:83], a[224:227], a[48:51]
    v_exp_f32 v171, v171
    s_barrier
    v_mul_f32 v200, s52, v200
    v_mul_f32 v217, v201, v217
    v_mul_f32 v201, s52, v201
    v_mul_f32 v218, v202, v218
    v_mul_f32 v202, s52, v202
    v_mul_f32 v219, v203, v219
    v_mul_f32 v203, s52, v203
    v_exp_f32 v200, v200
    v_exp_f32 v201, v201
    v_exp_f32 v202, v202
    v_exp_f32 v203, v203
    v_add_f32 v168, 1.0, v168
    v_add_f32 v169, 1.0, v169
    s_add_u32 m0, s63, 32768
    s_add_u32 s61, s10, 0
    s_nop 0
    buffer_load_dwordx4 v2, s[24:27], s61 offen offset:0 lds
    v_add_f32 v170, 1.0, v170
    v_add_f32 v171, 1.0, v171
    v_add_f32 v200, 1.0, v200
    v_add_f32 v201, 1.0, v201
    v_add_f32 v202, 1.0, v202
    v_add_f32 v203, 1.0, v203
    v_rcp_f32 v168, v168
    v_rcp_f32 v169, v169
    v_rcp_f32 v170, v170
    v_rcp_f32 v171, v171
    v_rcp_f32 v200, v200
    v_rcp_f32 v201, v201
    v_rcp_f32 v202, v202
    buffer_load_dwordx4 v3, s[24:27], s61 offen offset:1024 lds
    v_rcp_f32 v203, v203
    v_mul_f32 v184, v184, v168
    v_mul_f32 v185, v185, v169
    v_mul_f32 v186, v186, v170
    v_mul_f32 v187, v187, v171
    v_mul_f32 v216, v216, v200
    v_mul_f32 v217, v217, v201
    v_mul_f32 v218, v218, v202
    v_mul_f32 v219, v219, v203
    v_cvt_pk_bf16_f32 v168, v184, v185
    v_cvt_pk_bf16_f32 v169, v186, v187
    v_cvt_pk_bf16_f32 v170, v216, v217
    v_cvt_pk_bf16_f32 v171, v218, v219
    buffer_load_dwordx4 v4, s[24:27], s61 offen offset:2048 lds
    buffer_store_dwordx4 v[168:171], v1, s[4:7], s21 offen offset:2048 sc1
    v_pk_mul_f32 v[188:189], v[172:173], v[188:189]
    v_pk_mul_f32 v[190:191], v[174:175], v[190:191]
    v_pk_mul_f32 v[220:221], v[204:205], v[220:221]
    v_pk_mul_f32 v[222:223], v[206:207], v[222:223]
    v_pk_mul_f32 v[172:173], v[172:173], s[52:53]
    v_pk_mul_f32 v[174:175], v[174:175], s[52:53]
    v_pk_mul_f32 v[204:205], v[204:205], s[52:53]
    v_pk_mul_f32 v[206:207], v[206:207], s[52:53]
    v_exp_f32 v172, v172
    v_exp_f32 v173, v173
    v_exp_f32 v174, v174
    v_exp_f32 v175, v175
    v_exp_f32 v204, v204
    buffer_load_dwordx4 v5, s[24:27], s61 offen offset:3072 lds
    v_exp_f32 v205, v205
    v_exp_f32 v206, v206
    v_exp_f32 v207, v207
    v_pk_add_f32 v[172:173], v[172:173], 1.0 op_sel_hi:[1,0]
    v_pk_add_f32 v[174:175], v[174:175], 1.0 op_sel_hi:[1,0]
    v_pk_add_f32 v[204:205], v[204:205], 1.0 op_sel_hi:[1,0]
    v_pk_add_f32 v[206:207], v[206:207], 1.0 op_sel_hi:[1,0]
    v_rcp_f32 v172, v172
    v_rcp_f32 v173, v173
    v_rcp_f32 v174, v174
    v_rcp_f32 v175, v175
    v_rcp_f32 v204, v204
    v_rcp_f32 v205, v205
    s_add_u32 m0, s63, 49152
    s_add_u32 s61, s11, 0
    s_nop 0
    buffer_load_dwordx4 v2, s[24:27], s61 offen offset:0 lds
    v_rcp_f32 v206, v206
    v_rcp_f32 v207, v207
    v_pk_mul_f32 v[188:189], v[188:189], v[172:173]
    v_pk_mul_f32 v[190:191], v[190:191], v[174:175]
    v_pk_mul_f32 v[220:221], v[220:221], v[204:205]
    v_pk_mul_f32 v[222:223], v[222:223], v[206:207]
    v_cvt_pk_bf16_f32 v172, v188, v189
    v_cvt_pk_bf16_f32 v173, v190, v191
    v_cvt_pk_bf16_f32 v174, v220, v221
    v_cvt_pk_bf16_f32 v175, v222, v223
    buffer_store_dwordx4 v[172:175], v1, s[4:7], s21 offen offset:3072 sc1
    v_mov_b32 v31, 0
    buffer_atomic_add v31, v30, s[4:7], s74 offen offset:0 sc0 sc1
    v_accvgpr_read_b32 v20, a88
    v_accvgpr_read_b32 v21, a89
    v_accvgpr_read_b32 v22, a106
    v_accvgpr_read_b32 v23, a107
    v_accvgpr_read_b32 v112, a90
    v_accvgpr_read_b32 v113, a91
    v_accvgpr_read_b32 v114, a108
    v_accvgpr_read_b32 v115, a109
    v_pk_mul_f32 v[116:117], v[32:33], v[112:113] op_sel_hi:[0,1]
    v_pk_mul_f32 v[118:119], v[48:49], v[114:115] op_sel_hi:[0,1]
    v_pk_mul_f32 v[120:121], v[32:33], v[112:113] op_sel:[1,0]
    v_pk_mul_f32 v[122:123], v[48:49], v[114:115] op_sel:[1,0]
    v_pk_fma_f32 v[32:33], v[64:65], v[112:113], v[116:117] op_sel:[0,1,0] op_sel_hi:[0,0,1] neg_lo:[1,0,0]
    v_pk_fma_f32 v[48:49], v[80:81], v[114:115], v[118:119] op_sel:[0,1,0] op_sel_hi:[0,0,1] neg_lo:[1,0,0]
    v_pk_fma_f32 v[64:65], v[64:65], v[112:113], v[120:121] op_sel:[1,1,0] op_sel_hi:[1,0,1] neg_lo:[1,0,0]
    v_pk_fma_f32 v[80:81], v[80:81], v[114:115], v[122:123] op_sel:[1,1,0] op_sel_hi:[1,0,1] neg_lo:[1,0,0]
    v_pk_mul_f32 v[116:117], v[34:35], v[112:113] op_sel_hi:[0,1]
    buffer_load_dwordx4 v3, s[24:27], s61 offen offset:1024 lds
    v_pk_fma_f32 v[144:145], v[20:21], v[32:33], v[64:65] op_sel_hi:[0,1,1]
    v_pk_mul_f32 v[118:119], v[50:51], v[114:115] op_sel_hi:[0,1]
    v_pk_fma_f32 v[146:147], v[22:23], v[48:49], v[80:81] op_sel_hi:[0,1,1]
    v_pk_mul_f32 v[120:121], v[34:35], v[112:113] op_sel:[1,0]
    v_pk_fma_f32 v[124:125], v[20:21], v[32:33], v[144:145] op_sel:[1,1,0] op_sel_hi:[1,0,1] neg_lo:[1,0,0]
    v_pk_mul_f32 v[122:123], v[50:51], v[114:115] op_sel:[1,0]
    v_pk_fma_f32 v[126:127], v[22:23], v[48:49], v[146:147] op_sel:[1,1,0] op_sel_hi:[1,0,1] neg_lo:[1,0,0]
    v_pk_fma_f32 v[34:35], v[66:67], v[112:113], v[116:117] op_sel:[0,1,0] op_sel_hi:[0,0,1] neg_lo:[1,0,0]
    v_pk_fma_f32 v[50:51], v[82:83], v[114:115], v[118:119] op_sel:[0,1,0] op_sel_hi:[0,0,1] neg_lo:[1,0,0]
    v_pk_fma_f32 v[66:67], v[66:67], v[112:113], v[120:121] op_sel:[1,1,0] op_sel_hi:[1,0,1] neg_lo:[1,0,0]
    v_pk_fma_f32 v[82:83], v[82:83], v[114:115], v[122:123] op_sel:[1,1,0] op_sel_hi:[1,0,1] neg_lo:[1,0,0]
    v_pk_mul_f32 v[116:117], v[36:37], v[112:113] op_sel_hi:[0,1]
    v_pk_fma_f32 v[144:145], v[20:21], v[124:125], v[34:35] op_sel_hi:[0,1,1]
    v_pk_mul_f32 v[118:119], v[52:53], v[114:115] op_sel_hi:[0,1]
    v_pk_fma_f32 v[146:147], v[22:23], v[126:127], v[50:51] op_sel_hi:[0,1,1]
    v_pk_mul_f32 v[120:121], v[36:37], v[112:113] op_sel:[1,0]
    v_pk_fma_f32 v[124:125], v[20:21], v[124:125], v[144:145] op_sel:[1,1,0] op_sel_hi:[1,0,1] neg_lo:[1,0,0]
    buffer_load_dwordx4 v4, s[24:27], s61 offen offset:2048 lds
    v_pk_mul_f32 v[122:123], v[52:53], v[114:115] op_sel:[1,0]
    v_pk_fma_f32 v[126:127], v[22:23], v[126:127], v[146:147] op_sel:[1,1,0] op_sel_hi:[1,0,1] neg_lo:[1,0,0]
    v_pk_fma_f32 v[36:37], v[68:69], v[112:113], v[116:117] op_sel:[0,1,0] op_sel_hi:[0,0,1] neg_lo:[1,0,0]
    v_pk_fma_f32 v[144:145], v[20:21], v[124:125], v[66:67] op_sel_hi:[0,1,1]
    v_pk_fma_f32 v[52:53], v[84:85], v[114:115], v[118:119] op_sel:[0,1,0] op_sel_hi:[0,0,1] neg_lo:[1,0,0]
    v_pk_fma_f32 v[146:147], v[22:23], v[126:127], v[82:83] op_sel_hi:[0,1,1]
    v_pk_fma_f32 v[68:69], v[68:69], v[112:113], v[120:121] op_sel:[1,1,0] op_sel_hi:[1,0,1] neg_lo:[1,0,0]
    v_pk_fma_f32 v[124:125], v[20:21], v[124:125], v[144:145] op_sel:[1,1,0] op_sel_hi:[1,0,1] neg_lo:[1,0,0]
    v_pk_fma_f32 v[84:85], v[84:85], v[114:115], v[122:123] op_sel:[1,1,0] op_sel_hi:[1,0,1] neg_lo:[1,0,0]
    v_pk_fma_f32 v[126:127], v[22:23], v[126:127], v[146:147] op_sel:[1,1,0] op_sel_hi:[1,0,1] neg_lo:[1,0,0]
    v_pk_mul_f32 v[116:117], v[38:39], v[112:113] op_sel_hi:[0,1]
    v_pk_fma_f32 v[144:145], v[20:21], v[124:125], v[36:37] op_sel_hi:[0,1,1]
    v_pk_mul_f32 v[118:119], v[54:55], v[114:115] op_sel_hi:[0,1]
    v_pk_fma_f32 v[146:147], v[22:23], v[126:127], v[52:53] op_sel_hi:[0,1,1]
    v_pk_mul_f32 v[120:121], v[38:39], v[112:113] op_sel:[1,0]
    v_pk_fma_f32 v[124:125], v[20:21], v[124:125], v[144:145] op_sel:[1,1,0] op_sel_hi:[1,0,1] neg_lo:[1,0,0]
    v_pk_mul_f32 v[122:123], v[54:55], v[114:115] op_sel:[1,0]
    buffer_load_dwordx4 v5, s[24:27], s61 offen offset:3072 lds
    v_pk_fma_f32 v[126:127], v[22:23], v[126:127], v[146:147] op_sel:[1,1,0] op_sel_hi:[1,0,1] neg_lo:[1,0,0]
    v_pk_fma_f32 v[38:39], v[70:71], v[112:113], v[116:117] op_sel:[0,1,0] op_sel_hi:[0,0,1] neg_lo:[1,0,0]
    v_pk_fma_f32 v[144:145], v[20:21], v[124:125], v[68:69] op_sel_hi:[0,1,1]
    v_pk_fma_f32 v[54:55], v[86:87], v[114:115], v[118:119] op_sel:[0,1,0] op_sel_hi:[0,0,1] neg_lo:[1,0,0]
    v_pk_fma_f32 v[146:147], v[22:23], v[126:127], v[84:85] op_sel_hi:[0,1,1]
    v_pk_fma_f32 v[70:71], v[70:71], v[112:113], v[120:121] op_sel:[1,1,0] op_sel_hi:[1,0,1] neg_lo:[1,0,0]
    v_pk_fma_f32 v[124:125], v[20:21], v[124:125], v[144:145] op_sel:[1,1,0] op_sel_hi:[1,0,1] neg_lo:[1,0,0]
    v_pk_fma_f32 v[86:87], v[86:87], v[114:115], v[122:123] op_sel:[1,1,0] op_sel_hi:[1,0,1] neg_lo:[1,0,0]
    v_pk_fma_f32 v[126:127], v[22:23], v[126:127], v[146:147] op_sel:[1,1,0] op_sel_hi:[1,0,1] neg_lo:[1,0,0]
    v_pk_mul_f32 v[116:117], v[40:41], v[112:113] op_sel_hi:[0,1]
    v_pk_fma_f32 v[144:145], v[20:21], v[124:125], v[38:39] op_sel_hi:[0,1,1]
    v_pk_mul_f32 v[118:119], v[56:57], v[114:115] op_sel_hi:[0,1]
    v_pk_fma_f32 v[146:147], v[22:23], v[126:127], v[54:55] op_sel_hi:[0,1,1]
    v_pk_mul_f32 v[120:121], v[40:41], v[112:113] op_sel:[1,0]
    v_pk_fma_f32 v[124:125], v[20:21], v[124:125], v[144:145] op_sel:[1,1,0] op_sel_hi:[1,0,1] neg_lo:[1,0,0]
    v_pk_mul_f32 v[122:123], v[56:57], v[114:115] op_sel:[1,0]
    v_pk_fma_f32 v[126:127], v[22:23], v[126:127], v[146:147] op_sel:[1,1,0] op_sel_hi:[1,0,1] neg_lo:[1,0,0]
    s_add_u32 m0, s63, 65536
    s_add_u32 s61, s8, 65536
    s_nop 0
    buffer_load_dwordx4 v2, s[24:27], s61 offen offset:0 lds
    v_pk_fma_f32 v[40:41], v[72:73], v[112:113], v[116:117] op_sel:[0,1,0] op_sel_hi:[0,0,1] neg_lo:[1,0,0]
    v_pk_fma_f32 v[144:145], v[20:21], v[124:125], v[70:71] op_sel_hi:[0,1,1]
    v_pk_fma_f32 v[56:57], v[88:89], v[114:115], v[118:119] op_sel:[0,1,0] op_sel_hi:[0,0,1] neg_lo:[1,0,0]
    v_pk_fma_f32 v[146:147], v[22:23], v[126:127], v[86:87] op_sel_hi:[0,1,1]
    v_pk_fma_f32 v[72:73], v[72:73], v[112:113], v[120:121] op_sel:[1,1,0] op_sel_hi:[1,0,1] neg_lo:[1,0,0]
    v_pk_fma_f32 v[124:125], v[20:21], v[124:125], v[144:145] op_sel:[1,1,0] op_sel_hi:[1,0,1] neg_lo:[1,0,0]
    v_pk_fma_f32 v[88:89], v[88:89], v[114:115], v[122:123] op_sel:[1,1,0] op_sel_hi:[1,0,1] neg_lo:[1,0,0]
    v_pk_fma_f32 v[126:127], v[22:23], v[126:127], v[146:147] op_sel:[1,1,0] op_sel_hi:[1,0,1] neg_lo:[1,0,0]
    v_pk_mul_f32 v[116:117], v[42:43], v[112:113] op_sel_hi:[0,1]
    v_pk_fma_f32 v[144:145], v[20:21], v[124:125], v[40:41] op_sel_hi:[0,1,1]
    v_pk_mul_f32 v[118:119], v[58:59], v[114:115] op_sel_hi:[0,1]
    v_pk_fma_f32 v[146:147], v[22:23], v[126:127], v[56:57] op_sel_hi:[0,1,1]
    v_pk_mul_f32 v[120:121], v[42:43], v[112:113] op_sel:[1,0]
    v_pk_fma_f32 v[124:125], v[20:21], v[124:125], v[144:145] op_sel:[1,1,0] op_sel_hi:[1,0,1] neg_lo:[1,0,0]
    v_pk_mul_f32 v[122:123], v[58:59], v[114:115] op_sel:[1,0]
    v_pk_fma_f32 v[126:127], v[22:23], v[126:127], v[146:147] op_sel:[1,1,0] op_sel_hi:[1,0,1] neg_lo:[1,0,0]
    v_pk_fma_f32 v[42:43], v[74:75], v[112:113], v[116:117] op_sel:[0,1,0] op_sel_hi:[0,0,1] neg_lo:[1,0,0]
    buffer_load_dwordx4 v3, s[24:27], s61 offen offset:1024 lds
    v_pk_fma_f32 v[144:145], v[20:21], v[124:125], v[72:73] op_sel_hi:[0,1,1]
    v_pk_fma_f32 v[58:59], v[90:91], v[114:115], v[118:119] op_sel:[0,1,0] op_sel_hi:[0,0,1] neg_lo:[1,0,0]
    v_pk_fma_f32 v[146:147], v[22:23], v[126:127], v[88:89] op_sel_hi:[0,1,1]
    v_pk_fma_f32 v[74:75], v[74:75], v[112:113], v[120:121] op_sel:[1,1,0] op_sel_hi:[1,0,1] neg_lo:[1,0,0]
    v_pk_fma_f32 v[124:125], v[20:21], v[124:125], v[144:145] op_sel:[1,1,0] op_sel_hi:[1,0,1] neg_lo:[1,0,0]
    v_pk_fma_f32 v[90:91], v[90:91], v[114:115], v[122:123] op_sel:[1,1,0] op_sel_hi:[1,0,1] neg_lo:[1,0,0]
    v_pk_fma_f32 v[126:127], v[22:23], v[126:127], v[146:147] op_sel:[1,1,0] op_sel_hi:[1,0,1] neg_lo:[1,0,0]
    v_pk_mul_f32 v[116:117], v[44:45], v[112:113] op_sel_hi:[0,1]
    v_pk_fma_f32 v[144:145], v[20:21], v[124:125], v[42:43] op_sel_hi:[0,1,1]
    v_pk_mul_f32 v[118:119], v[60:61], v[114:115] op_sel_hi:[0,1]
    v_pk_fma_f32 v[146:147], v[22:23], v[126:127], v[58:59] op_sel_hi:[0,1,1]
    v_pk_mul_f32 v[120:121], v[44:45], v[112:113] op_sel:[1,0]
    v_pk_fma_f32 v[124:125], v[20:21], v[124:125], v[144:145] op_sel:[1,1,0] op_sel_hi:[1,0,1] neg_lo:[1,0,0]
    v_pk_mul_f32 v[122:123], v[60:61], v[114:115] op_sel:[1,0]
    v_pk_fma_f32 v[126:127], v[22:23], v[126:127], v[146:147] op_sel:[1,1,0] op_sel_hi:[1,0,1] neg_lo:[1,0,0]
    v_pk_fma_f32 v[44:45], v[76:77], v[112:113], v[116:117] op_sel:[0,1,0] op_sel_hi:[0,0,1] neg_lo:[1,0,0]
    v_pk_fma_f32 v[144:145], v[20:21], v[124:125], v[74:75] op_sel_hi:[0,1,1]
    buffer_load_dwordx4 v4, s[24:27], s61 offen offset:2048 lds
    v_pk_fma_f32 v[60:61], v[92:93], v[114:115], v[118:119] op_sel:[0,1,0] op_sel_hi:[0,0,1] neg_lo:[1,0,0]
    v_pk_fma_f32 v[146:147], v[22:23], v[126:127], v[90:91] op_sel_hi:[0,1,1]
    v_pk_fma_f32 v[76:77], v[76:77], v[112:113], v[120:121] op_sel:[1,1,0] op_sel_hi:[1,0,1] neg_lo:[1,0,0]
    v_pk_fma_f32 v[124:125], v[20:21], v[124:125], v[144:145] op_sel:[1,1,0] op_sel_hi:[1,0,1] neg_lo:[1,0,0]
    v_pk_fma_f32 v[92:93], v[92:93], v[114:115], v[122:123] op_sel:[1,1,0] op_sel_hi:[1,0,1] neg_lo:[1,0,0]
    v_pk_fma_f32 v[126:127], v[22:23], v[126:127], v[146:147] op_sel:[1,1,0] op_sel_hi:[1,0,1] neg_lo:[1,0,0]
    v_pk_mul_f32 v[116:117], v[46:47], v[112:113] op_sel_hi:[0,1]
    v_pk_fma_f32 v[144:145], v[20:21], v[124:125], v[44:45] op_sel_hi:[0,1,1]
    v_pk_mul_f32 v[118:119], v[62:63], v[114:115] op_sel_hi:[0,1]
    v_pk_fma_f32 v[146:147], v[22:23], v[126:127], v[60:61] op_sel_hi:[0,1,1]
    v_pk_mul_f32 v[120:121], v[46:47], v[112:113] op_sel:[1,0]
    v_pk_fma_f32 v[124:125], v[20:21], v[124:125], v[144:145] op_sel:[1,1,0] op_sel_hi:[1,0,1] neg_lo:[1,0,0]
    v_pk_mul_f32 v[122:123], v[62:63], v[114:115] op_sel:[1,0]
    v_pk_fma_f32 v[126:127], v[22:23], v[126:127], v[146:147] op_sel:[1,1,0] op_sel_hi:[1,0,1] neg_lo:[1,0,0]
    v_pk_fma_f32 v[46:47], v[78:79], v[112:113], v[116:117] op_sel:[0,1,0] op_sel_hi:[0,0,1] neg_lo:[1,0,0]
    v_pk_fma_f32 v[144:145], v[20:21], v[124:125], v[76:77] op_sel_hi:[0,1,1]
    v_pk_fma_f32 v[62:63], v[94:95], v[114:115], v[118:119] op_sel:[0,1,0] op_sel_hi:[0,0,1] neg_lo:[1,0,0]
    buffer_load_dwordx4 v5, s[24:27], s61 offen offset:3072 lds
    v_pk_fma_f32 v[146:147], v[22:23], v[126:127], v[92:93] op_sel_hi:[0,1,1]
    v_pk_fma_f32 v[78:79], v[78:79], v[112:113], v[120:121] op_sel:[1,1,0] op_sel_hi:[1,0,1] neg_lo:[1,0,0]
    v_pk_fma_f32 v[124:125], v[20:21], v[124:125], v[144:145] op_sel:[1,1,0] op_sel_hi:[1,0,1] neg_lo:[1,0,0]
    v_pk_fma_f32 v[94:95], v[94:95], v[114:115], v[122:123] op_sel:[1,1,0] op_sel_hi:[1,0,1] neg_lo:[1,0,0]
    v_pk_fma_f32 v[126:127], v[22:23], v[126:127], v[146:147] op_sel:[1,1,0] op_sel_hi:[1,0,1] neg_lo:[1,0,0]
    v_pk_fma_f32 v[144:145], v[20:21], v[124:125], v[46:47] op_sel_hi:[0,1,1]
    v_pk_fma_f32 v[146:147], v[22:23], v[126:127], v[62:63] op_sel_hi:[0,1,1]
    v_pk_fma_f32 v[124:125], v[20:21], v[124:125], v[144:145] op_sel:[1,1,0] op_sel_hi:[1,0,1] neg_lo:[1,0,0]
    v_pk_fma_f32 v[126:127], v[22:23], v[126:127], v[146:147] op_sel:[1,1,0] op_sel_hi:[1,0,1] neg_lo:[1,0,0]
    v_pk_fma_f32 v[144:145], v[20:21], v[124:125], v[78:79] op_sel_hi:[0,1,1]
    v_pk_fma_f32 v[146:147], v[22:23], v[126:127], v[94:95] op_sel_hi:[0,1,1]
    v_pk_fma_f32 v[124:125], v[20:21], v[124:125], v[144:145] op_sel:[1,1,0] op_sel_hi:[1,0,1] neg_lo:[1,0,0]
    v_pk_fma_f32 v[126:127], v[22:23], v[126:127], v[146:147] op_sel:[1,1,0] op_sel_hi:[1,0,1] neg_lo:[1,0,0]
    v_mov_b64 v[24:25], v[124:125]
    v_mov_b64 v[26:27], v[126:127]
    v_accvgpr_read_b32 v148, a92
    v_accvgpr_read_b32 v149, a93
    v_accvgpr_read_b32 v150, a110
    v_accvgpr_read_b32 v151, a111
    v_accvgpr_read_b32 v152, a94
    v_accvgpr_read_b32 v153, a95
    v_accvgpr_read_b32 v154, a112
    v_accvgpr_read_b32 v155, a113
    v_permlane16_swap_b32 v24, v124
    v_permlane16_swap_b32 v25, v125
    v_permlane16_swap_b32 v26, v126
    v_permlane16_swap_b32 v27, v127
    v_pk_fma_f32 v[124:125], v[148:149], v[24:25], v[124:125] op_sel_hi:[0,1,1]
    v_pk_fma_f32 v[126:127], v[150:151], v[26:27], v[126:127] op_sel_hi:[0,1,1]
    v_pk_fma_f32 v[124:125], v[148:149], v[24:25], v[124:125] op_sel:[1,1,0] op_sel_hi:[1,0,1] neg_lo:[1,0,0]
    v_pk_fma_f32 v[126:127], v[150:151], v[26:27], v[126:127] op_sel:[1,1,0] op_sel_hi:[1,0,1] neg_lo:[1,0,0]
    v_mov_b64 v[120:121], v[124:125]
    v_mov_b64 v[122:123], v[126:127]
    v_and_b32 v17, 0xf0, v1
    s_lshl_b32 s65, s3, 8
    v_permlane32_swap_b32 v120, v124
    v_permlane32_swap_b32 v121, v125
    v_permlane32_swap_b32 v122, v126
    v_permlane32_swap_b32 v123, v127
    v_add_u32 v16, 131072, v17
    v_add_u32 v15, s65, v16
    v_pk_fma_f32 v[124:125], v[152:153], v[120:121], v[124:125] op_sel_hi:[0,1,1]
    v_pk_fma_f32 v[126:127], v[154:155], v[122:123], v[126:127] op_sel_hi:[0,1,1]
    v_pk_fma_f32 v[124:125], v[152:153], v[120:121], v[124:125] op_sel:[1,1,0] op_sel_hi:[1,0,1] neg_lo:[1,0,0]
    v_pk_fma_f32 v[126:127], v[154:155], v[122:123], v[126:127] op_sel:[1,1,0] op_sel_hi:[1,0,1] neg_lo:[1,0,0]
    ds_write_b128 v15, v[124:127]
    v_cndmask_b32 v120, 0, v120, s[68:69]
    v_cndmask_b32 v121, 0, v121, s[68:69]
    v_cndmask_b32 v122, 0, v122, s[68:69]
    v_cndmask_b32 v123, 0, v123, s[68:69]
    v_pk_fma_f32 v[24:25], v[148:149], v[120:121], v[24:25] op_sel_hi:[0,1,1]
    v_pk_fma_f32 v[26:27], v[150:151], v[122:123], v[26:27] op_sel_hi:[0,1,1]
    v_pk_fma_f32 v[24:25], v[148:149], v[120:121], v[24:25] op_sel:[1,1,0] op_sel_hi:[1,0,1] neg_lo:[1,0,0]
    v_pk_fma_f32 v[26:27], v[150:151], v[122:123], v[26:27] op_sel:[1,1,0] op_sel_hi:[1,0,1] neg_lo:[1,0,0]
    v_cndmask_b32 v24, v120, v24, s[66:67]
    v_cndmask_b32 v25, v121, v25, s[66:67]
    v_cndmask_b32 v26, v122, v26, s[66:67]
    v_cndmask_b32 v27, v123, v27, s[66:67]
    v_accvgpr_read_b32 v148, a96
    v_accvgpr_read_b32 v149, a97
    v_accvgpr_read_b32 v150, a114
    v_accvgpr_read_b32 v151, a115
    v_accvgpr_read_b32 v152, a98
    v_accvgpr_read_b32 v153, a99
    v_accvgpr_read_b32 v154, a116
    v_accvgpr_read_b32 v155, a117
    s_waitcnt vmcnt(7)
    v_cmp_ne_u32 vcc, 1, v31
    s_and_b64 vcc, vcc, 0xff
    s_cbranch_vccnz L_far4
L_back4:
    s_xor_b32 s60, s14, 0
    s_add_u32 s60, s60, s73
    s_nop 0
    buffer_load_dwordx4 a[128:131], v1, s[4:7], s60 offen offset:0 sc1
    buffer_load_dwordx4 a[132:135], v1, s[4:7], s60 offen offset:1024 sc1
    buffer_load_dwordx4 a[136:139], v1, s[4:7], s60 offen offset:2048 sc1
    buffer_load_dwordx4 a[140:143], v1, s[4:7], s60 offen offset:3072 sc1
    v_accvgpr_read_b32 v176, a0
    v_accvgpr_read_b32 v177, a1
    v_accvgpr_read_b32 v178, a2
    v_accvgpr_read_b32 v179, a3
    v_accvgpr_read_b32 v192, a16
    v_accvgpr_read_b32 v193, a17
    v_accvgpr_read_b32 v194, a18
L_pad6:
    s_cbranch_execz L_pad10
    v_accvgpr_read_b32 v195, a19
    v_pk_mul_f32 v[240:241], v[224:225], v[240:241]
    v_pk_mul_f32 v[242:243], v[226:227], v[242:243]
    v_pk_mul_f32 v[192:193], v[176:177], v[192:193]
    v_pk_mul_f32 v[194:195], v[178:179], v[194:195]
    v_pk_mul_f32 v[224:225], v[224:225], s[52:53]
    s_xor_b32 s60, s14, 4096
    s_add_u32 s60, s60, s73
    s_nop 0
    buffer_load_dwordx4 a[144:147], v1, s[4:7], s60 offen offset:0 sc1
    v_pk_mul_f32 v[226:227], v[226:227], s[52:53]
    v_pk_mul_f32 v[176:177], v[176:177], s[52:53]
    v_pk_mul_f32 v[178:179], v[178:179], s[52:53]
    v_exp_f32 v224, v224
    v_exp_f32 v225, v225
    v_exp_f32 v226, v226
    v_exp_f32 v227, v227
    v_exp_f32 v176, v176
    v_exp_f32 v177, v177
    v_exp_f32 v178, v178
    v_exp_f32 v179, v179
    v_pk_add_f32 v[224:225], v[224:225], 1.0 op_sel_hi:[1,0]
    v_pk_add_f32 v[226:227], v[226:227], 1.0 op_sel_hi:[1,0]
    buffer_load_dwordx4 a[148:151], v1, s[4:7], s60 offen offset:1024 sc1
    v_pk_add_f32 v[176:177], v[176:177], 1.0 op_sel_hi:[1,0]
    v_pk_add_f32 v[178:179], v[178:179], 1.0 op_sel_hi:[1,0]
    v_rcp_f32 v224, v224
    v_rcp_f32 v225, v225
    v_rcp_f32 v226, v226
    v_rcp_f32 v227, v227
    v_rcp_f32 v176, v176
    v_rcp_f32 v177, v177
    v_rcp_f32 v178, v178
    v_rcp_f32 v179, v179
    v_pk_mul_f32 v[240:241], v[240:241], v[224:225]
    v_pk_mul_f32 v[242:243], v[242:243], v[226:227]
    v_pk_mul_f32 v[192:193], v[192:193], v[176:177]
    buffer_load_dwordx4 a[152:155], v1, s[4:7], s60 offen offset:2048 sc1
    v_pk_mul_f32 v[194:195], v[194:195], v[178:179]
    v_cvt_pk_bf16_f32 v224, v240, v241
    v_cvt_pk_bf16_f32 v225, v242, v243
    v_cvt_pk_bf16_f32 v226, v192, v193
    v_cvt_pk_bf16_f32 v227, v194, v195
    buffer_store_dwordx4 v[224:227], v1, s[4:7], s22 offen offset:0 sc1
    s_waitcnt lgkmcnt(0)
    s_barrier
    ds_read_b128 v[128:131], v16 offset:0
    ds_read_b128 v[132:135], v16 offset:256
    ds_read_b128 v[136:139], v16 offset:512
    ds_read_b128 v[140:143], v16 offset:768
    s_sub_u32 s65, 7, s56
    s_lshl_b32 s65, s65, 8
    v_add_u32 v18, s65, v1
    v_lshl_add_u32 v29, v0, 8, s65
    v_add_u32 v17, s65, v17
    v_and_b32 v16, 0x300, v1
    v_lshl_add_u32 v17, v16, 3, v17
    s_lshl_b32 s65, s3, 13
    v_add_u32 v17, s65, v17
    v_lshrrev_b32 v15, 2, v0
    v_and_b32 v16, 7, v15
    v_lshlrev_b32 v15, 8, v15
    v_lshl_add_u32 v15, v16, 5, v15
    v_and_b32 v16, 3, v0
    v_lshl_add_u32 v6, v16, 3, v15
    v_xor_b32 v7, 32, v6
    v_xor_b32 v8, 64, v6
    v_xor_b32 v9, 96, v6
    v_xor_b32 v10, 128, v6
    v_xor_b32 v11, 160, v6
    v_xor_b32 v12, 192, v6
    v_xor_b32 v13, 224, v6
    s_waitcnt lgkmcnt(2)
    v_pk_fma_f32 v[132:133], v[148:149], v[128:129], v[132:133] op_sel_hi:[0,1,1]
    v_pk_fma_f32 v[134:135], v[150:151], v[130:131], v[134:135] op_sel_hi:[0,1,1]
    v_pk_fma_f32 v[132:133], v[148:149], v[128:129], v[132:133] op_sel:[1,1,0] op_sel_hi:[1,0,1] neg_lo:[1,0,0]
    v_pk_fma_f32 v[134:135], v[150:151], v[130:131], v[134:135] op_sel:[1,1,0] op_sel_hi:[1,0,1] neg_lo:[1,0,0]
    s_waitcnt lgkmcnt(1)
    v_pk_fma_f32 v[136:137], v[148:149], v[132:133], v[136:137] op_sel_hi:[0,1,1]
    v_pk_fma_f32 v[138:139], v[150:151], v[134:135], v[138:139] op_sel_hi:[0,1,1]
    v_pk_fma_f32 v[136:137], v[148:149], v[132:133], v[136:137] op_sel:[1,1,0] op_sel_hi:[1,0,1] neg_lo:[1,0,0]
    v_pk_fma_f32 v[138:139], v[150:151], v[134:135], v[138:139] op_sel:[1,1,0] op_sel_hi:[1,0,1] neg_lo:[1,0,0]
    s_waitcnt lgkmcnt(0)
    v_pk_fma_f32 v[140:141], v[148:149], v[136:137], v[140:141] op_sel_hi:[0,1,1]
    v_pk_fma_f32 v[142:143], v[150:151], v[138:139], v[142:143] op_sel_hi:[0,1,1]
    v_pk_fma_f32 v[140:141], v[148:149], v[136:137], v[140:141] op_sel:[1,1,0] op_sel_hi:[1,0,1] neg_lo:[1,0,0]
    v_pk_fma_f32 v[142:143], v[150:151], v[138:139], v[142:143] op_sel:[1,1,0] op_sel_hi:[1,0,1] neg_lo:[1,0,0]
    v_and_b32 v140, -2, v140
    v_and_b32 v141, -2, v141
    v_and_b32 v142, -2, v142
    v_and_b32 v143, -2, v143
    buffer_store_dwordx4 v[140:143], v17, s[44:47], 0 offen sc1
    v_cndmask_b32 v128, 0, v128, s[16:17]
    v_cndmask_b32 v132, v132, v136, s[16:17]
    v_cndmask_b32 v129, 0, v129, s[16:17]
    v_cndmask_b32 v133, v133, v137, s[16:17]
    v_cndmask_b32 v130, 0, v130, s[16:17]
    v_cndmask_b32 v134, v134, v138, s[16:17]
    v_cndmask_b32 v131, 0, v131, s[16:17]
    v_cndmask_b32 v135, v135, v139, s[16:17]
    v_cndmask_b32 v128, v128, v132, s[18:19]
    v_cndmask_b32 v129, v129, v133, s[18:19]
    v_cndmask_b32 v130, v130, v134, s[18:19]
    v_cndmask_b32 v131, v131, v135, s[18:19]
    v_pk_fma_f32 v[24:25], v[152:153], v[128:129], v[24:25] op_sel_hi:[0,1,1]
    v_pk_fma_f32 v[26:27], v[154:155], v[130:131], v[26:27] op_sel_hi:[0,1,1]
    v_pk_fma_f32 v[24:25], v[152:153], v[128:129], v[24:25] op_sel:[1,1,0] op_sel_hi:[1,0,1] neg_lo:[1,0,0]
    v_pk_fma_f32 v[26:27], v[154:155], v[130:131], v[26:27] op_sel:[1,1,0] op_sel_hi:[1,0,1] neg_lo:[1,0,0]
    v_mov_b32 v19, 1
    buffer_store_dword v19, v28, s[4:7], s75 offen offset:128 sc1
    v_accvgpr_read_b32 v180, a4
    v_accvgpr_read_b32 v181, a5
    v_accvgpr_read_b32 v182, a6
    v_accvgpr_read_b32 v183, a7
    v_accvgpr_read_b32 v196, a20
    v_accvgpr_read_b32 v197, a21
    v_accvgpr_read_b32 v198, a22
    v_accvgpr_read_b32 v199, a23
    v_pk_mul_f32 v[244:245], v[228:229], v[244:245]
    v_pk_mul_f32 v[246:247], v[230:231], v[246:247]
    v_pk_mul_f32 v[196:197], v[180:181], v[196:197]
    v_pk_mul_f32 v[198:199], v[182:183], v[198:199]
    v_pk_mul_f32 v[228:229], v[228:229], s[52:53]
    buffer_load_dwordx4 a[156:159], v1, s[4:7], s60 offen offset:3072 sc1
    v_pk_mul_f32 v[230:231], v[230:231], s[52:53]
    v_pk_mul_f32 v[180:181], v[180:181], s[52:53]
    v_pk_mul_f32 v[182:183], v[182:183], s[52:53]
    v_exp_f32 v228, v228
    v_exp_f32 v229, v229
    v_exp_f32 v230, v230
    v_exp_f32 v231, v231
    v_exp_f32 v180, v180
    v_exp_f32 v181, v181
    v_exp_f32 v182, v182
    v_exp_f32 v183, v183
    v_pk_add_f32 v[228:229], v[228:229], 1.0 op_sel_hi:[1,0]
    v_pk_add_f32 v[230:231], v[230:231], 1.0 op_sel_hi:[1,0]
    s_xor_b32 s60, s14, 8192
    s_add_u32 s60, s60, s73
    s_nop 0
    buffer_load_dwordx4 a[160:163], v1, s[4:7], s60 offen offset:0 sc1
    v_pk_add_f32 v[180:181], v[180:181], 1.0 op_sel_hi:[1,0]
    v_pk_add_f32 v[182:183], v[182:183], 1.0 op_sel_hi:[1,0]
    v_rcp_f32 v228, v228
    v_rcp_f32 v229, v229
    v_rcp_f32 v230, v230
    v_rcp_f32 v231, v231
    v_rcp_f32 v180, v180
    v_rcp_f32 v181, v181
    v_rcp_f32 v182, v182
    v_rcp_f32 v183, v183
    v_pk_mul_f32 v[244:245], v[244:245], v[228:229]
    v_pk_mul_f32 v[246:247], v[246:247], v[230:231]
    v_pk_mul_f32 v[196:197], v[196:197], v[180:181]
    buffer_load_dwordx4 a[164:167], v1, s[4:7], s60 offen offset:1024 sc1
    v_pk_mul_f32 v[198:199], v[198:199], v[182:183]
    v_cvt_pk_bf16_f32 v228, v244, v245
    v_cvt_pk_bf16_f32 v229, v246, v247
    v_cvt_pk_bf16_f32 v230, v196, v197
    v_cvt_pk_bf16_f32 v231, v198, v199
    buffer_store_dwordx4 v[228:231], v1, s[4:7], s22 offen offset:1024 sc1
    v_accvgpr_read_b32 v184, a8
    v_accvgpr_read_b32 v185, a9
    v_accvgpr_read_b32 v186, a10
    v_accvgpr_read_b32 v187, a11
    v_accvgpr_read_b32 v200, a24
    v_accvgpr_read_b32 v201, a25
    v_accvgpr_read_b32 v202, a26
    v_accvgpr_read_b32 v203, a27
    v_pk_mul_f32 v[248:249], v[232:233], v[248:249]
    v_pk_mul_f32 v[250:251], v[234:235], v[250:251]
    v_pk_mul_f32 v[200:201], v[184:185], v[200:201]
    v_pk_mul_f32 v[202:203], v[186:187], v[202:203]
    v_pk_mul_f32 v[232:233], v[232:233], s[52:53]
    buffer_load_dwordx4 a[168:171], v1, s[4:7], s60 offen offset:2048 sc1
    v_pk_mul_f32 v[234:235], v[234:235], s[52:53]
    v_pk_mul_f32 v[184:185], v[184:185], s[52:53]
    v_pk_mul_f32 v[186:187], v[186:187], s[52:53]
    v_exp_f32 v232, v232
    v_exp_f32 v233, v233
    v_exp_f32 v234, v234
    v_exp_f32 v235, v235
    v_exp_f32 v184, v184
    v_exp_f32 v185, v185
    v_exp_f32 v186, v186
    v_exp_f32 v187, v187
    v_pk_add_f32 v[232:233], v[232:233], 1.0 op_sel_hi:[1,0]
    v_pk_add_f32 v[234:235], v[234:235], 1.0 op_sel_hi:[1,0]
    buffer_load_dwordx4 a[172:175], v1, s[4:7], s60 offen offset:3072 sc1
    v_pk_add_f32 v[184:185], v[184:185], 1.0 op_sel_hi:[1,0]
    v_pk_add_f32 v[186:187], v[186:187], 1.0 op_sel_hi:[1,0]
    v_rcp_f32 v232, v232
    v_rcp_f32 v233, v233
    v_rcp_f32 v234, v234
    v_rcp_f32 v235, v235
    v_rcp_f32 v184, v184
    v_rcp_f32 v185, v185
    v_rcp_f32 v186, v186
    v_rcp_f32 v187, v187
    v_pk_mul_f32 v[248:249], v[248:249], v[232:233]
    v_pk_mul_f32 v[250:251], v[250:251], v[234:235]
    v_pk_mul_f32 v[200:201], v[200:201], v[184:185]
    s_xor_b32 s60, s14, 12288
    s_add_u32 s60, s60, s73
    s_nop 0
    buffer_load_dwordx4 a[176:179], v1, s[4:7], s60 offen offset:0 sc1
    v_pk_mul_f32 v[202:203], v[202:203], v[186:187]
    v_cvt_pk_bf16_f32 v232, v248, v249
    v_cvt_pk_bf16_f32 v233, v250, v251
    v_cvt_pk_bf16_f32 v234, v200, v201
    v_cvt_pk_bf16_f32 v235, v202, v203
    buffer_store_dwordx4 v[232:235], v1, s[4:7], s22 offen offset:2048 sc1
    v_accvgpr_read_b32 v188, a12
    v_accvgpr_read_b32 v189, a13
    v_accvgpr_read_b32 v190, a14
    v_accvgpr_read_b32 v191, a15
    v_accvgpr_read_b32 v204, a28
    v_accvgpr_read_b32 v205, a29
    v_accvgpr_read_b32 v206, a30
    v_accvgpr_read_b32 v207, a31
    v_pk_mul_f32 v[252:253], v[236:237], v[252:253]
    v_pk_mul_f32 v[254:255], v[238:239], v[254:255]
    v_pk_mul_f32 v[204:205], v[188:189], v[204:205]
    v_pk_mul_f32 v[206:207], v[190:191], v[206:207]
    v_pk_mul_f32 v[236:237], v[236:237], s[52:53]
    buffer_load_dwordx4 a[180:183], v1, s[4:7], s60 offen offset:1024 sc1
    v_pk_mul_f32 v[238:239], v[238:239], s[52:53]
    v_pk_mul_f32 v[188:189], v[188:189], s[52:53]
    v_pk_mul_f32 v[190:191], v[190:191], s[52:53]
    v_exp_f32 v236, v236
    v_exp_f32 v237, v237
    v_exp_f32 v238, v238
    v_exp_f32 v239, v239
    v_exp_f32 v188, v188
    v_exp_f32 v189, v189
    v_exp_f32 v190, v190
    v_exp_f32 v191, v191
    v_pk_add_f32 v[236:237], v[236:237], 1.0 op_sel_hi:[1,0]
    v_pk_add_f32 v[238:239], v[238:239], 1.0 op_sel_hi:[1,0]
    buffer_load_dwordx4 a[184:187], v1, s[4:7], s60 offen offset:2048 sc1
    v_pk_add_f32 v[188:189], v[188:189], 1.0 op_sel_hi:[1,0]
    v_pk_add_f32 v[190:191], v[190:191], 1.0 op_sel_hi:[1,0]
    v_rcp_f32 v236, v236
    v_rcp_f32 v237, v237
    v_rcp_f32 v238, v238
    v_rcp_f32 v239, v239
    v_rcp_f32 v188, v188
    v_rcp_f32 v189, v189
    v_rcp_f32 v190, v190
    v_rcp_f32 v191, v191
    v_pk_mul_f32 v[252:253], v[252:253], v[236:237]
    v_pk_mul_f32 v[254:255], v[254:255], v[238:239]
    v_pk_mul_f32 v[204:205], v[204:205], v[188:189]
    buffer_load_dwordx4 a[188:191], v1, s[4:7], s60 offen offset:3072 sc1
    v_pk_mul_f32 v[206:207], v[206:207], v[190:191]
    v_cvt_pk_bf16_f32 v236, v252, v253
    v_cvt_pk_bf16_f32 v237, v254, v255
    v_cvt_pk_bf16_f32 v238, v204, v205
    v_cvt_pk_bf16_f32 v239, v206, v207
    buffer_store_dwordx4 v[236:239], v1, s[4:7], s22 offen offset:3072 sc1
    v_accvgpr_read_b32 v176, a32
    v_accvgpr_read_b32 v177, a33
    v_accvgpr_read_b32 v178, a34
    v_accvgpr_read_b32 v179, a35
    v_accvgpr_read_b32 v180, a36
    v_accvgpr_read_b32 v181, a37
    v_accvgpr_read_b32 v182, a38
    v_accvgpr_read_b32 v183, a39
    v_accvgpr_read_b32 v192, a48
    v_accvgpr_read_b32 v193, a49
    v_accvgpr_read_b32 v194, a50
    v_accvgpr_read_b32 v195, a51
    v_accvgpr_read_b32 v196, a52
    s_add_u32 m0, s63, 81920
    s_add_u32 s61, s9, 65536
    s_nop 0
    buffer_load_dwordx4 v2, s[24:27], s61 offen offset:0 lds
    v_accvgpr_read_b32 v197, a53
    v_accvgpr_read_b32 v198, a54
    v_accvgpr_read_b32 v199, a55
    v_pk_mul_f32 v[192:193], v[176:177], v[192:193]
    v_pk_mul_f32 v[194:195], v[178:179], v[194:195]
    v_pk_mul_f32 v[196:197], v[180:181], v[196:197]
    v_pk_mul_f32 v[198:199], v[182:183], v[198:199]
    v_pk_mul_f32 v[176:177], v[176:177], s[52:53]
    v_pk_mul_f32 v[178:179], v[178:179], s[52:53]
    v_pk_mul_f32 v[180:181], v[180:181], s[52:53]
    v_pk_mul_f32 v[182:183], v[182:183], s[52:53]
    v_exp_f32 v176, v176
    v_exp_f32 v177, v177
    buffer_load_dwordx4 v3, s[24:27], s61 offen offset:1024 lds
    v_exp_f32 v178, v178
    v_exp_f32 v179, v179
    v_exp_f32 v180, v180
    v_exp_f32 v181, v181
    v_exp_f32 v182, v182
    v_exp_f32 v183, v183
    v_pk_add_f32 v[176:177], v[176:177], 1.0 op_sel_hi:[1,0]
    v_pk_add_f32 v[178:179], v[178:179], 1.0 op_sel_hi:[1,0]
    v_pk_add_f32 v[180:181], v[180:181], 1.0 op_sel_hi:[1,0]
    v_pk_add_f32 v[182:183], v[182:183], 1.0 op_sel_hi:[1,0]
    v_rcp_f32 v176, v176
    v_rcp_f32 v177, v177
    v_rcp_f32 v178, v178
    buffer_load_dwordx4 v4, s[24:27], s61 offen offset:2048 lds
    v_rcp_f32 v179, v179
    v_rcp_f32 v180, v180
    v_rcp_f32 v181, v181
    v_rcp_f32 v182, v182
    v_rcp_f32 v183, v183
    v_pk_mul_f32 v[192:193], v[192:193], v[176:177]
    v_pk_mul_f32 v[194:195], v[194:195], v[178:179]
    v_pk_mul_f32 v[196:197], v[196:197], v[180:181]
    v_pk_mul_f32 v[198:199], v[198:199], v[182:183]
    v_cvt_pk_bf16_f32 v176, v192, v193
    v_cvt_pk_bf16_f32 v177, v194, v195
    v_cvt_pk_bf16_f32 v178, v196, v197
    v_cvt_pk_bf16_f32 v179, v198, v199
    buffer_load_dwordx4 v5, s[24:27], s61 offen offset:3072 lds
    buffer_store_dwordx4 v[176:179], v1, s[4:7], s23 offen offset:0 sc1
    v_accvgpr_read_b32 v184, a40
    v_accvgpr_read_b32 v185, a41
    v_accvgpr_read_b32 v186, a42
    v_accvgpr_read_b32 v187, a43
    v_accvgpr_read_b32 v188, a44
    v_accvgpr_read_b32 v189, a45
    v_accvgpr_read_b32 v190, a46
    v_accvgpr_read_b32 v191, a47
    v_accvgpr_read_b32 v200, a56
    v_accvgpr_read_b32 v201, a57
    v_accvgpr_read_b32 v202, a58
    v_accvgpr_read_b32 v203, a59
    v_accvgpr_read_b32 v204, a60
    v_accvgpr_read_b32 v205, a61
    v_accvgpr_read_b32 v206, a62
    v_accvgpr_read_b32 v207, a63
    v_pk_mul_f32 v[200:201], v[184:185], v[200:201]
    v_pk_mul_f32 v[202:203], v[186:187], v[202:203]
    v_pk_mul_f32 v[204:205], v[188:189], v[204:205]
    v_pk_mul_f32 v[206:207], v[190:191], v[206:207]
    v_pk_mul_f32 v[184:185], v[184:185], s[52:53]
    v_pk_mul_f32 v[186:187], v[186:187], s[52:53]
    v_pk_mul_f32 v[188:189], v[188:189], s[52:53]
    v_pk_mul_f32 v[190:191], v[190:191], s[52:53]
    v_exp_f32 v184, v184
    v_exp_f32 v185, v185
    v_exp_f32 v186, v186
    v_exp_f32 v187, v187
    v_exp_f32 v188, v188
    v_exp_f32 v189, v189
    v_exp_f32 v190, v190
    v_exp_f32 v191, v191
    v_pk_add_f32 v[184:185], v[184:185], 1.0 op_sel_hi:[1,0]
    v_pk_add_f32 v[186:187], v[186:187], 1.0 op_sel_hi:[1,0]
    v_pk_add_f32 v[188:189], v[188:189], 1.0 op_sel_hi:[1,0]
    v_pk_add_f32 v[190:191], v[190:191], 1.0 op_sel_hi:[1,0]
    v_rcp_f32 v184, v184
    v_rcp_f32 v185, v185
    v_rcp_f32 v186, v186
    v_rcp_f32 v187, v187
    v_rcp_f32 v188, v188
    v_rcp_f32 v189, v189
    v_rcp_f32 v190, v190
    v_rcp_f32 v191, v191
    v_pk_mul_f32 v[200:201], v[200:201], v[184:185]
    v_pk_mul_f32 v[202:203], v[202:203], v[186:187]
    v_pk_mul_f32 v[204:205], v[204:205], v[188:189]
    v_pk_mul_f32 v[206:207], v[206:207], v[190:191]
    v_cvt_pk_bf16_f32 v184, v200, v201
    v_cvt_pk_bf16_f32 v185, v202, v203
    v_cvt_pk_bf16_f32 v186, v204, v205
    v_cvt_pk_bf16_f32 v187, v206, v207
    buffer_store_dwordx4 v[184:187], v1, s[4:7], s23 offen offset:2048 sc1
    ds_read_b64_tr_b16 a[64:65], v6 offset:0
    ds_read_b64_tr_b16 a[66:67], v6 offset:4096
    ds_read_b64_tr_b16 a[68:69], v6 offset:8192
    ds_read_b64_tr_b16 a[70:71], v6 offset:12288
    ds_read_b64_tr_b16 a[72:73], v7 offset:0
    ds_read_b64_tr_b16 a[74:75], v7 offset:4096
    ds_read_b64_tr_b16 a[76:77], v7 offset:8192
    ds_read_b64_tr_b16 a[78:79], v7 offset:12288
    s_waitcnt vmcnt(17) lgkmcnt(4)
    v_mfma_f32_16x16x32_bf16 v[96:99], a[64:67], a[128:131], 0
    ds_read_b64_tr_b16 a[80:81], v8 offset:0
    v_mfma_f32_16x16x32_bf16 v[96:99], a[68:71], a[144:147], v[96:99]
    ds_read_b64_tr_b16 a[82:83], v8 offset:4096
    v_mfma_f32_16x16x32_bf16 v[100:103], a[68:71], a[148:151], 0
    ds_read_b64_tr_b16 a[84:85], v8 offset:8192
    v_mfma_f32_16x16x32_bf16 v[100:103], a[64:67], a[132:135], v[100:103]
    ds_read_b64_tr_b16 a[86:87], v8 offset:12288
    v_mfma_f32_16x16x32_bf16 v[104:107], a[64:67], a[136:139], 0
    v_mov_b32 v31, 0
    buffer_atomic_add v31, v30, s[4:7], s74 offen offset:128 sc0 sc1
    v_mfma_f32_16x16x32_bf16 v[104:107], a[68:71], a[152:155], v[104:107]
    s_xor_b32 s60, s14, 16384
    s_add_u32 s60, s60, s73
    v_mfma_f32_16x16x32_bf16 v[108:111], a[68:71], a[156:159], 0
    buffer_load_dwordx4 a[192:195], v1, s[4:7], s60 offen offset:0 sc1
    v_mfma_f32_16x16x32_bf16 v[108:111], a[64:67], a[140:143], v[108:111]
    buffer_load_dwordx4 v[240:243], v18, s[44:47], 0 offen offset:256 sc1
    s_waitcnt lgkmcnt(0)
    v_mfma_f32_16x16x32_bf16 v[124:127], a[72:75], a[140:143], 0
    ds_read_b64_tr_b16 a[64:65], v9 offset:0
    v_mfma_f32_16x16x32_bf16 v[124:127], a[76:79], a[156:159], v[124:127]
    ds_read_b64_tr_b16 a[66:67], v9 offset:4096
    v_mfma_f32_16x16x32_bf16 v[120:123], a[76:79], a[152:155], 0
    ds_read_b64_tr_b16 a[68:69], v9 offset:8192
    v_mfma_f32_16x16x32_bf16 v[120:123], a[72:75], a[136:139], v[120:123]
    ds_read_b64_tr_b16 a[70:71], v9 offset:12288
    v_mfma_f32_16x16x32_bf16 v[116:119], a[72:75], a[132:135], 0
    buffer_load_dwordx4 a[196:199], v1, s[4:7], s60 offen offset:1024 sc1
    v_mfma_f32_16x16x32_bf16 v[116:119], a[76:79], a[148:151], v[116:119]
    buffer_load_dwordx4 v[244:247], v18, s[44:47], 0 offen offset:1280 sc1
    v_mfma_f32_16x16x32_bf16 v[112:115], a[76:79], a[144:147], 0
    buffer_load_dwordx4 a[200:203], v1, s[4:7], s60 offen offset:2048 sc1
    v_mfma_f32_16x16x32_bf16 v[112:115], a[72:75], a[128:131], v[112:115]
    v_lshrrev_b32 v252, 4, v0
    v_lshrrev_b32 v253, 3, v0
    v_mfma_f32_16x16x32_bf16 v[128:131], a[80:83], a[128:131], 0
    ds_read_b64_tr_b16 a[72:73], v10 offset:0
    v_and_b32 v254, 7, v0
    v_mfma_f32_16x16x32_bf16 v[128:131], a[84:87], a[144:147], v[128:131]
    ds_read_b64_tr_b16 a[74:75], v10 offset:4096
    v_xor_b32 v254, v254, v252
    v_mfma_f32_16x16x32_bf16 v[132:135], a[84:87], a[148:151], 0
    ds_read_b64_tr_b16 a[76:77], v10 offset:8192
    v_lshlrev_b32 v253, 11, v253
    v_mfma_f32_16x16x32_bf16 v[132:135], a[80:83], a[132:135], v[132:135]
    ds_read_b64_tr_b16 a[78:79], v10 offset:12288
    v_lshl_add_u32 v14, v254, 4, v253
    v_mfma_f32_16x16x32_bf16 v[136:139], a[80:83], a[136:139], 0
    v_xor_b32 v15, 64, v14
    v_add_u32 v16, 30720, v14
    v_mfma_f32_16x16x32_bf16 v[136:139], a[84:87], a[152:155], v[136:139]
    buffer_load_dwordx4 a[204:207], v1, s[4:7], s60 offen offset:3072 sc1
    v_mfma_f32_16x16x32_bf16 v[140:143], a[84:87], a[156:159], 0
    v_add_u32 v17, 46080, v15
    v_add_u32 v15, 15360, v15
    v_mfma_f32_16x16x32_bf16 v[140:143], a[80:83], a[140:143], v[140:143]
    v_accvgpr_read_b32 v248, a104
    v_accvgpr_read_b32 v249, a105
    s_waitcnt lgkmcnt(0)
    v_mfma_f32_16x16x32_bf16 v[156:159], a[64:67], a[140:143], 0
    ds_read_b64_tr_b16 a[80:81], v11 offset:0
    v_accvgpr_read_b32 v250, a122
    v_mfma_f32_16x16x32_bf16 v[156:159], a[68:71], a[156:159], v[156:159]
    ds_read_b64_tr_b16 a[82:83], v11 offset:4096
    v_accvgpr_read_b32 v251, a123
    v_mfma_f32_16x16x32_bf16 v[152:155], a[68:71], a[152:155], 0
    ds_read_b64_tr_b16 a[84:85], v11 offset:8192
    v_accvgpr_read_b32 v252, a100
    v_mfma_f32_16x16x32_bf16 v[152:155], a[64:67], a[136:139], v[152:155]
    ds_read_b64_tr_b16 a[86:87], v11 offset:12288
    s_xor_b32 s60, s14, 20480
    s_add_u32 s60, s60, s73
    v_mfma_f32_16x16x32_bf16 v[148:151], a[64:67], a[132:135], 0
    buffer_load_dwordx4 a[208:211], v1, s[4:7], s60 offen offset:0 sc1
    v_mfma_f32_16x16x32_bf16 v[148:151], a[68:71], a[148:151], v[148:151]
    v_accvgpr_read_b32 v253, a101
    v_accvgpr_read_b32 v254, a118
    v_mfma_f32_16x16x32_bf16 v[144:147], a[68:71], a[144:147], 0
    buffer_load_dwordx4 a[212:215], v1, s[4:7], s60 offen offset:1024 sc1
    v_mfma_f32_16x16x32_bf16 v[144:147], a[64:67], a[128:131], v[144:147]
    v_accvgpr_read_b32 v255, a119
    v_mfma_f32_16x16x32_bf16 v[160:163], a[72:75], a[128:131], 0
    ds_read_b64_tr_b16 a[64:65], v12 offset:0
    v_mfma_f32_16x16x32_bf16 v[160:163], a[76:79], a[144:147], v[160:163]
    ds_read_b64_tr_b16 a[66:67], v12 offset:4096
    v_mfma_f32_16x16x32_bf16 v[164:167], a[76:79], a[148:151], 0
    ds_read_b64_tr_b16 a[68:69], v12 offset:8192
    v_mfma_f32_16x16x32_bf16 v[164:167], a[72:75], a[132:135], v[164:167]
    ds_read_b64_tr_b16 a[70:71], v12 offset:12288
    v_mfma_f32_16x16x32_bf16 v[168:171], a[72:75], a[136:139], 0
    v_mfma_f32_16x16x32_bf16 v[168:171], a[76:79], a[152:155], v[168:171]
    buffer_load_dwordx4 a[216:219], v1, s[4:7], s60 offen offset:2048 sc1
    v_mfma_f32_16x16x32_bf16 v[172:175], a[76:79], a[156:159], 0
    v_mfma_f32_16x16x32_bf16 v[172:175], a[72:75], a[140:143], v[172:175]
    s_waitcnt lgkmcnt(0)
    v_mfma_f32_16x16x32_bf16 v[188:191], a[80:83], a[140:143], 0
    ds_read_b64_tr_b16 a[72:73], v13 offset:0
    v_mfma_f32_16x16x32_bf16 v[188:191], a[84:87], a[156:159], v[188:191]
    ds_read_b64_tr_b16 a[74:75], v13 offset:4096
    v_mfma_f32_16x16x32_bf16 v[184:187], a[84:87], a[152:155], 0
    ds_read_b64_tr_b16 a[76:77], v13 offset:8192
    v_mfma_f32_16x16x32_bf16 v[184:187], a[80:83], a[136:139], v[184:187]
    ds_read_b64_tr_b16 a[78:79], v13 offset:12288
    v_mfma_f32_16x16x32_bf16 v[180:183], a[80:83], a[132:135], 0
    buffer_load_dwordx4 a[220:223], v1, s[4:7], s60 offen offset:3072 sc1
    v_mfma_f32_16x16x32_bf16 v[180:183], a[84:87], a[148:151], v[180:183]
    s_xor_b32 s60, s14, 24576
    s_add_u32 s60, s60, s73
    v_mfma_f32_16x16x32_bf16 v[176:179], a[84:87], a[144:147], 0
    buffer_load_dwordx4 a[224:227], v1, s[4:7], s60 offen offset:0 sc1
    v_mfma_f32_16x16x32_bf16 v[176:179], a[80:83], a[128:131], v[176:179]
    v_mfma_f32_16x16x32_bf16 v[192:195], a[64:67], a[128:131], 0
    s_barrier
    ds_read_b64_tr_b16 a[80:81], v6 offset:16384
    v_mfma_f32_16x16x32_bf16 v[192:195], a[68:71], a[144:147], v[192:195]
    ds_read_b64_tr_b16 a[82:83], v6 offset:20480
    v_mfma_f32_16x16x32_bf16 v[196:199], a[68:71], a[148:151], 0
    ds_read_b64_tr_b16 a[84:85], v6 offset:24576
    v_mfma_f32_16x16x32_bf16 v[196:199], a[64:67], a[132:135], v[196:199]
    ds_read_b64_tr_b16 a[86:87], v6 offset:28672
    v_mfma_f32_16x16x32_bf16 v[200:203], a[64:67], a[136:139], 0
    buffer_load_dwordx4 a[228:231], v1, s[4:7], s60 offen offset:1024 sc1
    v_mfma_f32_16x16x32_bf16 v[200:203], a[68:71], a[152:155], v[200:203]
    v_mfma_f32_16x16x32_bf16 v[204:207], a[68:71], a[156:159], 0
    buffer_load_dwordx4 a[232:235], v1, s[4:7], s60 offen offset:2048 sc1
    v_mfma_f32_16x16x32_bf16 v[204:207], a[64:67], a[140:143], v[204:207]
    s_waitcnt lgkmcnt(0)
    v_mfma_f32_16x16x32_bf16 v[220:223], a[72:75], a[140:143], 0
    ds_read_b64_tr_b16 a[64:65], v7 offset:16384
    v_mfma_f32_16x16x32_bf16 v[220:223], a[76:79], a[156:159], v[220:223]
    ds_read_b64_tr_b16 a[66:67], v7 offset:20480
    v_mfma_f32_16x16x32_bf16 v[216:219], a[76:79], a[152:155], 0
    ds_read_b64_tr_b16 a[68:69], v7 offset:24576
    v_mfma_f32_16x16x32_bf16 v[216:219], a[72:75], a[136:139], v[216:219]
    ds_read_b64_tr_b16 a[70:71], v7 offset:28672
    v_mfma_f32_16x16x32_bf16 v[212:215], a[72:75], a[132:135], 0
    v_mfma_f32_16x16x32_bf16 v[212:215], a[76:79], a[148:151], v[212:215]
    buffer_load_dwordx4 a[236:239], v1, s[4:7], s60 offen offset:3072 sc1
    v_mfma_f32_16x16x32_bf16 v[208:211], a[76:79], a[144:147], 0
    v_mfma_f32_16x16x32_bf16 v[208:211], a[72:75], a[128:131], v[208:211]
    s_waitcnt vmcnt(22)
    v_mfma_f32_16x16x32_bf16 v[96:99], a[80:83], a[160:163], v[96:99]
    s_waitcnt vmcnt(14)
    v_cmp_ne_u32 vcc, 1, v31
    s_and_b64 vcc, vcc, 0xff
    s_cbranch_vccnz L_far6
L_back6:
    ds_read_b64_tr_b16 a[72:73], v8 offset:16384
    v_mfma_f32_16x16x32_bf16 v[96:99], a[84:87], a[176:179], v[96:99]
    ds_read_b64_tr_b16 a[74:75], v8 offset:20480
    v_mfma_f32_16x16x32_bf16 v[100:103], a[84:87], a[180:183], v[100:103]
    ds_read_b64_tr_b16 a[76:77], v8 offset:24576
    v_mfma_f32_16x16x32_bf16 v[100:103], a[80:83], a[164:167], v[100:103]
    ds_read_b64_tr_b16 a[78:79], v8 offset:28672
    s_xor_b32 s60, s14, 28672
    s_add_u32 s60, s60, s73
    v_mfma_f32_16x16x32_bf16 v[104:107], a[80:83], a[168:171], v[104:107]
    buffer_load_dwordx4 a[240:243], v1, s[4:7], s60 offen offset:0 sc1
    v_mfma_f32_16x16x32_bf16 v[104:107], a[84:87], a[184:187], v[104:107]
    v_mfma_f32_16x16x32_bf16 v[108:111], a[84:87], a[188:191], v[108:111]
    buffer_load_dwordx4 a[244:247], v1, s[4:7], s60 offen offset:1024 sc1
    v_mfma_f32_16x16x32_bf16 v[108:111], a[80:83], a[172:175], v[108:111]
    s_waitcnt vmcnt(12)
    v_or3_b32 v19, v240, v241, v242
    s_waitcnt lgkmcnt(0)
    v_mfma_f32_16x16x32_bf16 v[124:127], a[64:67], a[172:175], v[124:127]
    ds_read_b64_tr_b16 a[80:81], v9 offset:16384
    v_or3_b32 v19, v19, v243, v244
    v_mfma_f32_16x16x32_bf16 v[124:127], a[68:71], a[188:191], v[124:127]
    ds_read_b64_tr_b16 a[82:83], v9 offset:20480
    v_or3_b32 v19, v19, v245, v246
    v_mfma_f32_16x16x32_bf16 v[120:123], a[68:71], a[184:187], v[120:123]
    ds_read_b64_tr_b16 a[84:85], v9 offset:24576
    v_or_b32 v19, v19, v247
    v_mfma_f32_16x16x32_bf16 v[120:123], a[64:67], a[168:171], v[120:123]
    ds_read_b64_tr_b16 a[86:87], v9 offset:28672
    v_and_b32 v19, 1, v19
    v_mfma_f32_16x16x32_bf16 v[116:119], a[64:67], a[164:167], v[116:119]
    v_cmp_ne_u32 vcc, 0, v19
    s_cbranch_vccnz L_far5
L_back5:
    v_mfma_f32_16x16x32_bf16 v[116:119], a[68:71], a[180:183], v[116:119]
    buffer_load_dwordx4 a[248:251], v1, s[4:7], s60 offen offset:2048 sc1
    v_mfma_f32_16x16x32_bf16 v[112:115], a[68:71], a[176:179], v[112:115]
    v_fmac_f32 v240, v248, v244
    v_fmac_f32 v242, v250, v246
    v_mfma_f32_16x16x32_bf16 v[112:115], a[64:67], a[160:163], v[112:115]
    v_fmac_f32 v241, v248, v245
    v_fmac_f32 v243, v250, v247
    v_mfma_f32_16x16x32_bf16 v[128:131], a[72:75], a[160:163], v[128:131]
    ds_read_b64_tr_b16 a[64:65], v10 offset:16384
    v_fma_f32 v240, -v249, v245, v240
    v_mfma_f32_16x16x32_bf16 v[128:131], a[76:79], a[176:179], v[128:131]
    ds_read_b64_tr_b16 a[66:67], v10 offset:20480
    v_fma_f32 v242, -v251, v247, v242
    v_mfma_f32_16x16x32_bf16 v[132:135], a[76:79], a[180:183], v[132:135]
    ds_read_b64_tr_b16 a[68:69], v10 offset:24576
    v_fmac_f32 v241, v249, v244
    v_mfma_f32_16x16x32_bf16 v[132:135], a[72:75], a[164:167], v[132:135]
    ds_read_b64_tr_b16 a[70:71], v10 offset:28672
    v_fmac_f32 v243, v251, v246
    v_mfma_f32_16x16x32_bf16 v[136:139], a[72:75], a[168:171], v[136:139]
    buffer_load_dwordx4 a[252:255], v1, s[4:7], s60 offen offset:3072 sc1
    v_mfma_f32_16x16x32_bf16 v[136:139], a[76:79], a[184:187], v[136:139]
    s_add_u32 m0, s63, 98304
    s_add_u32 s61, s10, 65536
    v_mfma_f32_16x16x32_bf16 v[140:143], a[76:79], a[188:191], v[140:143]
    buffer_load_dwordx4 v2, s[24:27], s61 offen offset:0 lds
    v_mfma_f32_16x16x32_bf16 v[140:143], a[72:75], a[172:175], v[140:143]
L_pad7:
    s_cbranch_execz L_pad11
    v_mul_f32 v244, v252, v240
    v_mul_f32 v246, v254, v242
    s_waitcnt lgkmcnt(0)
    v_mfma_f32_16x16x32_bf16 v[156:159], a[80:83], a[172:175], v[156:159]
    ds_read_b64_tr_b16 a[72:73], v11 offset:16384
    v_mul_f32 v245, v252, v241
    v_mfma_f32_16x16x32_bf16 v[156:159], a[84:87], a[188:191], v[156:159]
    ds_read_b64_tr_b16 a[74:75], v11 offset:20480
    v_mul_f32 v247, v254, v243
    v_mfma_f32_16x16x32_bf16 v[152:155], a[84:87], a[184:187], v[152:155]
    ds_read_b64_tr_b16 a[76:77], v11 offset:24576
    v_fma_f32 v244, -v253, v241, v244
    v_mfma_f32_16x16x32_bf16 v[152:155], a[80:83], a[168:171], v[152:155]
    ds_read_b64_tr_b16 a[78:79], v11 offset:28672
    v_fma_f32 v246, -v255, v243, v246
    v_mfma_f32_16x16x32_bf16 v[148:151], a[80:83], a[164:167], v[148:151]
    buffer_load_dwordx4 v3, s[24:27], s61 offen offset:1024 lds
    v_mfma_f32_16x16x32_bf16 v[148:151], a[84:87], a[180:183], v[148:151]
    v_fmac_f32 v245, v253, v240
    v_fmac_f32 v247, v255, v242
    v_mfma_f32_16x16x32_bf16 v[144:147], a[84:87], a[176:179], v[144:147]
    buffer_load_dwordx4 v4, s[24:27], s61 offen offset:2048 lds
    v_mfma_f32_16x16x32_bf16 v[144:147], a[80:83], a[160:163], v[144:147]
    v_accvgpr_read_b32 v248, a102
    v_accvgpr_read_b32 v249, a103
    v_mfma_f32_16x16x32_bf16 v[160:163], a[64:67], a[160:163], v[160:163]
    ds_read_b64_tr_b16 a[80:81], v12 offset:16384
    v_accvgpr_read_b32 v250, a120
    v_mfma_f32_16x16x32_bf16 v[160:163], a[68:71], a[176:179], v[160:163]
    ds_read_b64_tr_b16 a[82:83], v12 offset:20480
    v_accvgpr_read_b32 v251, a121
    v_mfma_f32_16x16x32_bf16 v[164:167], a[68:71], a[180:183], v[164:167]
    ds_read_b64_tr_b16 a[84:85], v12 offset:24576
    v_mov_b32 v240, v244
    v_mfma_f32_16x16x32_bf16 v[164:167], a[64:67], a[164:167], v[164:167]
    ds_read_b64_tr_b16 a[86:87], v12 offset:28672
    v_mov_b32 v241, v245
    v_mfma_f32_16x16x32_bf16 v[168:171], a[64:67], a[168:171], v[168:171]
    v_mov_b32 v242, v246
    v_mov_b32 v243, v247
    v_mfma_f32_16x16x32_bf16 v[168:171], a[68:71], a[184:187], v[168:171]
    buffer_load_dwordx4 v5, s[24:27], s61 offen offset:3072 lds
    v_mfma_f32_16x16x32_bf16 v[172:175], a[68:71], a[188:191], v[172:175]
    v_permlane16_swap_b32 v240, v244
    v_permlane16_swap_b32 v241, v245
    v_mfma_f32_16x16x32_bf16 v[172:175], a[64:67], a[172:175], v[172:175]
    v_permlane16_swap_b32 v242, v246
    v_permlane16_swap_b32 v243, v247
    s_waitcnt lgkmcnt(0)
    v_mfma_f32_16x16x32_bf16 v[188:191], a[72:75], a[172:175], v[188:191]
    ds_read_b64_tr_b16 a[64:65], v13 offset:16384
    v_add_f32 v244, v240, v244
    v_mfma_f32_16x16x32_bf16 v[188:191], a[76:79], a[188:191], v[188:191]
    ds_read_b64_tr_b16 a[66:67], v13 offset:20480
    v_add_f32 v245, v241, v245
    v_mfma_f32_16x16x32_bf16 v[184:187], a[76:79], a[184:187], v[184:187]
    ds_read_b64_tr_b16 a[68:69], v13 offset:24576
    v_add_f32 v246, v242, v246
    v_mfma_f32_16x16x32_bf16 v[184:187], a[72:75], a[168:171], v[184:187]
    ds_read_b64_tr_b16 a[70:71], v13 offset:28672
    s_add_u32 m0, s63, 114688
    s_add_u32 s61, s11, 65536
    v_mfma_f32_16x16x32_bf16 v[180:183], a[72:75], a[164:167], v[180:183]
    buffer_load_dwordx4 v2, s[24:27], s61 offen offset:0 lds
    v_mfma_f32_16x16x32_bf16 v[180:183], a[76:79], a[180:183], v[180:183]
    v_add_f32 v247, v243, v247
    v_mov_b32 v240, v244
    v_mfma_f32_16x16x32_bf16 v[176:179], a[76:79], a[176:179], v[176:179]
    buffer_load_dwordx4 v3, s[24:27], s61 offen offset:1024 lds
    v_mfma_f32_16x16x32_bf16 v[176:179], a[72:75], a[160:163], v[176:179]
    v_mov_b32 v241, v245
    v_mov_b32 v242, v246
    v_mfma_f32_16x16x32_bf16 v[192:195], a[80:83], a[160:163], v[192:195]
    ds_read_b64_tr_b16 a[72:73], v6 offset:32768
    v_mov_b32 v243, v247
    v_mfma_f32_16x16x32_bf16 v[192:195], a[84:87], a[176:179], v[192:195]
    ds_read_b64_tr_b16 a[74:75], v6 offset:36864
    v_permlane32_swap_b32 v240, v244
    v_mfma_f32_16x16x32_bf16 v[196:199], a[84:87], a[180:183], v[196:199]
    ds_read_b64_tr_b16 a[76:77], v6 offset:40960
    v_permlane32_swap_b32 v241, v245
    v_mfma_f32_16x16x32_bf16 v[196:199], a[80:83], a[164:167], v[196:199]
    ds_read_b64_tr_b16 a[78:79], v6 offset:45056
    v_permlane32_swap_b32 v242, v246
    v_mfma_f32_16x16x32_bf16 v[200:203], a[80:83], a[168:171], v[200:203]
    v_permlane32_swap_b32 v243, v247
    v_add_f32 v244, v240, v244
    v_mfma_f32_16x16x32_bf16 v[200:203], a[84:87], a[184:187], v[200:203]
    buffer_load_dwordx4 v4, s[24:27], s61 offen offset:2048 lds
    v_mfma_f32_16x16x32_bf16 v[204:207], a[84:87], a[188:191], v[204:207]
    v_add_f32 v245, v241, v245
    v_add_f32 v246, v242, v246
    v_mfma_f32_16x16x32_bf16 v[204:207], a[80:83], a[172:175], v[204:207]
    v_add_f32 v247, v243, v247
    v_fmac_f32 v24, v248, v244
    s_waitcnt lgkmcnt(0)
    v_mfma_f32_16x16x32_bf16 v[220:223], a[64:67], a[172:175], v[220:223]
    ds_read_b64_tr_b16 a[80:81], v7 offset:32768
    v_fmac_f32 v26, v250, v246
    v_mfma_f32_16x16x32_bf16 v[220:223], a[68:71], a[188:191], v[220:223]
    ds_read_b64_tr_b16 a[82:83], v7 offset:36864
    v_fmac_f32 v25, v248, v245
    v_mfma_f32_16x16x32_bf16 v[216:219], a[68:71], a[184:187], v[216:219]
    ds_read_b64_tr_b16 a[84:85], v7 offset:40960
    v_fmac_f32 v27, v250, v247
    v_mfma_f32_16x16x32_bf16 v[216:219], a[64:67], a[168:171], v[216:219]
    ds_read_b64_tr_b16 a[86:87], v7 offset:45056
    v_fma_f32 v24, -v249, v245, v24
    v_mfma_f32_16x16x32_bf16 v[212:215], a[64:67], a[164:167], v[212:215]
    buffer_load_dwordx4 v5, s[24:27], s61 offen offset:3072 lds
    v_mfma_f32_16x16x32_bf16 v[212:215], a[68:71], a[180:183], v[212:215]
    s_xor_b32 s60, s14, 32768
    s_add_u32 s60, s60, s73
    v_mfma_f32_16x16x32_bf16 v[208:211], a[68:71], a[176:179], v[208:211]
    buffer_load_dwordx4 a[128:131], v1, s[4:7], s60 offen offset:0 sc1
    v_mfma_f32_16x16x32_bf16 v[208:211], a[64:67], a[160:163], v[208:211]
    v_fma_f32 v26, -v251, v247, v26
    v_fmac_f32 v25, v249, v244
    s_waitcnt vmcnt(17)
    v_mfma_f32_16x16x32_bf16 v[96:99], a[72:75], a[192:195], v[96:99]
    ds_read_b64_tr_b16 a[64:65], v8 offset:32768
    v_fmac_f32 v27, v251, v246
    v_mfma_f32_16x16x32_bf16 v[96:99], a[76:79], a[208:211], v[96:99]
    ds_read_b64_tr_b16 a[66:67], v8 offset:36864
    v_mov_b32 v19, 1
    v_mfma_f32_16x16x32_bf16 v[100:103], a[76:79], a[212:215], v[100:103]
    ds_read_b64_tr_b16 a[68:69], v8 offset:40960
    v_mfma_f32_16x16x32_bf16 v[100:103], a[72:75], a[196:199], v[100:103]
    ds_read_b64_tr_b16 a[70:71], v8 offset:45056
    v_mfma_f32_16x16x32_bf16 v[104:107], a[72:75], a[200:203], v[104:107]
    buffer_load_dwordx4 a[132:135], v1, s[4:7], s60 offen offset:1024 sc1
    v_mfma_f32_16x16x32_bf16 v[104:107], a[76:79], a[216:219], v[104:107]
    buffer_store_dword v19, v28, s[4:7], s75 offen offset:256 sc1
    v_mfma_f32_16x16x32_bf16 v[108:111], a[76:79], a[220:223], v[108:111]
    buffer_load_dwordx4 a[136:139], v1, s[4:7], s60 offen offset:2048 sc1
    v_mfma_f32_16x16x32_bf16 v[108:111], a[72:75], a[204:207], v[108:111]
    v_fmac_f32 v32, v20, v24
    v_fmac_f32 v48, v22, v26
    s_waitcnt lgkmcnt(0)
    v_mfma_f32_16x16x32_bf16 v[124:127], a[80:83], a[204:207], v[124:127]
    ds_read_b64_tr_b16 a[72:73], v9 offset:32768
    v_fmac_f32 v33, v20, v25
    v_mfma_f32_16x16x32_bf16 v[124:127], a[84:87], a[220:223], v[124:127]
    ds_read_b64_tr_b16 a[74:75], v9 offset:36864
    v_fmac_f32 v49, v22, v27
    v_mfma_f32_16x16x32_bf16 v[120:123], a[84:87], a[216:219], v[120:123]
    ds_read_b64_tr_b16 a[76:77], v9 offset:40960
    v_fma_f32 v32, -v21, v25, v32
    v_mfma_f32_16x16x32_bf16 v[120:123], a[80:83], a[200:203], v[120:123]
    ds_read_b64_tr_b16 a[78:79], v9 offset:45056
    v_fma_f32 v48, -v23, v27, v48
    v_mfma_f32_16x16x32_bf16 v[116:119], a[80:83], a[196:199], v[116:119]
    v_fmac_f32 v33, v21, v24
    v_fmac_f32 v49, v23, v26
    v_mfma_f32_16x16x32_bf16 v[116:119], a[84:87], a[212:215], v[116:119]
    buffer_load_dwordx4 a[140:143], v1, s[4:7], s60 offen offset:3072 sc1
    v_mfma_f32_16x16x32_bf16 v[112:115], a[84:87], a[208:211], v[112:115]
    v_fmac_f32 v64, v20, v32
    v_fmac_f32 v80, v22, v48
    v_mfma_f32_16x16x32_bf16 v[112:115], a[80:83], a[192:195], v[112:115]
    v_fmac_f32 v65, v20, v33
    v_fmac_f32 v81, v22, v49
    v_mfma_f32_16x16x32_bf16 v[128:131], a[64:67], a[192:195], v[128:131]
    ds_read_b64_tr_b16 a[80:81], v10 offset:32768
    v_fma_f32 v64, -v21, v33, v64
    v_mfma_f32_16x16x32_bf16 v[128:131], a[68:71], a[208:211], v[128:131]
    ds_read_b64_tr_b16 a[82:83], v10 offset:36864
    v_fma_f32 v80, -v23, v49, v80
    v_mfma_f32_16x16x32_bf16 v[132:135], a[68:71], a[212:215], v[132:135]
    ds_read_b64_tr_b16 a[84:85], v10 offset:40960
    v_fmac_f32 v65, v21, v32
    v_mfma_f32_16x16x32_bf16 v[132:135], a[64:67], a[196:199], v[132:135]
    ds_read_b64_tr_b16 a[86:87], v10 offset:45056
    s_xor_b32 s60, s14, 36864
    s_add_u32 s60, s60, s73
    v_mfma_f32_16x16x32_bf16 v[136:139], a[64:67], a[200:203], v[136:139]
    buffer_load_dwordx4 a[144:147], v1, s[4:7], s60 offen offset:0 sc1
    v_mfma_f32_16x16x32_bf16 v[136:139], a[68:71], a[216:219], v[136:139]
    v_fmac_f32 v81, v23, v48
    v_cvt_pk_bf16_f32 v224, v32, v64
    v_mfma_f32_16x16x32_bf16 v[140:143], a[68:71], a[220:223], v[140:143]
    buffer_load_dwordx4 a[148:151], v1, s[4:7], s60 offen offset:1024 sc1
    v_mfma_f32_16x16x32_bf16 v[140:143], a[64:67], a[204:207], v[140:143]
    v_cvt_pk_bf16_f32 v232, v48, v80
    v_cvt_pk_bf16_f32 v240, -v33, -v65
    s_waitcnt lgkmcnt(0)
    v_mfma_f32_16x16x32_bf16 v[156:159], a[72:75], a[204:207], v[156:159]
    ds_read_b64_tr_b16 a[64:65], v11 offset:32768
    v_cvt_pk_bf16_f32 v248, -v49, -v81
    v_mfma_f32_16x16x32_bf16 v[156:159], a[76:79], a[220:223], v[156:159]
    ds_read_b64_tr_b16 a[66:67], v11 offset:36864
    v_fmac_f32 v34, v20, v64
    v_mfma_f32_16x16x32_bf16 v[152:155], a[76:79], a[216:219], v[152:155]
    ds_read_b64_tr_b16 a[68:69], v11 offset:40960
    v_fmac_f32 v50, v22, v80
    v_mfma_f32_16x16x32_bf16 v[152:155], a[72:75], a[200:203], v[152:155]
    ds_read_b64_tr_b16 a[70:71], v11 offset:45056
    v_fmac_f32 v35, v20, v65
    v_mfma_f32_16x16x32_bf16 v[148:151], a[72:75], a[196:199], v[148:151]
    v_fmac_f32 v51, v22, v81
    v_fma_f32 v34, -v21, v65, v34
    v_mfma_f32_16x16x32_bf16 v[148:151], a[76:79], a[212:215], v[148:151]
    buffer_load_dwordx4 a[152:155], v1, s[4:7], s60 offen offset:2048 sc1
    v_mfma_f32_16x16x32_bf16 v[144:147], a[76:79], a[208:211], v[144:147]
    v_fma_f32 v50, -v23, v81, v50
    v_fmac_f32 v35, v21, v64
    v_mfma_f32_16x16x32_bf16 v[144:147], a[72:75], a[192:195], v[144:147]
    v_fmac_f32 v51, v23, v80
    v_fmac_f32 v66, v20, v34
    v_mfma_f32_16x16x32_bf16 v[160:163], a[80:83], a[192:195], v[160:163]
    ds_read_b64_tr_b16 a[72:73], v12 offset:32768
    v_fmac_f32 v82, v22, v50
    v_mfma_f32_16x16x32_bf16 v[160:163], a[84:87], a[208:211], v[160:163]
    ds_read_b64_tr_b16 a[74:75], v12 offset:36864
    v_fmac_f32 v67, v20, v35
    v_mfma_f32_16x16x32_bf16 v[164:167], a[84:87], a[212:215], v[164:167]
    ds_read_b64_tr_b16 a[76:77], v12 offset:40960
    v_fmac_f32 v83, v22, v51
    v_mfma_f32_16x16x32_bf16 v[164:167], a[80:83], a[196:199], v[164:167]
    ds_read_b64_tr_b16 a[78:79], v12 offset:45056
    v_fma_f32 v66, -v21, v35, v66
    v_mfma_f32_16x16x32_bf16 v[168:171], a[80:83], a[200:203], v[168:171]
    buffer_load_dwordx4 a[156:159], v1, s[4:7], s60 offen offset:3072 sc1
    v_mfma_f32_16x16x32_bf16 v[168:171], a[84:87], a[216:219], v[168:171]
    s_xor_b32 s60, s14, 40960
    s_add_u32 s60, s60, s73
    v_mfma_f32_16x16x32_bf16 v[172:175], a[84:87], a[220:223], v[172:175]
    buffer_load_dwordx4 a[160:163], v1, s[4:7], s60 offen offset:0 sc1
    v_mfma_f32_16x16x32_bf16 v[172:175], a[80:83], a[204:207], v[172:175]
    v_fma_f32 v82, -v23, v51, v82
    v_fmac_f32 v67, v21, v34
    s_waitcnt lgkmcnt(0)
    v_mfma_f32_16x16x32_bf16 v[188:191], a[64:67], a[204:207], v[188:191]
    ds_read_b64_tr_b16 a[80:81], v13 offset:32768
    v_fmac_f32 v83, v23, v50
    v_mfma_f32_16x16x32_bf16 v[188:191], a[68:71], a[220:223], v[188:191]
    ds_read_b64_tr_b16 a[82:83], v13 offset:36864
    v_cvt_pk_bf16_f32 v225, v34, v66
    v_mfma_f32_16x16x32_bf16 v[184:187], a[68:71], a[216:219], v[184:187]
    ds_read_b64_tr_b16 a[84:85], v13 offset:40960
    v_cvt_pk_bf16_f32 v233, v50, v82
    v_mfma_f32_16x16x32_bf16 v[184:187], a[64:67], a[200:203], v[184:187]
    ds_read_b64_tr_b16 a[86:87], v13 offset:45056
    v_cvt_pk_bf16_f32 v241, -v35, -v67
    v_mfma_f32_16x16x32_bf16 v[180:183], a[64:67], a[196:199], v[180:183]
    buffer_load_dwordx4 a[164:167], v1, s[4:7], s60 offen offset:1024 sc1
    v_mfma_f32_16x16x32_bf16 v[180:183], a[68:71], a[212:215], v[180:183]
    v_cvt_pk_bf16_f32 v249, -v51, -v83
    v_fmac_f32 v36, v20, v66
    v_mfma_f32_16x16x32_bf16 v[176:179], a[68:71], a[208:211], v[176:179]
    buffer_load_dwordx4 a[168:171], v1, s[4:7], s60 offen offset:2048 sc1
    v_mfma_f32_16x16x32_bf16 v[176:179], a[64:67], a[192:195], v[176:179]
    v_fmac_f32 v52, v22, v82
    v_fmac_f32 v37, v20, v67
    v_mfma_f32_16x16x32_bf16 v[192:195], a[72:75], a[192:195], v[192:195]
    s_barrier
    ds_read_b64_tr_b16 a[64:65], v6 offset:49152
    v_mfma_f32_16x16x32_bf16 v[192:195], a[76:79], a[208:211], v[192:195]
    ds_read_b64_tr_b16 a[66:67], v6 offset:53248
    v_fmac_f32 v53, v22, v83
    v_mfma_f32_16x16x32_bf16 v[196:199], a[76:79], a[212:215], v[196:199]
    ds_read_b64_tr_b16 a[68:69], v6 offset:57344
    v_fma_f32 v36, -v21, v67, v36
    v_mfma_f32_16x16x32_bf16 v[196:199], a[72:75], a[196:199], v[196:199]
    ds_read_b64_tr_b16 a[70:71], v6 offset:61440
    v_fma_f32 v52, -v23, v83, v52
    v_mfma_f32_16x16x32_bf16 v[200:203], a[72:75], a[200:203], v[200:203]
    v_fmac_f32 v37, v21, v66
    v_fmac_f32 v53, v23, v82
    v_mfma_f32_16x16x32_bf16 v[200:203], a[76:79], a[216:219], v[200:203]
    buffer_load_dwordx4 a[172:175], v1, s[4:7], s60 offen offset:3072 sc1
    v_mfma_f32_16x16x32_bf16 v[204:207], a[76:79], a[220:223], v[204:207]
    v_fmac_f32 v68, v20, v36
    v_fmac_f32 v84, v22, v52
    v_mfma_f32_16x16x32_bf16 v[204:207], a[72:75], a[204:207], v[204:207]
    v_fmac_f32 v69, v20, v37
    v_fmac_f32 v85, v22, v53
    s_waitcnt lgkmcnt(0)
    v_mfma_f32_16x16x32_bf16 v[220:223], a[80:83], a[204:207], v[220:223]
    ds_read_b64_tr_b16 a[72:73], v7 offset:49152
    v_fma_f32 v68, -v21, v37, v68
    v_mfma_f32_16x16x32_bf16 v[220:223], a[84:87], a[220:223], v[220:223]
    ds_read_b64_tr_b16 a[74:75], v7 offset:53248
    v_fma_f32 v84, -v23, v53, v84
    v_mfma_f32_16x16x32_bf16 v[216:219], a[84:87], a[216:219], v[216:219]
    ds_read_b64_tr_b16 a[76:77], v7 offset:57344
    v_fmac_f32 v69, v21, v36
    v_mfma_f32_16x16x32_bf16 v[216:219], a[80:83], a[200:203], v[216:219]
    ds_read_b64_tr_b16 a[78:79], v7 offset:61440
    s_xor_b32 s60, s14, 45056
    s_add_u32 s60, s60, s73
    v_mfma_f32_16x16x32_bf16 v[212:215], a[80:83], a[196:199], v[212:215]
    buffer_load_dwordx4 a[176:179], v1, s[4:7], s60 offen offset:0 sc1
    v_mfma_f32_16x16x32_bf16 v[212:215], a[84:87], a[212:215], v[212:215]
    v_fmac_f32 v85, v23, v52
    v_cvt_pk_bf16_f32 v226, v36, v68
    v_mfma_f32_16x16x32_bf16 v[208:211], a[84:87], a[208:211], v[208:211]
    buffer_load_dwordx4 a[180:183], v1, s[4:7], s60 offen offset:1024 sc1
    v_mfma_f32_16x16x32_bf16 v[208:211], a[80:83], a[192:195], v[208:211]
    v_cvt_pk_bf16_f32 v234, v52, v84
    v_cvt_pk_bf16_f32 v242, -v37, -v69
    s_waitcnt vmcnt(23)
    v_mfma_f32_16x16x32_bf16 v[96:99], a[64:67], a[224:227], v[96:99]
    ds_read_b64_tr_b16 a[80:81], v8 offset:49152
    v_cvt_pk_bf16_f32 v250, -v53, -v85
    v_mfma_f32_16x16x32_bf16 v[96:99], a[68:71], a[240:243], v[96:99]
    ds_read_b64_tr_b16 a[82:83], v8 offset:53248
    v_fmac_f32 v38, v20, v68
    v_mfma_f32_16x16x32_bf16 v[100:103], a[68:71], a[244:247], v[100:103]
    ds_read_b64_tr_b16 a[84:85], v8 offset:57344
    v_fmac_f32 v54, v22, v84
    v_mfma_f32_16x16x32_bf16 v[100:103], a[64:67], a[228:231], v[100:103]
    ds_read_b64_tr_b16 a[86:87], v8 offset:61440
    v_fmac_f32 v39, v20, v69
    v_mfma_f32_16x16x32_bf16 v[104:107], a[64:67], a[232:235], v[104:107]
    v_fmac_f32 v55, v22, v85
    v_fma_f32 v38, -v21, v69, v38
    v_mfma_f32_16x16x32_bf16 v[104:107], a[68:71], a[248:251], v[104:107]
    buffer_load_dwordx4 a[184:187], v1, s[4:7], s60 offen offset:2048 sc1
    v_mfma_f32_16x16x32_bf16 v[108:111], a[68:71], a[252:255], v[108:111]
    v_fma_f32 v54, -v23, v85, v54
    v_fmac_f32 v39, v21, v68
    v_mfma_f32_16x16x32_bf16 v[108:111], a[64:67], a[236:239], v[108:111]
    v_fmac_f32 v55, v23, v84
    v_fmac_f32 v70, v20, v38
    s_waitcnt lgkmcnt(0)
    v_mfma_f32_16x16x32_bf16 v[124:127], a[72:75], a[236:239], v[124:127]
    ds_read_b64_tr_b16 a[64:65], v9 offset:49152
    v_fmac_f32 v86, v22, v54
    v_mfma_f32_16x16x32_bf16 v[124:127], a[76:79], a[252:255], v[124:127]
    ds_read_b64_tr_b16 a[66:67], v9 offset:53248
    v_fmac_f32 v71, v20, v39
    v_mfma_f32_16x16x32_bf16 v[120:123], a[76:79], a[248:251], v[120:123]
    ds_read_b64_tr_b16 a[68:69], v9 offset:57344
    v_fmac_f32 v87, v22, v55
    v_mfma_f32_16x16x32_bf16 v[120:123], a[72:75], a[232:235], v[120:123]
    ds_read_b64_tr_b16 a[70:71], v9 offset:61440
    v_fma_f32 v70, -v21, v39, v70
    v_mfma_f32_16x16x32_bf16 v[116:119], a[72:75], a[228:231], v[116:119]
    buffer_load_dwordx4 a[188:191], v1, s[4:7], s60 offen offset:3072 sc1
    v_mfma_f32_16x16x32_bf16 v[116:119], a[76:79], a[244:247], v[116:119]
    s_add_u32 m0, s63, 0
    s_add_u32 s61, s8, 131072
    v_mfma_f32_16x16x32_bf16 v[112:115], a[76:79], a[240:243], v[112:115]
    buffer_load_dwordx4 v2, s[24:27], s61 offen offset:0 lds
    v_mfma_f32_16x16x32_bf16 v[112:115], a[72:75], a[224:227], v[112:115]
    v_fma_f32 v86, -v23, v55, v86
    v_fmac_f32 v71, v21, v38
    v_mfma_f32_16x16x32_bf16 v[128:131], a[80:83], a[224:227], v[128:131]
    ds_read_b64_tr_b16 a[72:73], v10 offset:49152
    v_fmac_f32 v87, v23, v54
    v_mfma_f32_16x16x32_bf16 v[128:131], a[84:87], a[240:243], v[128:131]
    ds_read_b64_tr_b16 a[74:75], v10 offset:53248
    v_cvt_pk_bf16_f32 v227, v38, v70
    v_mfma_f32_16x16x32_bf16 v[132:135], a[84:87], a[244:247], v[132:135]
    ds_read_b64_tr_b16 a[76:77], v10 offset:57344
    v_cvt_pk_bf16_f32 v235, v54, v86
    v_mfma_f32_16x16x32_bf16 v[132:135], a[80:83], a[228:231], v[132:135]
    ds_read_b64_tr_b16 a[78:79], v10 offset:61440
    v_cvt_pk_bf16_f32 v243, -v39, -v71
    v_mfma_f32_16x16x32_bf16 v[136:139], a[80:83], a[232:235], v[136:139]
    buffer_load_dwordx4 v3, s[24:27], s61 offen offset:1024 lds
    v_mfma_f32_16x16x32_bf16 v[136:139], a[84:87], a[248:251], v[136:139]
    v_cvt_pk_bf16_f32 v251, -v55, -v87
    v_fmac_f32 v40, v20, v70
    v_mfma_f32_16x16x32_bf16 v[140:143], a[84:87], a[252:255], v[140:143]
    buffer_load_dwordx4 v4, s[24:27], s61 offen offset:2048 lds
    v_mfma_f32_16x16x32_bf16 v[140:143], a[80:83], a[236:239], v[140:143]
    v_fmac_f32 v56, v22, v86
    v_fmac_f32 v41, v20, v71
    s_waitcnt lgkmcnt(0)
    v_mfma_f32_16x16x32_bf16 v[156:159], a[64:67], a[236:239], v[156:159]
    ds_read_b64_tr_b16 a[80:81], v11 offset:49152
    v_fmac_f32 v57, v22, v87
    v_mfma_f32_16x16x32_bf16 v[156:159], a[68:71], a[252:255], v[156:159]
    ds_read_b64_tr_b16 a[82:83], v11 offset:53248
    v_fma_f32 v40, -v21, v71, v40
    v_mfma_f32_16x16x32_bf16 v[152:155], a[68:71], a[248:251], v[152:155]
    ds_read_b64_tr_b16 a[84:85], v11 offset:57344
    v_fma_f32 v56, -v23, v87, v56
    v_mfma_f32_16x16x32_bf16 v[152:155], a[64:67], a[232:235], v[152:155]
    ds_read_b64_tr_b16 a[86:87], v11 offset:61440
    v_fmac_f32 v41, v21, v70
    v_mfma_f32_16x16x32_bf16 v[148:151], a[64:67], a[228:231], v[148:151]
    v_fmac_f32 v57, v23, v86
    v_fmac_f32 v72, v20, v40
    v_mfma_f32_16x16x32_bf16 v[148:151], a[68:71], a[244:247], v[148:151]
    buffer_load_dwordx4 v5, s[24:27], s61 offen offset:3072 lds
    v_mfma_f32_16x16x32_bf16 v[144:147], a[68:71], a[240:243], v[144:147]
    v_fmac_f32 v88, v22, v56
    v_fmac_f32 v73, v20, v41
    v_mfma_f32_16x16x32_bf16 v[144:147], a[64:67], a[224:227], v[144:147]
    v_fmac_f32 v89, v22, v57
    v_fma_f32 v72, -v21, v41, v72
    v_mfma_f32_16x16x32_bf16 v[160:163], a[72:75], a[224:227], v[160:163]
    ds_read_b64_tr_b16 a[64:65], v12 offset:49152
    v_fma_f32 v88, -v23, v57, v88
    v_mfma_f32_16x16x32_bf16 v[160:163], a[76:79], a[240:243], v[160:163]
    ds_read_b64_tr_b16 a[66:67], v12 offset:53248
    v_fmac_f32 v73, v21, v40
    v_mfma_f32_16x16x32_bf16 v[164:167], a[76:79], a[244:247], v[164:167]
    ds_read_b64_tr_b16 a[68:69], v12 offset:57344
    v_fmac_f32 v89, v23, v56
    v_mfma_f32_16x16x32_bf16 v[164:167], a[72:75], a[228:231], v[164:167]
    ds_read_b64_tr_b16 a[70:71], v12 offset:61440
    s_add_u32 m0, s63, 16384
    s_add_u32 s61, s9, 131072
    v_mfma_f32_16x16x32_bf16 v[168:171], a[72:75], a[232:235], v[168:171]
    buffer_load_dwordx4 v2, s[24:27], s61 offen offset:0 lds
    v_mfma_f32_16x16x32_bf16 v[168:171], a[76:79], a[248:251], v[168:171]
    v_cvt_pk_bf16_f32 v228, v40, v72
    v_cvt_pk_bf16_f32 v236, v56, v88
    v_mfma_f32_16x16x32_bf16 v[172:175], a[76:79], a[252:255], v[172:175]
    buffer_load_dwordx4 v3, s[24:27], s61 offen offset:1024 lds
    v_mfma_f32_16x16x32_bf16 v[172:175], a[72:75], a[236:239], v[172:175]
    v_cvt_pk_bf16_f32 v244, -v41, -v73
    v_cvt_pk_bf16_f32 v252, -v57, -v89
    s_waitcnt lgkmcnt(0)
    v_mfma_f32_16x16x32_bf16 v[188:191], a[80:83], a[236:239], v[188:191]
    ds_read_b64_tr_b16 a[72:73], v13 offset:49152
    v_fmac_f32 v42, v20, v72
    v_mfma_f32_16x16x32_bf16 v[188:191], a[84:87], a[252:255], v[188:191]
    ds_read_b64_tr_b16 a[74:75], v13 offset:53248
    v_fmac_f32 v58, v22, v88
    v_mfma_f32_16x16x32_bf16 v[184:187], a[84:87], a[248:251], v[184:187]
    ds_read_b64_tr_b16 a[76:77], v13 offset:57344
    v_fmac_f32 v43, v20, v73
    v_mfma_f32_16x16x32_bf16 v[184:187], a[80:83], a[232:235], v[184:187]
    ds_read_b64_tr_b16 a[78:79], v13 offset:61440
    v_fmac_f32 v59, v22, v89
    v_mfma_f32_16x16x32_bf16 v[180:183], a[80:83], a[228:231], v[180:183]
    v_fma_f32 v42, -v21, v73, v42
    v_fma_f32 v58, -v23, v89, v58
    v_mfma_f32_16x16x32_bf16 v[180:183], a[84:87], a[244:247], v[180:183]
    buffer_load_dwordx4 v4, s[24:27], s61 offen offset:2048 lds
    v_mfma_f32_16x16x32_bf16 v[176:179], a[84:87], a[240:243], v[176:179]
    v_fmac_f32 v43, v21, v72
    v_fmac_f32 v59, v23, v88
    v_mfma_f32_16x16x32_bf16 v[176:179], a[80:83], a[224:227], v[176:179]
    v_xor_b32 v6, 0x10000, v6
    v_fmac_f32 v74, v20, v42
    v_mfma_f32_16x16x32_bf16 v[192:195], a[64:67], a[224:227], v[192:195]
    ds_read_b64_tr_b16 a[80:81], v6 offset:0
    v_fmac_f32 v90, v22, v58
    v_mfma_f32_16x16x32_bf16 v[192:195], a[68:71], a[240:243], v[192:195]
    ds_read_b64_tr_b16 a[82:83], v6 offset:4096
    v_fmac_f32 v75, v20, v43
    v_mfma_f32_16x16x32_bf16 v[196:199], a[68:71], a[244:247], v[196:199]
    ds_read_b64_tr_b16 a[84:85], v6 offset:8192
    v_fmac_f32 v91, v22, v59
    v_mfma_f32_16x16x32_bf16 v[196:199], a[64:67], a[228:231], v[196:199]
    ds_read_b64_tr_b16 a[86:87], v6 offset:12288
    v_fma_f32 v74, -v21, v43, v74
    v_mfma_f32_16x16x32_bf16 v[200:203], a[64:67], a[232:235], v[200:203]
    buffer_load_dwordx4 v5, s[24:27], s61 offen offset:3072 lds
    v_mfma_f32_16x16x32_bf16 v[200:203], a[68:71], a[248:251], v[200:203]
    s_xor_b32 s60, s14, 49152
    s_add_u32 s60, s60, s73
    v_mfma_f32_16x16x32_bf16 v[204:207], a[68:71], a[252:255], v[204:207]
    buffer_load_dwordx4 a[192:195], v1, s[4:7], s60 offen offset:0 sc1
    v_mfma_f32_16x16x32_bf16 v[204:207], a[64:67], a[236:239], v[204:207]
    v_xor_b32 v7, 0x10000, v7
    v_fma_f32 v90, -v23, v59, v90
    s_waitcnt lgkmcnt(0)
    v_mfma_f32_16x16x32_bf16 v[220:223], a[72:75], a[236:239], v[220:223]
    ds_read_b64_tr_b16 a[64:65], v7 offset:0
    v_fmac_f32 v75, v21, v42
    v_mfma_f32_16x16x32_bf16 v[220:223], a[76:79], a[252:255], v[220:223]
    ds_read_b64_tr_b16 a[66:67], v7 offset:4096
    v_fmac_f32 v91, v23, v58
    v_mfma_f32_16x16x32_bf16 v[216:219], a[76:79], a[248:251], v[216:219]
    ds_read_b64_tr_b16 a[68:69], v7 offset:8192
    v_cvt_pk_bf16_f32 v229, v42, v74
    v_mfma_f32_16x16x32_bf16 v[216:219], a[72:75], a[232:235], v[216:219]
    ds_read_b64_tr_b16 a[70:71], v7 offset:12288
    v_cvt_pk_bf16_f32 v237, v58, v90
    v_mfma_f32_16x16x32_bf16 v[212:215], a[72:75], a[228:231], v[212:215]
    buffer_load_dwordx4 a[196:199], v1, s[4:7], s60 offen offset:1024 sc1
    v_mfma_f32_16x16x32_bf16 v[212:215], a[76:79], a[244:247], v[212:215]
    v_cvt_pk_bf16_f32 v245, -v43, -v75
    v_cvt_pk_bf16_f32 v253, -v59, -v91
    v_mfma_f32_16x16x32_bf16 v[208:211], a[76:79], a[240:243], v[208:211]
    buffer_load_dwordx4 a[200:203], v1, s[4:7], s60 offen offset:2048 sc1
    v_mfma_f32_16x16x32_bf16 v[208:211], a[72:75], a[224:227], v[208:211]
    v_xor_b32 v8, 0x10000, v8
    v_fmac_f32 v44, v20, v74
    s_waitcnt vmcnt(19)
    v_mfma_f32_16x16x32_bf16 v[96:99], a[80:83], a[128:131], v[96:99]
    ds_read_b64_tr_b16 a[72:73], v8 offset:0
    v_fmac_f32 v60, v22, v90
    v_mfma_f32_16x16x32_bf16 v[96:99], a[84:87], a[144:147], v[96:99]
    ds_read_b64_tr_b16 a[74:75], v8 offset:4096
    v_fmac_f32 v45, v20, v75
    v_mfma_f32_16x16x32_bf16 v[100:103], a[84:87], a[148:151], v[100:103]
    ds_read_b64_tr_b16 a[76:77], v8 offset:8192
    v_fmac_f32 v61, v22, v91
    v_mfma_f32_16x16x32_bf16 v[100:103], a[80:83], a[132:135], v[100:103]
    ds_read_b64_tr_b16 a[78:79], v8 offset:12288
    v_fma_f32 v44, -v21, v75, v44
    v_mfma_f32_16x16x32_bf16 v[104:107], a[80:83], a[136:139], v[104:107]
    v_fma_f32 v60, -v23, v91, v60
    v_fmac_f32 v45, v21, v74
    v_mfma_f32_16x16x32_bf16 v[104:107], a[84:87], a[152:155], v[104:107]
    v_mov_b32 v31, 0
    buffer_atomic_add v31, v30, s[4:7], s74 offen offset:256 sc0 sc1
    v_mfma_f32_16x16x32_bf16 v[108:111], a[84:87], a[156:159], v[108:111]
    v_fmac_f32 v61, v23, v90
    v_fmac_f32 v76, v20, v44
    v_mfma_f32_16x16x32_bf16 v[108:111], a[80:83], a[140:143], v[108:111]
    v_xor_b32 v9, 0x10000, v9
    v_fmac_f32 v92, v22, v60
    s_waitcnt lgkmcnt(0)
    v_mfma_f32_16x16x32_bf16 v[124:127], a[64:67], a[140:143], v[124:127]
    ds_read_b64_tr_b16 a[80:81], v9 offset:0
    v_fmac_f32 v77, v20, v45
    v_mfma_f32_16x16x32_bf16 v[124:127], a[68:71], a[156:159], v[124:127]
    ds_read_b64_tr_b16 a[82:83], v9 offset:4096
    v_fmac_f32 v93, v22, v61
    v_mfma_f32_16x16x32_bf16 v[120:123], a[68:71], a[152:155], v[120:123]
    ds_read_b64_tr_b16 a[84:85], v9 offset:8192
    v_fma_f32 v76, -v21, v45, v76
    v_mfma_f32_16x16x32_bf16 v[120:123], a[64:67], a[136:139], v[120:123]
    ds_read_b64_tr_b16 a[86:87], v9 offset:12288
    v_fma_f32 v92, -v23, v61, v92
    v_mfma_f32_16x16x32_bf16 v[116:119], a[64:67], a[132:135], v[116:119]
    buffer_load_dwordx4 a[204:207], v1, s[4:7], s60 offen offset:3072 sc1
    v_mfma_f32_16x16x32_bf16 v[116:119], a[68:71], a[148:151], v[116:119]
    s_xor_b32 s60, s14, 53248
    s_add_u32 s60, s60, s73
    v_mfma_f32_16x16x32_bf16 v[112:115], a[68:71], a[144:147], v[112:115]
    buffer_load_dwordx4 a[208:211], v1, s[4:7], s60 offen offset:0 sc1
    v_mfma_f32_16x16x32_bf16 v[112:115], a[64:67], a[128:131], v[112:115]
    v_xor_b32 v10, 0x10000, v10
    v_fmac_f32 v77, v21, v44
    v_mfma_f32_16x16x32_bf16 v[128:131], a[72:75], a[128:131], v[128:131]
    ds_read_b64_tr_b16 a[64:65], v10 offset:0
    v_fmac_f32 v93, v23, v60
    v_mfma_f32_16x16x32_bf16 v[128:131], a[76:79], a[144:147], v[128:131]
    ds_read_b64_tr_b16 a[66:67], v10 offset:4096
    v_cvt_pk_bf16_f32 v230, v44, v76
    v_mfma_f32_16x16x32_bf16 v[132:135], a[76:79], a[148:151], v[132:135]
    ds_read_b64_tr_b16 a[68:69], v10 offset:8192
    v_cvt_pk_bf16_f32 v238, v60, v92
    v_mfma_f32_16x16x32_bf16 v[132:135], a[72:75], a[132:135], v[132:135]
    ds_read_b64_tr_b16 a[70:71], v10 offset:12288
    v_cvt_pk_bf16_f32 v246, -v45, -v77
    v_mfma_f32_16x16x32_bf16 v[136:139], a[72:75], a[136:139], v[136:139]
    v_cvt_pk_bf16_f32 v254, -v61, -v93
    v_fmac_f32 v46, v20, v76
    v_mfma_f32_16x16x32_bf16 v[136:139], a[76:79], a[152:155], v[136:139]
    buffer_load_dwordx4 a[212:215], v1, s[4:7], s60 offen offset:1024 sc1
    v_mfma_f32_16x16x32_bf16 v[140:143], a[76:79], a[156:159], v[140:143]
    v_fmac_f32 v62, v22, v92
    v_fmac_f32 v47, v20, v77
    v_mfma_f32_16x16x32_bf16 v[140:143], a[72:75], a[140:143], v[140:143]
    v_xor_b32 v11, 0x10000, v11
    v_fmac_f32 v63, v22, v93
    s_waitcnt lgkmcnt(0)
    v_mfma_f32_16x16x32_bf16 v[156:159], a[80:83], a[140:143], v[156:159]
    ds_read_b64_tr_b16 a[72:73], v11 offset:0
    v_fma_f32 v46, -v21, v77, v46
    v_mfma_f32_16x16x32_bf16 v[156:159], a[84:87], a[156:159], v[156:159]
    ds_read_b64_tr_b16 a[74:75], v11 offset:4096
    v_fma_f32 v62, -v23, v93, v62
    v_mfma_f32_16x16x32_bf16 v[152:155], a[84:87], a[152:155], v[152:155]
    ds_read_b64_tr_b16 a[76:77], v11 offset:8192
    v_fmac_f32 v47, v21, v76
    v_mfma_f32_16x16x32_bf16 v[152:155], a[80:83], a[136:139], v[152:155]
    ds_read_b64_tr_b16 a[78:79], v11 offset:12288
    v_fmac_f32 v63, v23, v92
    v_mfma_f32_16x16x32_bf16 v[148:151], a[80:83], a[132:135], v[148:151]
    buffer_load_dwordx4 a[216:219], v1, s[4:7], s60 offen offset:2048 sc1
    v_mfma_f32_16x16x32_bf16 v[148:151], a[84:87], a[148:151], v[148:151]
    v_fmac_f32 v78, v20, v46
    v_fmac_f32 v94, v22, v62
    v_mfma_f32_16x16x32_bf16 v[144:147], a[84:87], a[144:147], v[144:147]
    buffer_load_dwordx4 a[220:223], v1, s[4:7], s60 offen offset:3072 sc1
    v_mfma_f32_16x16x32_bf16 v[144:147], a[80:83], a[128:131], v[144:147]
    v_xor_b32 v12, 0x10000, v12
    v_fmac_f32 v79, v20, v47
    v_mfma_f32_16x16x32_bf16 v[160:163], a[64:67], a[128:131], v[160:163]
    ds_read_b64_tr_b16 a[80:81], v12 offset:0
    v_fmac_f32 v95, v22, v63
    v_mfma_f32_16x16x32_bf16 v[160:163], a[68:71], a[144:147], v[160:163]
    ds_read_b64_tr_b16 a[82:83], v12 offset:4096
    v_fma_f32 v78, -v21, v47, v78
    v_mfma_f32_16x16x32_bf16 v[164:167], a[68:71], a[148:151], v[164:167]
    ds_read_b64_tr_b16 a[84:85], v12 offset:8192
    v_fma_f32 v94, -v23, v63, v94
    v_mfma_f32_16x16x32_bf16 v[164:167], a[64:67], a[132:135], v[164:167]
L_pad8:
    s_cbranch_execz L_pad12
    ds_read_b64_tr_b16 a[86:87], v12 offset:12288
    s_xor_b32 s60, s14, 57344
    s_add_u32 s60, s60, s73
    v_mfma_f32_16x16x32_bf16 v[168:171], a[64:67], a[136:139], v[168:171]
    buffer_load_dwordx4 a[224:227], v1, s[4:7], s60 offen offset:0 sc1
    v_mfma_f32_16x16x32_bf16 v[168:171], a[68:71], a[152:155], v[168:171]
    v_fmac_f32 v79, v21, v46
    v_fmac_f32 v95, v23, v62
    v_mfma_f32_16x16x32_bf16 v[172:175], a[68:71], a[156:159], v[172:175]
    buffer_load_dwordx4 a[228:231], v1, s[4:7], s60 offen offset:1024 sc1
    v_mfma_f32_16x16x32_bf16 v[172:175], a[64:67], a[140:143], v[172:175]
    v_xor_b32 v13, 0x10000, v13
    v_cvt_pk_bf16_f32 v231, v46, v78
    s_waitcnt lgkmcnt(0)
    v_mfma_f32_16x16x32_bf16 v[188:191], a[72:75], a[140:143], v[188:191]
    ds_read_b64_tr_b16 a[64:65], v13 offset:0
    v_cvt_pk_bf16_f32 v239, v62, v94
    v_mfma_f32_16x16x32_bf16 v[188:191], a[76:79], a[156:159], v[188:191]
    ds_read_b64_tr_b16 a[66:67], v13 offset:4096
    v_cvt_pk_bf16_f32 v247, -v47, -v79
    v_mfma_f32_16x16x32_bf16 v[184:187], a[76:79], a[152:155], v[184:187]
    ds_read_b64_tr_b16 a[68:69], v13 offset:8192
    v_cvt_pk_bf16_f32 v255, -v63, -v95
    v_mfma_f32_16x16x32_bf16 v[184:187], a[72:75], a[136:139], v[184:187]
    ds_read_b64_tr_b16 a[70:71], v13 offset:12288
    s_lshl_b32 s65, s3, 12
    v_mfma_f32_16x16x32_bf16 v[180:183], a[72:75], a[132:135], v[180:183]
    s_add_u32 s65, s65, 131072
    v_and_b32 v24, 15, v0
    v_mfma_f32_16x16x32_bf16 v[180:183], a[76:79], a[148:151], v[180:183]
    buffer_load_dwordx4 a[232:235], v1, s[4:7], s60 offen offset:2048 sc1
    v_mfma_f32_16x16x32_bf16 v[176:179], a[76:79], a[144:147], v[176:179]
    v_lshlrev_b32 v27, 1, v24
    v_lshrrev_b32 v18, 4, v0
    v_mfma_f32_16x16x32_bf16 v[176:179], a[72:75], a[128:131], v[176:179]
    v_and_b32 v25, 7, v0
    v_lshlrev_b32 v19, 1, v18
    v_mfma_f32_16x16x32_bf16 v[192:195], a[80:83], a[128:131], v[192:195]
    s_barrier
    ds_read_b64_tr_b16 a[72:73], v6 offset:16384
    v_mfma_f32_16x16x32_bf16 v[192:195], a[84:87], a[144:147], v[192:195]
    ds_read_b64_tr_b16 a[74:75], v6 offset:20480
    v_xor_b32 v25, v25, v19
    v_mfma_f32_16x16x32_bf16 v[196:199], a[84:87], a[148:151], v[196:199]
    ds_read_b64_tr_b16 a[76:77], v6 offset:24576
    v_lshlrev_b32 v25, 4, v25
    v_mfma_f32_16x16x32_bf16 v[196:199], a[80:83], a[132:135], v[196:199]
    ds_read_b64_tr_b16 a[78:79], v6 offset:28672
    v_lshl_add_u32 v24, v24, 7, v25
    v_mfma_f32_16x16x32_bf16 v[200:203], a[80:83], a[136:139], v[200:203]
    buffer_load_dwordx4 a[236:239], v1, s[4:7], s60 offen offset:3072 sc1
    v_mfma_f32_16x16x32_bf16 v[200:203], a[84:87], a[152:155], v[200:203]
    s_xor_b32 s60, s14, 61440
    s_add_u32 s60, s60, s73
    v_mfma_f32_16x16x32_bf16 v[204:207], a[84:87], a[156:159], v[204:207]
    buffer_load_dwordx4 a[240:243], v1, s[4:7], s60 offen offset:0 sc1
    v_mfma_f32_16x16x32_bf16 v[204:207], a[80:83], a[140:143], v[204:207]
    v_add_u32 v24, s65, v24
    v_xor_b32 v25, 16, v24
    s_waitcnt lgkmcnt(0)
    v_mfma_f32_16x16x32_bf16 v[220:223], a[64:67], a[140:143], v[220:223]
    ds_read_b64_tr_b16 a[80:81], v7 offset:16384
    v_bfe_u32 v19, v0, 2, 2
    v_mfma_f32_16x16x32_bf16 v[220:223], a[68:71], a[156:159], v[220:223]
    ds_read_b64_tr_b16 a[82:83], v7 offset:20480
    v_and_b32 v26, 3, v0
    v_mfma_f32_16x16x32_bf16 v[216:219], a[68:71], a[152:155], v[216:219]
    ds_read_b64_tr_b16 a[84:85], v7 offset:24576
    v_lshlrev_b32 v20, 1, v26
    v_mfma_f32_16x16x32_bf16 v[216:219], a[64:67], a[136:139], v[216:219]
    ds_read_b64_tr_b16 a[86:87], v7 offset:28672
    v_xor_b32 v20, v20, v19
    v_mfma_f32_16x16x32_bf16 v[212:215], a[64:67], a[132:135], v[212:215]
    v_lshlrev_b32 v20, 4, v20
    v_lshl_add_u32 v19, v18, 3, v19
    v_mfma_f32_16x16x32_bf16 v[212:215], a[68:71], a[148:151], v[212:215]
    buffer_load_dwordx4 a[244:247], v1, s[4:7], s60 offen offset:1024 sc1
    v_mfma_f32_16x16x32_bf16 v[208:211], a[68:71], a[144:147], v[208:211]
    v_lshl_add_u32 v20, v19, 7, v20
    v_add_u32 v20, s65, v20
    v_mfma_f32_16x16x32_bf16 v[208:211], a[64:67], a[128:131], v[208:211]
    v_xor_b32 v21, 16, v20
    v_xor_b32 v22, 64, v20
    s_waitcnt vmcnt(23)
    v_mfma_f32_16x16x32_bf16 v[96:99], a[72:75], a[160:163], v[96:99]
    s_waitcnt vmcnt(11)
    v_cmp_ne_u32 vcc, 1, v31
    s_and_b64 vcc, vcc, 0xff
    s_cbranch_vccnz L_far7
L_back7:
    ds_read_b64_tr_b16 a[64:65], v8 offset:16384
    v_mfma_f32_16x16x32_bf16 v[96:99], a[76:79], a[176:179], v[96:99]
    ds_read_b64_tr_b16 a[66:67], v8 offset:20480
    v_xor_b32 v23, 64, v21
    v_mfma_f32_16x16x32_bf16 v[100:103], a[76:79], a[180:183], v[100:103]
    ds_read_b64_tr_b16 a[68:69], v8 offset:24576
    v_mfma_f32_16x16x32_bf16 v[100:103], a[72:75], a[164:167], v[100:103]
    ds_read_b64_tr_b16 a[70:71], v8 offset:28672
    v_mfma_f32_16x16x32_bf16 v[104:107], a[72:75], a[168:171], v[104:107]
    buffer_load_dwordx4 a[248:251], v1, s[4:7], s60 offen offset:2048 sc1
    v_mfma_f32_16x16x32_bf16 v[104:107], a[76:79], a[184:187], v[104:107]
    ds_write_b128 v24, v[224:227] offset:0
    v_mfma_f32_16x16x32_bf16 v[108:111], a[76:79], a[188:191], v[108:111]
    buffer_load_dwordx4 a[252:255], v1, s[4:7], s60 offen offset:3072 sc1
    v_mfma_f32_16x16x32_bf16 v[108:111], a[72:75], a[172:175], v[108:111]
    ds_write_b128 v25, v[228:231] offset:0
    s_waitcnt lgkmcnt(2)
    v_mfma_f32_16x16x32_bf16 v[124:127], a[80:83], a[172:175], v[124:127]
    ds_read_b64_tr_b16 a[72:73], v9 offset:16384
    v_mfma_f32_16x16x32_bf16 v[124:127], a[84:87], a[188:191], v[124:127]
    ds_read_b64_tr_b16 a[74:75], v9 offset:20480
    v_mfma_f32_16x16x32_bf16 v[120:123], a[84:87], a[184:187], v[120:123]
    ds_read_b64_tr_b16 a[76:77], v9 offset:24576
    v_mfma_f32_16x16x32_bf16 v[120:123], a[80:83], a[168:171], v[120:123]
    ds_read_b64_tr_b16 a[78:79], v9 offset:28672
    s_add_u32 m0, s63, 32768
    s_add_u32 s61, s10, 131072
    v_mfma_f32_16x16x32_bf16 v[116:119], a[80:83], a[164:167], v[116:119]
    buffer_load_dwordx4 v2, s[24:27], s61 offen offset:0 lds
    v_mfma_f32_16x16x32_bf16 v[116:119], a[84:87], a[180:183], v[116:119]
    ds_write_b128 v24, v[232:235] offset:2048
    v_mfma_f32_16x16x32_bf16 v[112:115], a[84:87], a[176:179], v[112:115]
    buffer_load_dwordx4 v3, s[24:27], s61 offen offset:1024 lds
    v_mfma_f32_16x16x32_bf16 v[112:115], a[80:83], a[160:163], v[112:115]
    ds_write_b128 v25, v[236:239] offset:2048
    v_mfma_f32_16x16x32_bf16 v[128:131], a[64:67], a[160:163], v[128:131]
    ds_read_b64_tr_b16 a[80:81], v10 offset:16384
    v_mfma_f32_16x16x32_bf16 v[128:131], a[68:71], a[176:179], v[128:131]
    ds_read_b64_tr_b16 a[82:83], v10 offset:20480
    v_mfma_f32_16x16x32_bf16 v[132:135], a[68:71], a[180:183], v[132:135]
    ds_read_b64_tr_b16 a[84:85], v10 offset:24576
    v_mfma_f32_16x16x32_bf16 v[132:135], a[64:67], a[164:167], v[132:135]
    ds_read_b64_tr_b16 a[86:87], v10 offset:28672
    v_mfma_f32_16x16x32_bf16 v[136:139], a[64:67], a[168:171], v[136:139]
    ds_read_b64_tr_b16 v[224:225], v20 offset:0
    v_mfma_f32_16x16x32_bf16 v[136:139], a[68:71], a[184:187], v[136:139]
    buffer_load_dwordx4 v4, s[24:27], s61 offen offset:2048 lds
    v_mfma_f32_16x16x32_bf16 v[140:143], a[68:71], a[188:191], v[140:143]
    ds_read_b64_tr_b16 v[226:227], v22 offset:512
    v_mfma_f32_16x16x32_bf16 v[140:143], a[64:67], a[172:175], v[140:143]
    ds_read_b64_tr_b16 v[228:229], v20 offset:8
    s_waitcnt lgkmcnt(3)
    v_mfma_f32_16x16x32_bf16 v[156:159], a[72:75], a[172:175], v[156:159]
    ds_read_b64_tr_b16 a[64:65], v11 offset:16384
    v_mfma_f32_16x16x32_bf16 v[156:159], a[76:79], a[188:191], v[156:159]
    ds_read_b64_tr_b16 a[66:67], v11 offset:20480
    v_mfma_f32_16x16x32_bf16 v[152:155], a[76:79], a[184:187], v[152:155]
    ds_read_b64_tr_b16 a[68:69], v11 offset:24576
    v_mfma_f32_16x16x32_bf16 v[152:155], a[72:75], a[168:171], v[152:155]
    ds_read_b64_tr_b16 a[70:71], v11 offset:28672
    v_mfma_f32_16x16x32_bf16 v[148:151], a[72:75], a[164:167], v[148:151]
    buffer_load_dwordx4 v5, s[24:27], s61 offen offset:3072 lds
    v_mfma_f32_16x16x32_bf16 v[148:151], a[76:79], a[180:183], v[148:151]
    s_add_u32 m0, s63, 49152
    s_add_u32 s61, s11, 131072
    v_mfma_f32_16x16x32_bf16 v[144:147], a[76:79], a[176:179], v[144:147]
    buffer_load_dwordx4 v2, s[24:27], s61 offen offset:0 lds
    v_mfma_f32_16x16x32_bf16 v[144:147], a[72:75], a[160:163], v[144:147]
    ds_read_b64_tr_b16 v[230:231], v22 offset:520
    v_mfma_f32_16x16x32_bf16 v[160:163], a[80:83], a[160:163], v[160:163]
    ds_read_b64_tr_b16 a[72:73], v12 offset:16384
    v_mfma_f32_16x16x32_bf16 v[160:163], a[84:87], a[176:179], v[160:163]
    ds_read_b64_tr_b16 a[74:75], v12 offset:20480
    v_mfma_f32_16x16x32_bf16 v[164:167], a[84:87], a[180:183], v[164:167]
    ds_read_b64_tr_b16 a[76:77], v12 offset:24576
    v_mfma_f32_16x16x32_bf16 v[164:167], a[80:83], a[164:167], v[164:167]
    ds_read_b64_tr_b16 a[78:79], v12 offset:28672
    v_mfma_f32_16x16x32_bf16 v[168:171], a[80:83], a[168:171], v[168:171]
    ds_read_b64_tr_b16 v[232:233], v21 offset:0
    v_mfma_f32_16x16x32_bf16 v[168:171], a[84:87], a[184:187], v[168:171]
    buffer_load_dwordx4 v3, s[24:27], s61 offen offset:1024 lds
    v_mfma_f32_16x16x32_bf16 v[172:175], a[84:87], a[188:191], v[172:175]
    ds_read_b64_tr_b16 v[234:235], v23 offset:512
    v_mfma_f32_16x16x32_bf16 v[172:175], a[80:83], a[172:175], v[172:175]
    ds_read_b64_tr_b16 v[236:237], v21 offset:8
    s_waitcnt lgkmcnt(3)
    v_mfma_f32_16x16x32_bf16 v[188:191], a[64:67], a[172:175], v[188:191]
    ds_read_b64_tr_b16 a[80:81], v13 offset:16384
    v_mfma_f32_16x16x32_bf16 v[188:191], a[68:71], a[188:191], v[188:191]
    ds_read_b64_tr_b16 a[82:83], v13 offset:20480
    v_mfma_f32_16x16x32_bf16 v[184:187], a[68:71], a[184:187], v[184:187]
    ds_read_b64_tr_b16 a[84:85], v13 offset:24576
    v_mfma_f32_16x16x32_bf16 v[184:187], a[64:67], a[168:171], v[184:187]
    ds_read_b64_tr_b16 a[86:87], v13 offset:28672
    v_mfma_f32_16x16x32_bf16 v[180:183], a[64:67], a[164:167], v[180:183]
    buffer_load_dwordx4 v4, s[24:27], s61 offen offset:2048 lds
    v_mfma_f32_16x16x32_bf16 v[180:183], a[68:71], a[180:183], v[180:183]
    ds_read_b64_tr_b16 v[238:239], v23 offset:520
    v_mfma_f32_16x16x32_bf16 v[176:179], a[68:71], a[176:179], v[176:179]
    buffer_load_dwordx4 v5, s[24:27], s61 offen offset:3072 lds
    v_mfma_f32_16x16x32_bf16 v[176:179], a[64:67], a[160:163], v[176:179]
    buffer_store_dwordx4 v[224:227], v1, s[4:7], s80 offen offset:0 sc1
    v_mfma_f32_16x16x32_bf16 v[192:195], a[72:75], a[160:163], v[192:195]
    ds_read_b64_tr_b16 a[64:65], v6 offset:32768
    v_mfma_f32_16x16x32_bf16 v[192:195], a[76:79], a[176:179], v[192:195]
    ds_read_b64_tr_b16 a[66:67], v6 offset:36864
    v_mfma_f32_16x16x32_bf16 v[196:199], a[76:79], a[180:183], v[196:199]
    ds_read_b64_tr_b16 a[68:69], v6 offset:40960
    v_mfma_f32_16x16x32_bf16 v[196:199], a[72:75], a[164:167], v[196:199]
    ds_read_b64_tr_b16 a[70:71], v6 offset:45056
    s_xor_b32 s60, s14, 65536
    s_add_u32 s60, s60, s73
    v_mfma_f32_16x16x32_bf16 v[200:203], a[72:75], a[168:171], v[200:203]
    buffer_load_dwordx4 a[128:131], v1, s[4:7], s60 offen offset:0 sc1
    v_mfma_f32_16x16x32_bf16 v[200:203], a[76:79], a[184:187], v[200:203]
    ds_write_b128 v24, v[240:243] offset:0
    v_mfma_f32_16x16x32_bf16 v[204:207], a[76:79], a[188:191], v[204:207]
    buffer_load_dwordx4 a[132:135], v1, s[4:7], s60 offen offset:1024 sc1
    v_mfma_f32_16x16x32_bf16 v[204:207], a[72:75], a[172:175], v[204:207]
    ds_write_b128 v25, v[244:247] offset:0
    s_waitcnt lgkmcnt(2)
    v_mfma_f32_16x16x32_bf16 v[220:223], a[80:83], a[172:175], v[220:223]
    ds_read_b64_tr_b16 a[72:73], v7 offset:32768
    v_mfma_f32_16x16x32_bf16 v[220:223], a[84:87], a[188:191], v[220:223]
    ds_read_b64_tr_b16 a[74:75], v7 offset:36864
    v_mfma_f32_16x16x32_bf16 v[216:219], a[84:87], a[184:187], v[216:219]
    ds_read_b64_tr_b16 a[76:77], v7 offset:40960
    v_mfma_f32_16x16x32_bf16 v[216:219], a[80:83], a[168:171], v[216:219]
    ds_read_b64_tr_b16 a[78:79], v7 offset:45056
    v_mfma_f32_16x16x32_bf16 v[212:215], a[80:83], a[164:167], v[212:215]
    ds_write_b128 v24, v[248:251] offset:2048
    v_mfma_f32_16x16x32_bf16 v[212:215], a[84:87], a[180:183], v[212:215]
    buffer_load_dwordx4 a[136:139], v1, s[4:7], s60 offen offset:2048 sc1
    v_mfma_f32_16x16x32_bf16 v[208:211], a[84:87], a[176:179], v[208:211]
    ds_write_b128 v25, v[252:255] offset:2048
    v_mfma_f32_16x16x32_bf16 v[208:211], a[80:83], a[160:163], v[208:211]
    ds_read_b64_tr_b16 v[240:241], v20 offset:0
    s_waitcnt vmcnt(20)
    v_mfma_f32_16x16x32_bf16 v[96:99], a[64:67], a[192:195], v[96:99]
    ds_read_b64_tr_b16 a[80:81], v8 offset:32768
    v_mfma_f32_16x16x32_bf16 v[96:99], a[68:71], a[208:211], v[96:99]
    ds_read_b64_tr_b16 a[82:83], v8 offset:36864
    v_mfma_f32_16x16x32_bf16 v[100:103], a[68:71], a[212:215], v[100:103]
    ds_read_b64_tr_b16 a[84:85], v8 offset:40960
    v_mfma_f32_16x16x32_bf16 v[100:103], a[64:67], a[196:199], v[100:103]
    ds_read_b64_tr_b16 a[86:87], v8 offset:45056
    v_mfma_f32_16x16x32_bf16 v[104:107], a[64:67], a[200:203], v[104:107]
    buffer_load_dwordx4 a[140:143], v1, s[4:7], s60 offen offset:3072 sc1
    v_mfma_f32_16x16x32_bf16 v[104:107], a[68:71], a[216:219], v[104:107]
    s_xor_b32 s60, s14, 69632
    s_add_u32 s60, s60, s73
    v_mfma_f32_16x16x32_bf16 v[108:111], a[68:71], a[220:223], v[108:111]
    buffer_load_dwordx4 a[144:147], v1, s[4:7], s60 offen offset:0 sc1
    v_mfma_f32_16x16x32_bf16 v[108:111], a[64:67], a[204:207], v[108:111]
    ds_read_b64_tr_b16 v[242:243], v22 offset:512
    s_waitcnt lgkmcnt(1)
    v_mfma_f32_16x16x32_bf16 v[124:127], a[72:75], a[204:207], v[124:127]
    ds_read_b64_tr_b16 a[64:65], v9 offset:32768
    v_mfma_f32_16x16x32_bf16 v[124:127], a[76:79], a[220:223], v[124:127]
    ds_read_b64_tr_b16 a[66:67], v9 offset:36864
    v_mfma_f32_16x16x32_bf16 v[120:123], a[76:79], a[216:219], v[120:123]
    ds_read_b64_tr_b16 a[68:69], v9 offset:40960
    v_mfma_f32_16x16x32_bf16 v[120:123], a[72:75], a[200:203], v[120:123]
    ds_read_b64_tr_b16 a[70:71], v9 offset:45056
    v_mfma_f32_16x16x32_bf16 v[116:119], a[72:75], a[196:199], v[116:119]
    ds_read_b64_tr_b16 v[244:245], v20 offset:8
    v_mfma_f32_16x16x32_bf16 v[116:119], a[76:79], a[212:215], v[116:119]
    buffer_load_dwordx4 a[148:151], v1, s[4:7], s60 offen offset:1024 sc1
    v_mfma_f32_16x16x32_bf16 v[112:115], a[76:79], a[208:211], v[112:115]
    ds_read_b64_tr_b16 v[246:247], v22 offset:520
    v_mfma_f32_16x16x32_bf16 v[112:115], a[72:75], a[192:195], v[112:115]
    ds_read_b64_tr_b16 v[248:249], v21 offset:0
    v_mfma_f32_16x16x32_bf16 v[128:131], a[80:83], a[192:195], v[128:131]
    ds_read_b64_tr_b16 a[72:73], v10 offset:32768
    v_mfma_f32_16x16x32_bf16 v[128:131], a[84:87], a[208:211], v[128:131]
    ds_read_b64_tr_b16 a[74:75], v10 offset:36864
    v_mfma_f32_16x16x32_bf16 v[132:135], a[84:87], a[212:215], v[132:135]
    ds_read_b64_tr_b16 a[76:77], v10 offset:40960
    v_mfma_f32_16x16x32_bf16 v[132:135], a[80:83], a[196:199], v[132:135]
    ds_read_b64_tr_b16 a[78:79], v10 offset:45056
    v_mfma_f32_16x16x32_bf16 v[136:139], a[80:83], a[200:203], v[136:139]
    buffer_load_dwordx4 a[152:155], v1, s[4:7], s60 offen offset:2048 sc1
    v_mfma_f32_16x16x32_bf16 v[136:139], a[84:87], a[216:219], v[136:139]
    ds_read_b64_tr_b16 v[250:251], v23 offset:512
    v_mfma_f32_16x16x32_bf16 v[140:143], a[84:87], a[220:223], v[140:143]
    buffer_load_dwordx4 a[156:159], v1, s[4:7], s60 offen offset:3072 sc1
    v_mfma_f32_16x16x32_bf16 v[140:143], a[80:83], a[204:207], v[140:143]
    ds_read_b64_tr_b16 v[252:253], v21 offset:8
    s_waitcnt lgkmcnt(2)
    v_mfma_f32_16x16x32_bf16 v[156:159], a[64:67], a[204:207], v[156:159]
    ds_read_b64_tr_b16 a[80:81], v11 offset:32768
    v_mfma_f32_16x16x32_bf16 v[156:159], a[68:71], a[220:223], v[156:159]
    ds_read_b64_tr_b16 a[82:83], v11 offset:36864
    v_mfma_f32_16x16x32_bf16 v[152:155], a[68:71], a[216:219], v[152:155]
    ds_read_b64_tr_b16 a[84:85], v11 offset:40960
    v_mfma_f32_16x16x32_bf16 v[152:155], a[64:67], a[200:203], v[152:155]
    ds_read_b64_tr_b16 a[86:87], v11 offset:45056
    s_xor_b32 s60, s14, 73728
    s_add_u32 s60, s60, s73
    v_mfma_f32_16x16x32_bf16 v[148:151], a[64:67], a[196:199], v[148:151]
    buffer_load_dwordx4 a[160:163], v1, s[4:7], s60 offen offset:0 sc1
    v_mfma_f32_16x16x32_bf16 v[148:151], a[68:71], a[212:215], v[148:151]
    ds_read_b64_tr_b16 v[254:255], v23 offset:520
    v_mfma_f32_16x16x32_bf16 v[144:147], a[68:71], a[208:211], v[144:147]
    buffer_load_dwordx4 a[164:167], v1, s[4:7], s60 offen offset:1024 sc1
    v_mfma_f32_16x16x32_bf16 v[144:147], a[64:67], a[192:195], v[144:147]
    buffer_store_dwordx4 v[228:231], v1, s[4:7], s80 offen offset:1024 sc1
    v_mfma_f32_16x16x32_bf16 v[160:163], a[72:75], a[192:195], v[160:163]
    ds_read_b64_tr_b16 a[64:65], v12 offset:32768
    v_bfe_u32 v19, v0, 1, 3
    v_mfma_f32_16x16x32_bf16 v[160:163], a[76:79], a[208:211], v[160:163]
    ds_read_b64_tr_b16 a[66:67], v12 offset:36864
    v_xor_b32 v19, v19, v18
    v_mfma_f32_16x16x32_bf16 v[164:167], a[76:79], a[212:215], v[164:167]
    ds_read_b64_tr_b16 a[68:69], v12 offset:40960
    v_lshlrev_b32 v24, 6, v27
    v_mfma_f32_16x16x32_bf16 v[164:167], a[72:75], a[196:199], v[164:167]
    ds_read_b64_tr_b16 a[70:71], v12 offset:45056
    v_lshl_add_u32 v20, v19, 4, v24
    v_mfma_f32_16x16x32_bf16 v[168:171], a[72:75], a[200:203], v[168:171]
    v_xor_b32 v21, 64, v20
    v_xor_b32 v22, 0x10000, v20
    v_mfma_f32_16x16x32_bf16 v[168:171], a[76:79], a[216:219], v[168:171]
    buffer_load_dwordx4 a[168:171], v1, s[4:7], s60 offen offset:2048 sc1
    v_mfma_f32_16x16x32_bf16 v[172:175], a[76:79], a[220:223], v[172:175]
    v_xor_b32 v23, 0x10000, v21
    v_bfe_u32 v19, v0, 2, 2
    v_mfma_f32_16x16x32_bf16 v[172:175], a[72:75], a[204:207], v[172:175]
    v_lshl_add_u32 v25, v19, 4, v26
    v_lshlrev_b32 v19, 5, v27
    s_waitcnt lgkmcnt(0)
    v_mfma_f32_16x16x32_bf16 v[188:191], a[80:83], a[204:207], v[188:191]
    ds_read_b64_tr_b16 a[72:73], v13 offset:32768
    v_lshl_add_u32 v26, v18, 4, v19
    v_mfma_f32_16x16x32_bf16 v[188:191], a[84:87], a[220:223], v[188:191]
    ds_read_b64_tr_b16 a[74:75], v13 offset:36864
    v_add_u32 v26, s78, v26
    v_mfma_f32_16x16x32_bf16 v[184:187], a[84:87], a[216:219], v[184:187]
    ds_read_b64_tr_b16 a[76:77], v13 offset:40960
    v_mfma_f32_16x16x32_bf16 v[184:187], a[80:83], a[200:203], v[184:187]
    ds_read_b64_tr_b16 a[78:79], v13 offset:45056
    v_mfma_f32_16x16x32_bf16 v[180:183], a[80:83], a[196:199], v[180:183]
    buffer_load_dwordx4 a[172:175], v1, s[4:7], s60 offen offset:3072 sc1
    v_mfma_f32_16x16x32_bf16 v[180:183], a[84:87], a[212:215], v[180:183]
    s_xor_b32 s60, s14, 77824
    s_add_u32 s60, s60, s73
    v_mfma_f32_16x16x32_bf16 v[176:179], a[84:87], a[208:211], v[176:179]
    buffer_load_dwordx4 a[176:179], v1, s[4:7], s60 offen offset:0 sc1
    v_mfma_f32_16x16x32_bf16 v[176:179], a[80:83], a[192:195], v[176:179]
    v_mfma_f32_16x16x32_bf16 v[192:195], a[64:67], a[192:195], v[192:195]
    s_barrier
    ds_read_b64_tr_b16 a[80:81], v6 offset:49152
    v_mfma_f32_16x16x32_bf16 v[192:195], a[68:71], a[208:211], v[192:195]
    ds_read_b64_tr_b16 a[82:83], v6 offset:53248
    v_mfma_f32_16x16x32_bf16 v[196:199], a[68:71], a[212:215], v[196:199]
    ds_read_b64_tr_b16 a[84:85], v6 offset:57344
    v_mfma_f32_16x16x32_bf16 v[196:199], a[64:67], a[196:199], v[196:199]
    ds_read_b64_tr_b16 a[86:87], v6 offset:61440
    v_mfma_f32_16x16x32_bf16 v[200:203], a[64:67], a[200:203], v[200:203]
    v_mfma_f32_16x16x32_bf16 v[200:203], a[68:71], a[216:219], v[200:203]
    buffer_load_dwordx4 a[180:183], v1, s[4:7], s60 offen offset:1024 sc1
    v_mfma_f32_16x16x32_bf16 v[204:207], a[68:71], a[220:223], v[204:207]
    v_mfma_f32_16x16x32_bf16 v[204:207], a[64:67], a[204:207], v[204:207]
    s_waitcnt lgkmcnt(0)
    v_mfma_f32_16x16x32_bf16 v[220:223], a[72:75], a[204:207], v[220:223]
    ds_read_b64_tr_b16 a[64:65], v7 offset:49152
    v_mfma_f32_16x16x32_bf16 v[220:223], a[76:79], a[220:223], v[220:223]
    ds_read_b64_tr_b16 a[66:67], v7 offset:53248
    v_mfma_f32_16x16x32_bf16 v[216:219], a[76:79], a[216:219], v[216:219]
    ds_read_b64_tr_b16 a[68:69], v7 offset:57344
    v_mfma_f32_16x16x32_bf16 v[216:219], a[72:75], a[200:203], v[216:219]
    ds_read_b64_tr_b16 a[70:71], v7 offset:61440
    v_mfma_f32_16x16x32_bf16 v[212:215], a[72:75], a[196:199], v[212:215]
    buffer_load_dwordx4 a[184:187], v1, s[4:7], s60 offen offset:2048 sc1
    v_mfma_f32_16x16x32_bf16 v[212:215], a[76:79], a[212:215], v[212:215]
    buffer_store_dwordx4 v[232:235], v1, s[4:7], s80 offen offset:2048 sc1
    v_mfma_f32_16x16x32_bf16 v[208:211], a[76:79], a[208:211], v[208:211]
    buffer_load_dwordx4 a[188:191], v1, s[4:7], s60 offen offset:3072 sc1
    v_mfma_f32_16x16x32_bf16 v[208:211], a[72:75], a[192:195], v[208:211]
    s_waitcnt vmcnt(27)
    v_mfma_f32_16x16x32_bf16 v[96:99], a[80:83], a[224:227], v[96:99]
    ds_read_b64_tr_b16 a[72:73], v8 offset:49152
    v_mfma_f32_16x16x32_bf16 v[96:99], a[84:87], a[240:243], v[96:99]
    ds_read_b64_tr_b16 a[74:75], v8 offset:53248
    v_mfma_f32_16x16x32_bf16 v[100:103], a[84:87], a[244:247], v[100:103]
    ds_read_b64_tr_b16 a[76:77], v8 offset:57344
    v_mfma_f32_16x16x32_bf16 v[100:103], a[80:83], a[228:231], v[100:103]
    ds_read_b64_tr_b16 a[78:79], v8 offset:61440
    s_add_u32 m0, s63, 65536
    s_mov_b32 s61, s12
    v_mfma_f32_16x16x32_bf16 v[104:107], a[80:83], a[232:235], v[104:107]
    buffer_load_dwordx4 v2, s[24:27], s61 offen offset:0 lds
    v_mfma_f32_16x16x32_bf16 v[104:107], a[84:87], a[248:251], v[104:107]
    v_mfma_f32_16x16x32_bf16 v[108:111], a[84:87], a[252:255], v[108:111]
    buffer_load_dwordx4 v3, s[24:27], s61 offen offset:1024 lds
    v_mfma_f32_16x16x32_bf16 v[108:111], a[80:83], a[236:239], v[108:111]
    s_waitcnt lgkmcnt(0)
    v_mfma_f32_16x16x32_bf16 v[124:127], a[64:67], a[236:239], v[124:127]
    ds_read_b64_tr_b16 a[80:81], v9 offset:49152
    v_mfma_f32_16x16x32_bf16 v[124:127], a[68:71], a[252:255], v[124:127]
    ds_read_b64_tr_b16 a[82:83], v9 offset:53248
    v_mfma_f32_16x16x32_bf16 v[120:123], a[68:71], a[248:251], v[120:123]
    ds_read_b64_tr_b16 a[84:85], v9 offset:57344
    v_mfma_f32_16x16x32_bf16 v[120:123], a[64:67], a[232:235], v[120:123]
    ds_read_b64_tr_b16 a[86:87], v9 offset:61440
    v_mfma_f32_16x16x32_bf16 v[116:119], a[64:67], a[228:231], v[116:119]
    v_mfma_f32_16x16x32_bf16 v[116:119], a[68:71], a[244:247], v[116:119]
    buffer_load_dwordx4 v4, s[24:27], s61 offen offset:2048 lds
    v_mfma_f32_16x16x32_bf16 v[112:115], a[68:71], a[240:243], v[112:115]
    buffer_store_dwordx4 v[236:239], v1, s[4:7], s80 offen offset:3072 sc1
    s_add_u32 s80, s80, 8192
    v_mfma_f32_16x16x32_bf16 v[112:115], a[64:67], a[224:227], v[112:115]
    v_mfma_f32_16x16x32_bf16 v[128:131], a[72:75], a[224:227], v[128:131]
    ds_read_b64_tr_b16 a[64:65], v10 offset:49152
    v_mfma_f32_16x16x32_bf16 v[128:131], a[76:79], a[240:243], v[128:131]
    ds_read_b64_tr_b16 a[66:67], v10 offset:53248
    v_mfma_f32_16x16x32_bf16 v[132:135], a[76:79], a[244:247], v[132:135]
    ds_read_b64_tr_b16 a[68:69], v10 offset:57344
    v_mfma_f32_16x16x32_bf16 v[132:135], a[72:75], a[228:231], v[132:135]
    ds_read_b64_tr_b16 a[70:71], v10 offset:61440
    v_mfma_f32_16x16x32_bf16 v[136:139], a[72:75], a[232:235], v[136:139]
    buffer_load_dwordx4 v5, s[24:27], s61 offen offset:3072 lds
    v_mfma_f32_16x16x32_bf16 v[136:139], a[76:79], a[248:251], v[136:139]
    s_add_u32 m0, s63, 81920
    s_mov_b32 s61, s13
    v_mfma_f32_16x16x32_bf16 v[140:143], a[76:79], a[252:255], v[140:143]
    buffer_load_dwordx4 v2, s[24:27], s61 offen offset:0 lds
    v_mfma_f32_16x16x32_bf16 v[140:143], a[72:75], a[236:239], v[140:143]
    s_waitcnt lgkmcnt(0)
    v_mfma_f32_16x16x32_bf16 v[156:159], a[80:83], a[236:239], v[156:159]
    ds_read_b64_tr_b16 a[72:73], v11 offset:49152
    v_mfma_f32_16x16x32_bf16 v[156:159], a[84:87], a[252:255], v[156:159]
    ds_read_b64_tr_b16 a[74:75], v11 offset:53248
    v_mfma_f32_16x16x32_bf16 v[152:155], a[84:87], a[248:251], v[152:155]
    ds_read_b64_tr_b16 a[76:77], v11 offset:57344
    v_mfma_f32_16x16x32_bf16 v[152:155], a[80:83], a[232:235], v[152:155]
    ds_read_b64_tr_b16 a[78:79], v11 offset:61440
    v_mfma_f32_16x16x32_bf16 v[148:151], a[80:83], a[228:231], v[148:151]
    v_mfma_f32_16x16x32_bf16 v[148:151], a[84:87], a[244:247], v[148:151]
    buffer_load_dwordx4 v3, s[24:27], s61 offen offset:1024 lds
    v_mfma_f32_16x16x32_bf16 v[144:147], a[84:87], a[240:243], v[144:147]
    v_mfma_f32_16x16x32_bf16 v[144:147], a[80:83], a[224:227], v[144:147]
    buffer_store_dwordx4 v[240:243], v1, s[4:7], s80 offen offset:0 sc1
    v_mfma_f32_16x16x32_bf16 v[160:163], a[64:67], a[224:227], v[160:163]
    ds_read_b64_tr_b16 a[80:81], v12 offset:49152
    v_mfma_f32_16x16x32_bf16 v[160:163], a[68:71], a[240:243], v[160:163]
    ds_read_b64_tr_b16 a[82:83], v12 offset:53248
    v_mfma_f32_16x16x32_bf16 v[164:167], a[68:71], a[244:247], v[164:167]
    ds_read_b64_tr_b16 a[84:85], v12 offset:57344
    v_mfma_f32_16x16x32_bf16 v[164:167], a[64:67], a[228:231], v[164:167]
    ds_read_b64_tr_b16 a[86:87], v12 offset:61440
    v_mfma_f32_16x16x32_bf16 v[168:171], a[64:67], a[232:235], v[168:171]
    buffer_load_dwordx4 v4, s[24:27], s61 offen offset:2048 lds
    v_mfma_f32_16x16x32_bf16 v[168:171], a[68:71], a[248:251], v[168:171]
    v_mfma_f32_16x16x32_bf16 v[172:175], a[68:71], a[252:255], v[172:175]
    buffer_load_dwordx4 v5, s[24:27], s61 offen offset:3072 lds
    v_mfma_f32_16x16x32_bf16 v[172:175], a[64:67], a[236:239], v[172:175]
    s_waitcnt lgkmcnt(0)
    v_mfma_f32_16x16x32_bf16 v[188:191], a[72:75], a[236:239], v[188:191]
    ds_read_b64_tr_b16 a[64:65], v13 offset:49152
    v_mfma_f32_16x16x32_bf16 v[188:191], a[76:79], a[252:255], v[188:191]
    ds_read_b64_tr_b16 a[66:67], v13 offset:53248
    v_mfma_f32_16x16x32_bf16 v[184:187], a[76:79], a[248:251], v[184:187]
    ds_read_b64_tr_b16 a[68:69], v13 offset:57344
    v_mfma_f32_16x16x32_bf16 v[184:187], a[72:75], a[232:235], v[184:187]
    ds_read_b64_tr_b16 a[70:71], v13 offset:61440
    s_xor_b32 s60, s14, 81920
    s_add_u32 s60, s60, s73
    v_mfma_f32_16x16x32_bf16 v[180:183], a[72:75], a[228:231], v[180:183]
    buffer_load_dwordx4 a[192:195], v1, s[4:7], s60 offen offset:0 sc1
    v_mfma_f32_16x16x32_bf16 v[180:183], a[76:79], a[244:247], v[180:183]
    v_mfma_f32_16x16x32_bf16 v[176:179], a[76:79], a[240:243], v[176:179]
    buffer_load_dwordx4 a[196:199], v1, s[4:7], s60 offen offset:1024 sc1
    v_mfma_f32_16x16x32_bf16 v[176:179], a[72:75], a[224:227], v[176:179]
    v_xor_b32 v6, 0x10000, v6
    v_mfma_f32_16x16x32_bf16 v[192:195], a[80:83], a[224:227], v[192:195]
    ds_read_b64_tr_b16 a[72:73], v6 offset:0
    v_mfma_f32_16x16x32_bf16 v[192:195], a[84:87], a[240:243], v[192:195]
    ds_read_b64_tr_b16 a[74:75], v6 offset:4096
    v_mfma_f32_16x16x32_bf16 v[196:199], a[84:87], a[244:247], v[196:199]
    ds_read_b64_tr_b16 a[76:77], v6 offset:8192
    v_mfma_f32_16x16x32_bf16 v[196:199], a[80:83], a[228:231], v[196:199]
    ds_read_b64_tr_b16 a[78:79], v6 offset:12288
    v_mfma_f32_16x16x32_bf16 v[200:203], a[80:83], a[232:235], v[200:203]
    buffer_store_dwordx4 v[244:247], v1, s[4:7], s80 offen offset:1024 sc1
    v_mfma_f32_16x16x32_bf16 v[200:203], a[84:87], a[248:251], v[200:203]
    buffer_load_dwordx4 a[200:203], v1, s[4:7], s60 offen offset:2048 sc1
    v_mfma_f32_16x16x32_bf16 v[204:207], a[84:87], a[252:255], v[204:207]
    v_mfma_f32_16x16x32_bf16 v[204:207], a[80:83], a[236:239], v[204:207]
    v_xor_b32 v7, 0x10000, v7
    s_waitcnt lgkmcnt(0)
    v_mfma_f32_16x16x32_bf16 v[220:223], a[64:67], a[236:239], v[220:223]
    ds_read_b64_tr_b16 a[80:81], v7 offset:0
    v_mfma_f32_16x16x32_bf16 v[220:223], a[68:71], a[252:255], v[220:223]
    ds_read_b64_tr_b16 a[82:83], v7 offset:4096
    v_mfma_f32_16x16x32_bf16 v[216:219], a[68:71], a[248:251], v[216:219]
    ds_read_b64_tr_b16 a[84:85], v7 offset:8192
    v_mfma_f32_16x16x32_bf16 v[216:219], a[64:67], a[232:235], v[216:219]
    ds_read_b64_tr_b16 a[86:87], v7 offset:12288
    v_mfma_f32_16x16x32_bf16 v[212:215], a[64:67], a[228:231], v[212:215]
    buffer_load_dwordx4 a[204:207], v1, s[4:7], s60 offen offset:3072 sc1
    v_mfma_f32_16x16x32_bf16 v[212:215], a[68:71], a[244:247], v[212:215]
    s_xor_b32 s60, s14, 86016
    s_add_u32 s60, s60, s73
    v_mfma_f32_16x16x32_bf16 v[208:211], a[68:71], a[240:243], v[208:211]
    buffer_load_dwordx4 a[208:211], v1, s[4:7], s60 offen offset:0 sc1
    v_mfma_f32_16x16x32_bf16 v[208:211], a[64:67], a[224:227], v[208:211]
    v_xor_b32 v8, 0x10000, v8
    s_waitcnt vmcnt(26)
    v_mfma_f32_16x16x32_bf16 v[96:99], a[72:75], a[128:131], v[96:99]
    ds_read_b64_tr_b16 a[64:65], v8 offset:0
    v_mfma_f32_16x16x32_bf16 v[96:99], a[76:79], a[144:147], v[96:99]
    ds_read_b64_tr_b16 a[66:67], v8 offset:4096
    v_mfma_f32_16x16x32_bf16 v[100:103], a[76:79], a[148:151], v[100:103]
    ds_read_b64_tr_b16 a[68:69], v8 offset:8192
    v_mfma_f32_16x16x32_bf16 v[100:103], a[72:75], a[132:135], v[100:103]
    ds_read_b64_tr_b16 a[70:71], v8 offset:12288
    v_mfma_f32_16x16x32_bf16 v[104:107], a[72:75], a[136:139], v[104:107]
    buffer_store_dwordx4 v[248:251], v1, s[4:7], s80 offen offset:2048 sc1
    v_mfma_f32_16x16x32_bf16 v[104:107], a[76:79], a[152:155], v[104:107]
    buffer_load_dwordx4 a[212:215], v1, s[4:7], s60 offen offset:1024 sc1
    v_mfma_f32_16x16x32_bf16 v[108:111], a[76:79], a[156:159], v[108:111]
    v_mfma_f32_16x16x32_bf16 v[108:111], a[72:75], a[140:143], v[108:111]
    v_xor_b32 v9, 0x10000, v9
    s_waitcnt lgkmcnt(0)
    v_mfma_f32_16x16x32_bf16 v[124:127], a[80:83], a[140:143], v[124:127]
    ds_read_b64_tr_b16 a[72:73], v9 offset:0
    v_mfma_f32_16x16x32_bf16 v[124:127], a[84:87], a[156:159], v[124:127]
    ds_read_b64_tr_b16 a[74:75], v9 offset:4096
    v_mfma_f32_16x16x32_bf16 v[120:123], a[84:87], a[152:155], v[120:123]
    ds_read_b64_tr_b16 a[76:77], v9 offset:8192
    v_mfma_f32_16x16x32_bf16 v[120:123], a[80:83], a[136:139], v[120:123]
    ds_read_b64_tr_b16 a[78:79], v9 offset:12288
    v_mfma_f32_16x16x32_bf16 v[116:119], a[80:83], a[132:135], v[116:119]
    buffer_load_dwordx4 a[216:219], v1, s[4:7], s60 offen offset:2048 sc1
    v_mfma_f32_16x16x32_bf16 v[116:119], a[84:87], a[148:151], v[116:119]
    v_mfma_f32_16x16x32_bf16 v[112:115], a[84:87], a[144:147], v[112:115]
    buffer_load_dwordx4 a[220:223], v1, s[4:7], s60 offen offset:3072 sc1
    v_mfma_f32_16x16x32_bf16 v[112:115], a[80:83], a[128:131], v[112:115]
    v_xor_b32 v10, 0x10000, v10
    v_mfma_f32_16x16x32_bf16 v[128:131], a[64:67], a[128:131], v[128:131]
    ds_read_b64_tr_b16 a[80:81], v10 offset:0
    v_mfma_f32_16x16x32_bf16 v[128:131], a[68:71], a[144:147], v[128:131]
    ds_read_b64_tr_b16 a[82:83], v10 offset:4096
    v_mfma_f32_16x16x32_bf16 v[132:135], a[68:71], a[148:151], v[132:135]
    ds_read_b64_tr_b16 a[84:85], v10 offset:8192
    v_mfma_f32_16x16x32_bf16 v[132:135], a[64:67], a[132:135], v[132:135]
    ds_read_b64_tr_b16 a[86:87], v10 offset:12288
    s_xor_b32 s60, s14, 90112
    s_add_u32 s60, s60, s73
    v_mfma_f32_16x16x32_bf16 v[136:139], a[64:67], a[136:139], v[136:139]
    buffer_load_dwordx4 a[224:227], v1, s[4:7], s60 offen offset:0 sc1
L_pad9:
    s_cbranch_execz L_warm_ret
    v_mfma_f32_16x16x32_bf16 v[136:139], a[68:71], a[152:155], v[136:139]
    buffer_store_dwordx4 v[252:255], v1, s[4:7], s80 offen offset:3072 sc1
    v_mfma_f32_16x16x32_bf16 v[140:143], a[68:71], a[156:159], v[140:143]
    buffer_load_dwordx4 a[228:231], v1, s[4:7], s60 offen offset:1024 sc1
    v_mfma_f32_16x16x32_bf16 v[140:143], a[64:67], a[140:143], v[140:143]
    v_xor_b32 v11, 0x10000, v11
    s_waitcnt lgkmcnt(0)
    v_mfma_f32_16x16x32_bf16 v[156:159], a[72:75], a[140:143], v[156:159]
    ds_read_b64_tr_b16 a[64:65], v11 offset:0
    v_mfma_f32_16x16x32_bf16 v[156:159], a[76:79], a[156:159], v[156:159]
    ds_read_b64_tr_b16 a[66:67], v11 offset:4096
    v_mfma_f32_16x16x32_bf16 v[152:155], a[76:79], a[152:155], v[152:155]
    ds_read_b64_tr_b16 a[68:69], v11 offset:8192
    v_mfma_f32_16x16x32_bf16 v[152:155], a[72:75], a[136:139], v[152:155]
    ds_read_b64_tr_b16 a[70:71], v11 offset:12288
    v_mfma_f32_16x16x32_bf16 v[148:151], a[72:75], a[132:135], v[148:151]
    v_mfma_f32_16x16x32_bf16 v[148:151], a[76:79], a[148:151], v[148:151]
    buffer_load_dwordx4 a[232:235], v1, s[4:7], s60 offen offset:2048 sc1
    v_mfma_f32_16x16x32_bf16 v[144:147], a[76:79], a[144:147], v[144:147]
    v_mfma_f32_16x16x32_bf16 v[144:147], a[72:75], a[128:131], v[144:147]
    v_xor_b32 v12, 0x10000, v12
    v_mfma_f32_16x16x32_bf16 v[160:163], a[80:83], a[128:131], v[160:163]
    ds_read_b64_tr_b16 a[72:73], v12 offset:0
    v_mfma_f32_16x16x32_bf16 v[160:163], a[84:87], a[144:147], v[160:163]
    ds_read_b64_tr_b16 a[74:75], v12 offset:4096
    v_mfma_f32_16x16x32_bf16 v[164:167], a[84:87], a[148:151], v[164:167]
    ds_read_b64_tr_b16 a[76:77], v12 offset:8192
    v_mfma_f32_16x16x32_bf16 v[164:167], a[80:83], a[132:135], v[164:167]
    ds_read_b64_tr_b16 a[78:79], v12 offset:12288
    v_mfma_f32_16x16x32_bf16 v[168:171], a[80:83], a[136:139], v[168:171]
    buffer_load_dwordx4 a[236:239], v1, s[4:7], s60 offen offset:3072 sc1
    v_mfma_f32_16x16x32_bf16 v[168:171], a[84:87], a[152:155], v[168:171]
    s_xor_b32 s60, s14, 94208
    s_add_u32 s60, s60, s73
    v_mfma_f32_16x16x32_bf16 v[172:175], a[84:87], a[156:159], v[172:175]
    buffer_load_dwordx4 a[240:243], v1, s[4:7], s60 offen offset:0 sc1
    v_mfma_f32_16x16x32_bf16 v[172:175], a[80:83], a[140:143], v[172:175]
    v_xor_b32 v13, 0x10000, v13
    s_waitcnt lgkmcnt(0)
    v_mfma_f32_16x16x32_bf16 v[188:191], a[64:67], a[140:143], v[188:191]
    ds_read_b64_tr_b16 a[80:81], v13 offset:0
    v_mfma_f32_16x16x32_bf16 v[188:191], a[68:71], a[156:159], v[188:191]
    ds_read_b64_tr_b16 a[82:83], v13 offset:4096
    v_mfma_f32_16x16x32_bf16 v[184:187], a[68:71], a[152:155], v[184:187]
    ds_read_b64_tr_b16 a[84:85], v13 offset:8192
    v_mfma_f32_16x16x32_bf16 v[184:187], a[64:67], a[136:139], v[184:187]
    ds_read_b64_tr_b16 a[86:87], v13 offset:12288
    v_mfma_f32_16x16x32_bf16 v[180:183], a[64:67], a[132:135], v[180:183]
    v_mfma_f32_16x16x32_bf16 v[180:183], a[68:71], a[148:151], v[180:183]
    buffer_load_dwordx4 a[244:247], v1, s[4:7], s60 offen offset:1024 sc1
    v_mfma_f32_16x16x32_bf16 v[176:179], a[68:71], a[144:147], v[176:179]
    v_mfma_f32_16x16x32_bf16 v[176:179], a[64:67], a[128:131], v[176:179]
    v_mfma_f32_16x16x32_bf16 v[192:195], a[72:75], a[128:131], v[192:195]
    s_barrier
    ds_read_b64_tr_b16 a[64:65], v6 offset:16384
    v_mfma_f32_16x16x32_bf16 v[192:195], a[76:79], a[144:147], v[192:195]
    ds_read_b64_tr_b16 a[66:67], v6 offset:20480
    v_mfma_f32_16x16x32_bf16 v[196:199], a[76:79], a[148:151], v[196:199]
    ds_read_b64_tr_b16 a[68:69], v6 offset:24576
    v_mfma_f32_16x16x32_bf16 v[196:199], a[72:75], a[132:135], v[196:199]
    ds_read_b64_tr_b16 a[70:71], v6 offset:28672
    v_mfma_f32_16x16x32_bf16 v[200:203], a[72:75], a[136:139], v[200:203]
    buffer_load_dwordx4 a[248:251], v1, s[4:7], s60 offen offset:2048 sc1
    v_mfma_f32_16x16x32_bf16 v[200:203], a[76:79], a[152:155], v[200:203]
    v_mfma_f32_16x16x32_bf16 v[204:207], a[76:79], a[156:159], v[204:207]
    buffer_load_dwordx4 a[252:255], v1, s[4:7], s60 offen offset:3072 sc1
    v_mfma_f32_16x16x32_bf16 v[204:207], a[72:75], a[140:143], v[204:207]
    s_waitcnt lgkmcnt(0)
    v_mfma_f32_16x16x32_bf16 v[220:223], a[80:83], a[140:143], v[220:223]
    ds_read_b64_tr_b16 a[72:73], v7 offset:16384
    v_mfma_f32_16x16x32_bf16 v[220:223], a[84:87], a[156:159], v[220:223]
    ds_read_b64_tr_b16 a[74:75], v7 offset:20480
    v_mfma_f32_16x16x32_bf16 v[216:219], a[84:87], a[152:155], v[216:219]
    ds_read_b64_tr_b16 a[76:77], v7 offset:24576
    v_mfma_f32_16x16x32_bf16 v[216:219], a[80:83], a[136:139], v[216:219]
    ds_read_b64_tr_b16 a[78:79], v7 offset:28672
    s_add_u32 m0, s63, 98304
    s_xor_b32 s61, s62, 0
    v_mfma_f32_16x16x32_bf16 v[212:215], a[80:83], a[132:135], v[212:215]
    buffer_load_dwordx4 v14, s[28:31], s61 offen offset:0 lds
    v_mfma_f32_16x16x32_bf16 v[212:215], a[84:87], a[148:151], v[212:215]
    v_mfma_f32_16x16x32_bf16 v[208:211], a[84:87], a[144:147], v[208:211]
    buffer_load_dwordx4 v15, s[28:31], s61 offen offset:1024 lds
    v_mfma_f32_16x16x32_bf16 v[208:211], a[80:83], a[128:131], v[208:211]
    s_waitcnt vmcnt(31)
    v_mfma_f32_16x16x32_bf16 v[96:99], a[64:67], a[160:163], v[96:99]
    ds_read_b64_tr_b16 a[80:81], v8 offset:16384
    v_mfma_f32_16x16x32_bf16 v[96:99], a[68:71], a[176:179], v[96:99]
    ds_read_b64_tr_b16 a[82:83], v8 offset:20480
    v_mfma_f32_16x16x32_bf16 v[100:103], a[68:71], a[180:183], v[100:103]
    ds_read_b64_tr_b16 a[84:85], v8 offset:24576
    v_mfma_f32_16x16x32_bf16 v[100:103], a[64:67], a[164:167], v[100:103]
    ds_read_b64_tr_b16 a[86:87], v8 offset:28672
    v_mfma_f32_16x16x32_bf16 v[104:107], a[64:67], a[168:171], v[104:107]
    v_mfma_f32_16x16x32_bf16 v[104:107], a[68:71], a[184:187], v[104:107]
    buffer_load_dwordx4 v16, s[28:31], s61 offen offset:2048 lds
    v_mfma_f32_16x16x32_bf16 v[108:111], a[68:71], a[188:191], v[108:111]
    v_mfma_f32_16x16x32_bf16 v[108:111], a[64:67], a[172:175], v[108:111]
    s_waitcnt lgkmcnt(0)
    v_mfma_f32_16x16x32_bf16 v[124:127], a[72:75], a[172:175], v[124:127]
    ds_read_b64_tr_b16 a[64:65], v9 offset:16384
    v_mfma_f32_16x16x32_bf16 v[124:127], a[76:79], a[188:191], v[124:127]
    ds_read_b64_tr_b16 a[66:67], v9 offset:20480
    v_mfma_f32_16x16x32_bf16 v[120:123], a[76:79], a[184:187], v[120:123]
    ds_read_b64_tr_b16 a[68:69], v9 offset:24576
    v_mfma_f32_16x16x32_bf16 v[120:123], a[72:75], a[168:171], v[120:123]
    ds_read_b64_tr_b16 a[70:71], v9 offset:28672
    v_mfma_f32_16x16x32_bf16 v[116:119], a[72:75], a[164:167], v[116:119]
    buffer_load_dwordx4 v17, s[28:31], s61 offen offset:3072 lds
    v_mfma_f32_16x16x32_bf16 v[116:119], a[76:79], a[180:183], v[116:119]
    s_add_u32 m0, s63, 114688
    s_xor_b32 s61, s62, 0
    v_mfma_f32_16x16x32_bf16 v[112:115], a[76:79], a[176:179], v[112:115]
    buffer_load_dwordx4 v14, s[32:35], s61 offen offset:0 lds
    v_mfma_f32_16x16x32_bf16 v[112:115], a[72:75], a[160:163], v[112:115]
    v_mfma_f32_16x16x32_bf16 v[128:131], a[80:83], a[160:163], v[128:131]
    ds_read_b64_tr_b16 a[72:73], v10 offset:16384
    v_mfma_f32_16x16x32_bf16 v[128:131], a[84:87], a[176:179], v[128:131]
    ds_read_b64_tr_b16 a[74:75], v10 offset:20480
    v_mfma_f32_16x16x32_bf16 v[132:135], a[84:87], a[180:183], v[132:135]
    ds_read_b64_tr_b16 a[76:77], v10 offset:24576
    v_mfma_f32_16x16x32_bf16 v[132:135], a[80:83], a[164:167], v[132:135]
    ds_read_b64_tr_b16 a[78:79], v10 offset:28672
    v_mfma_f32_16x16x32_bf16 v[136:139], a[80:83], a[168:171], v[136:139]
    v_mfma_f32_16x16x32_bf16 v[136:139], a[84:87], a[184:187], v[136:139]
    buffer_load_dwordx4 v15, s[32:35], s61 offen offset:1024 lds
    v_mfma_f32_16x16x32_bf16 v[140:143], a[84:87], a[188:191], v[140:143]
    v_mov_b32 v19, 1
    s_waitcnt vmcnt(13)
    v_mfma_f32_16x16x32_bf16 v[140:143], a[80:83], a[172:175], v[140:143]
    buffer_store_dword v19, v28, s[4:7], s75 offen offset:384 sc1
    s_waitcnt lgkmcnt(0)
    v_mfma_f32_16x16x32_bf16 v[156:159], a[64:67], a[172:175], v[156:159]
    ds_read_b64_tr_b16 a[80:81], v11 offset:16384
    v_mfma_f32_16x16x32_bf16 v[156:159], a[68:71], a[188:191], v[156:159]
    ds_read_b64_tr_b16 a[82:83], v11 offset:20480
    v_mfma_f32_16x16x32_bf16 v[152:155], a[68:71], a[184:187], v[152:155]
    ds_read_b64_tr_b16 a[84:85], v11 offset:24576
    v_mfma_f32_16x16x32_bf16 v[152:155], a[64:67], a[168:171], v[152:155]
    ds_read_b64_tr_b16 a[86:87], v11 offset:28672
    v_mfma_f32_16x16x32_bf16 v[148:151], a[64:67], a[164:167], v[148:151]
    buffer_load_dwordx4 v16, s[32:35], s61 offen offset:2048 lds
    v_mfma_f32_16x16x32_bf16 v[148:151], a[68:71], a[180:183], v[148:151]
    v_mfma_f32_16x16x32_bf16 v[144:147], a[68:71], a[176:179], v[144:147]
    buffer_load_dwordx4 v17, s[32:35], s61 offen offset:3072 lds
    v_mfma_f32_16x16x32_bf16 v[144:147], a[64:67], a[160:163], v[144:147]
    v_mfma_f32_16x16x32_bf16 v[160:163], a[72:75], a[160:163], v[160:163]
    ds_read_b64_tr_b16 a[64:65], v12 offset:16384
    v_mfma_f32_16x16x32_bf16 v[160:163], a[76:79], a[176:179], v[160:163]
    ds_read_b64_tr_b16 a[66:67], v12 offset:20480
    v_mfma_f32_16x16x32_bf16 v[164:167], a[76:79], a[180:183], v[164:167]
    ds_read_b64_tr_b16 a[68:69], v12 offset:24576
    v_mfma_f32_16x16x32_bf16 v[164:167], a[72:75], a[164:167], v[164:167]
    ds_read_b64_tr_b16 a[70:71], v12 offset:28672
    s_xor_b32 s60, s15, 98304
    s_add_u32 s60, s60, s73
    v_mfma_f32_16x16x32_bf16 v[168:171], a[72:75], a[168:171], v[168:171]
    buffer_load_dwordx4 v[32:35], v1, s[4:7], s60 offen offset:0 sc1
    v_mfma_f32_16x16x32_bf16 v[168:171], a[76:79], a[184:187], v[168:171]
    v_mfma_f32_16x16x32_bf16 v[172:175], a[76:79], a[188:191], v[172:175]
    buffer_load_dwordx4 v[36:39], v1, s[4:7], s60 offen offset:1024 sc1
    v_mfma_f32_16x16x32_bf16 v[172:175], a[72:75], a[172:175], v[172:175]
    s_waitcnt lgkmcnt(0)
    v_mfma_f32_16x16x32_bf16 v[188:191], a[80:83], a[172:175], v[188:191]
    ds_read_b64_tr_b16 a[72:73], v13 offset:16384
    v_mfma_f32_16x16x32_bf16 v[188:191], a[84:87], a[188:191], v[188:191]
    ds_read_b64_tr_b16 a[74:75], v13 offset:20480
    v_mfma_f32_16x16x32_bf16 v[184:187], a[84:87], a[184:187], v[184:187]
    ds_read_b64_tr_b16 a[76:77], v13 offset:24576
    v_mfma_f32_16x16x32_bf16 v[184:187], a[80:83], a[168:171], v[184:187]
    ds_read_b64_tr_b16 a[78:79], v13 offset:28672
    v_mfma_f32_16x16x32_bf16 v[180:183], a[80:83], a[164:167], v[180:183]
    v_mfma_f32_16x16x32_bf16 v[180:183], a[84:87], a[180:183], v[180:183]
    buffer_load_dwordx4 v[40:43], v1, s[4:7], s60 offen offset:2048 sc1
    v_mfma_f32_16x16x32_bf16 v[176:179], a[84:87], a[176:179], v[176:179]
    v_mfma_f32_16x16x32_bf16 v[176:179], a[80:83], a[160:163], v[176:179]
    v_mfma_f32_16x16x32_bf16 v[192:195], a[64:67], a[160:163], v[192:195]
    ds_read_b64_tr_b16 a[80:81], v6 offset:32768
    v_mfma_f32_16x16x32_bf16 v[192:195], a[68:71], a[176:179], v[192:195]
    ds_read_b64_tr_b16 a[82:83], v6 offset:36864
    v_mfma_f32_16x16x32_bf16 v[196:199], a[68:71], a[180:183], v[196:199]
    ds_read_b64_tr_b16 a[84:85], v6 offset:40960
    v_mfma_f32_16x16x32_bf16 v[196:199], a[64:67], a[164:167], v[196:199]
    ds_read_b64_tr_b16 a[86:87], v6 offset:45056
    v_mfma_f32_16x16x32_bf16 v[200:203], a[64:67], a[168:171], v[200:203]
    buffer_load_dwordx4 v[44:47], v1, s[4:7], s60 offen offset:3072 sc1
    v_mfma_f32_16x16x32_bf16 v[200:203], a[68:71], a[184:187], v[200:203]
    s_xor_b32 s60, s15, 102400
    s_add_u32 s60, s60, s73
    v_mfma_f32_16x16x32_bf16 v[204:207], a[68:71], a[188:191], v[204:207]
    buffer_load_dwordx4 v[48:51], v1, s[4:7], s60 offen offset:0 sc1
    v_mfma_f32_16x16x32_bf16 v[204:207], a[64:67], a[172:175], v[204:207]
    s_waitcnt lgkmcnt(0)
    v_mfma_f32_16x16x32_bf16 v[220:223], a[72:75], a[172:175], v[220:223]
    ds_read_b64_tr_b16 a[64:65], v7 offset:32768
    v_mfma_f32_16x16x32_bf16 v[220:223], a[76:79], a[188:191], v[220:223]
    ds_read_b64_tr_b16 a[66:67], v7 offset:36864
    v_mfma_f32_16x16x32_bf16 v[216:219], a[76:79], a[184:187], v[216:219]
    ds_read_b64_tr_b16 a[68:69], v7 offset:40960
    v_mfma_f32_16x16x32_bf16 v[216:219], a[72:75], a[168:171], v[216:219]
    ds_read_b64_tr_b16 a[70:71], v7 offset:45056
    v_mfma_f32_16x16x32_bf16 v[212:215], a[72:75], a[164:167], v[212:215]
    v_mfma_f32_16x16x32_bf16 v[212:215], a[76:79], a[180:183], v[212:215]
    buffer_load_dwordx4 v[52:55], v1, s[4:7], s60 offen offset:1024 sc1
    v_mfma_f32_16x16x32_bf16 v[208:211], a[76:79], a[176:179], v[208:211]
    v_mfma_f32_16x16x32_bf16 v[208:211], a[72:75], a[160:163], v[208:211]
    v_mfma_f32_16x16x32_bf16 v[96:99], a[80:83], a[192:195], v[96:99]
    ds_read_b64_tr_b16 a[72:73], v8 offset:32768
    v_mfma_f32_16x16x32_bf16 v[96:99], a[84:87], a[208:211], v[96:99]
    ds_read_b64_tr_b16 a[74:75], v8 offset:36864
    v_mfma_f32_16x16x32_bf16 v[100:103], a[84:87], a[212:215], v[100:103]
    ds_read_b64_tr_b16 a[76:77], v8 offset:40960
    v_mfma_f32_16x16x32_bf16 v[100:103], a[80:83], a[196:199], v[100:103]
    ds_read_b64_tr_b16 a[78:79], v8 offset:45056
    v_mfma_f32_16x16x32_bf16 v[104:107], a[80:83], a[200:203], v[104:107]
    buffer_load_dwordx4 v[56:59], v1, s[4:7], s60 offen offset:2048 sc1
    v_mfma_f32_16x16x32_bf16 v[104:107], a[84:87], a[216:219], v[104:107]
    v_mfma_f32_16x16x32_bf16 v[108:111], a[84:87], a[220:223], v[108:111]
    buffer_load_dwordx4 v[60:63], v1, s[4:7], s60 offen offset:3072 sc1
    v_mfma_f32_16x16x32_bf16 v[108:111], a[80:83], a[204:207], v[108:111]
    s_waitcnt lgkmcnt(0)
    v_mfma_f32_16x16x32_bf16 v[124:127], a[64:67], a[204:207], v[124:127]
    ds_read_b64_tr_b16 a[80:81], v9 offset:32768
    v_mfma_f32_16x16x32_bf16 v[124:127], a[68:71], a[220:223], v[124:127]
    ds_read_b64_tr_b16 a[82:83], v9 offset:36864
    v_mfma_f32_16x16x32_bf16 v[120:123], a[68:71], a[216:219], v[120:123]
    ds_read_b64_tr_b16 a[84:85], v9 offset:40960
    v_mfma_f32_16x16x32_bf16 v[120:123], a[64:67], a[200:203], v[120:123]
    ds_read_b64_tr_b16 a[86:87], v9 offset:45056
    s_xor_b32 s60, s15, 106496
    s_add_u32 s60, s60, s73
    v_mfma_f32_16x16x32_bf16 v[116:119], a[64:67], a[196:199], v[116:119]
    buffer_load_dwordx4 v[64:67], v1, s[4:7], s60 offen offset:0 sc1
    v_mfma_f32_16x16x32_bf16 v[116:119], a[68:71], a[212:215], v[116:119]
    v_mfma_f32_16x16x32_bf16 v[112:115], a[68:71], a[208:211], v[112:115]
    buffer_load_dwordx4 v[68:71], v1, s[4:7], s60 offen offset:1024 sc1
    v_mfma_f32_16x16x32_bf16 v[112:115], a[64:67], a[192:195], v[112:115]
    v_mfma_f32_16x16x32_bf16 v[128:131], a[72:75], a[192:195], v[128:131]
    ds_read_b64_tr_b16 a[64:65], v10 offset:32768
    v_mfma_f32_16x16x32_bf16 v[128:131], a[76:79], a[208:211], v[128:131]
    ds_read_b64_tr_b16 a[66:67], v10 offset:36864
    v_mfma_f32_16x16x32_bf16 v[132:135], a[76:79], a[212:215], v[132:135]
    ds_read_b64_tr_b16 a[68:69], v10 offset:40960
    v_mfma_f32_16x16x32_bf16 v[132:135], a[72:75], a[196:199], v[132:135]
    ds_read_b64_tr_b16 a[70:71], v10 offset:45056
    v_mfma_f32_16x16x32_bf16 v[136:139], a[72:75], a[200:203], v[136:139]
    v_mfma_f32_16x16x32_bf16 v[136:139], a[76:79], a[216:219], v[136:139]
    buffer_load_dwordx4 v[72:75], v1, s[4:7], s60 offen offset:2048 sc1
    v_mfma_f32_16x16x32_bf16 v[140:143], a[76:79], a[220:223], v[140:143]
    v_mfma_f32_16x16x32_bf16 v[140:143], a[72:75], a[204:207], v[140:143]
    s_waitcnt lgkmcnt(0)
    v_mfma_f32_16x16x32_bf16 v[156:159], a[80:83], a[204:207], v[156:159]
    ds_read_b64_tr_b16 a[72:73], v11 offset:32768
    v_mfma_f32_16x16x32_bf16 v[156:159], a[84:87], a[220:223], v[156:159]
    ds_read_b64_tr_b16 a[74:75], v11 offset:36864
    v_mfma_f32_16x16x32_bf16 v[152:155], a[84:87], a[216:219], v[152:155]
    ds_read_b64_tr_b16 a[76:77], v11 offset:40960
    v_mfma_f32_16x16x32_bf16 v[152:155], a[80:83], a[200:203], v[152:155]
    ds_read_b64_tr_b16 a[78:79], v11 offset:45056
    v_mfma_f32_16x16x32_bf16 v[148:151], a[80:83], a[196:199], v[148:151]
    buffer_load_dwordx4 v[76:79], v1, s[4:7], s60 offen offset:3072 sc1
    v_mfma_f32_16x16x32_bf16 v[148:151], a[84:87], a[212:215], v[148:151]
    s_xor_b32 s60, s15, 110592
    s_add_u32 s60, s60, s73
    v_mfma_f32_16x16x32_bf16 v[144:147], a[84:87], a[208:211], v[144:147]
    buffer_load_dwordx4 v[80:83], v1, s[4:7], s60 offen offset:0 sc1
    v_mfma_f32_16x16x32_bf16 v[144:147], a[80:83], a[192:195], v[144:147]
    v_mfma_f32_16x16x32_bf16 v[160:163], a[64:67], a[192:195], v[160:163]
    ds_read_b64_tr_b16 a[80:81], v12 offset:32768
    v_mfma_f32_16x16x32_bf16 v[160:163], a[68:71], a[208:211], v[160:163]
    ds_read_b64_tr_b16 a[82:83], v12 offset:36864
    v_mfma_f32_16x16x32_bf16 v[164:167], a[68:71], a[212:215], v[164:167]
    ds_read_b64_tr_b16 a[84:85], v12 offset:40960
    v_mfma_f32_16x16x32_bf16 v[164:167], a[64:67], a[196:199], v[164:167]
    ds_read_b64_tr_b16 a[86:87], v12 offset:45056
    v_mfma_f32_16x16x32_bf16 v[168:171], a[64:67], a[200:203], v[168:171]
    v_mfma_f32_16x16x32_bf16 v[168:171], a[68:71], a[216:219], v[168:171]
    buffer_load_dwordx4 v[84:87], v1, s[4:7], s60 offen offset:1024 sc1
    v_mfma_f32_16x16x32_bf16 v[172:175], a[68:71], a[220:223], v[172:175]
    v_mfma_f32_16x16x32_bf16 v[172:175], a[64:67], a[204:207], v[172:175]
    s_waitcnt lgkmcnt(0)
    v_mfma_f32_16x16x32_bf16 v[188:191], a[72:75], a[204:207], v[188:191]
    ds_read_b64_tr_b16 a[64:65], v13 offset:32768
    v_mfma_f32_16x16x32_bf16 v[188:191], a[76:79], a[220:223], v[188:191]
    ds_read_b64_tr_b16 a[66:67], v13 offset:36864
    v_mfma_f32_16x16x32_bf16 v[184:187], a[76:79], a[216:219], v[184:187]
    ds_read_b64_tr_b16 a[68:69], v13 offset:40960
    v_mfma_f32_16x16x32_bf16 v[184:187], a[72:75], a[200:203], v[184:187]
    ds_read_b64_tr_b16 a[70:71], v13 offset:45056
    v_mfma_f32_16x16x32_bf16 v[180:183], a[72:75], a[196:199], v[180:183]
    buffer_load_dwordx4 v[88:91], v1, s[4:7], s60 offen offset:2048 sc1
    v_mfma_f32_16x16x32_bf16 v[180:183], a[76:79], a[212:215], v[180:183]
    v_mfma_f32_16x16x32_bf16 v[176:179], a[76:79], a[208:211], v[176:179]
    buffer_load_dwordx4 v[92:95], v1, s[4:7], s60 offen offset:3072 sc1
    v_mfma_f32_16x16x32_bf16 v[176:179], a[72:75], a[192:195], v[176:179]
    v_mfma_f32_16x16x32_bf16 v[192:195], a[80:83], a[192:195], v[192:195]
    s_barrier
    ds_read_b64_tr_b16 a[72:73], v6 offset:49152
    v_mfma_f32_16x16x32_bf16 v[192:195], a[84:87], a[208:211], v[192:195]
    ds_read_b64_tr_b16 a[74:75], v6 offset:53248
    v_mfma_f32_16x16x32_bf16 v[196:199], a[84:87], a[212:215], v[196:199]
    ds_read_b64_tr_b16 a[76:77], v6 offset:57344
    v_mfma_f32_16x16x32_bf16 v[196:199], a[80:83], a[196:199], v[196:199]
    ds_read_b64_tr_b16 a[78:79], v6 offset:61440
    s_add_u32 m0, s63, 0
    s_xor_b32 s61, s62, 128
    v_mfma_f32_16x16x32_bf16 v[200:203], a[80:83], a[200:203], v[200:203]
    buffer_load_dwordx4 v14, s[28:31], s61 offen offset:0 lds
    v_mfma_f32_16x16x32_bf16 v[200:203], a[84:87], a[216:219], v[200:203]
    v_mfma_f32_16x16x32_bf16 v[204:207], a[84:87], a[220:223], v[204:207]
    buffer_load_dwordx4 v15, s[28:31], s61 offen offset:1024 lds
    v_mfma_f32_16x16x32_bf16 v[204:207], a[80:83], a[204:207], v[204:207]
    s_waitcnt lgkmcnt(0)
    v_mfma_f32_16x16x32_bf16 v[220:223], a[64:67], a[204:207], v[220:223]
    ds_read_b64_tr_b16 a[80:81], v7 offset:49152
    v_mfma_f32_16x16x32_bf16 v[220:223], a[68:71], a[220:223], v[220:223]
    ds_read_b64_tr_b16 a[82:83], v7 offset:53248
    v_mfma_f32_16x16x32_bf16 v[216:219], a[68:71], a[216:219], v[216:219]
    ds_read_b64_tr_b16 a[84:85], v7 offset:57344
    v_mfma_f32_16x16x32_bf16 v[216:219], a[64:67], a[200:203], v[216:219]
    ds_read_b64_tr_b16 a[86:87], v7 offset:61440
    v_mfma_f32_16x16x32_bf16 v[212:215], a[64:67], a[196:199], v[212:215]
    v_mfma_f32_16x16x32_bf16 v[212:215], a[68:71], a[212:215], v[212:215]
    buffer_load_dwordx4 v16, s[28:31], s61 offen offset:2048 lds
    v_mfma_f32_16x16x32_bf16 v[208:211], a[68:71], a[208:211], v[208:211]
    v_mfma_f32_16x16x32_bf16 v[208:211], a[64:67], a[192:195], v[208:211]
    s_waitcnt vmcnt(28)
    v_mfma_f32_16x16x32_bf16 v[96:99], a[72:75], a[224:227], v[96:99]
    ds_read_b64_tr_b16 a[64:65], v8 offset:49152
    v_mfma_f32_16x16x32_bf16 v[96:99], a[76:79], a[240:243], v[96:99]
    ds_read_b64_tr_b16 a[66:67], v8 offset:53248
    v_mfma_f32_16x16x32_bf16 v[100:103], a[76:79], a[244:247], v[100:103]
    ds_read_b64_tr_b16 a[68:69], v8 offset:57344
    v_mfma_f32_16x16x32_bf16 v[100:103], a[72:75], a[228:231], v[100:103]
    ds_read_b64_tr_b16 a[70:71], v8 offset:61440
    v_mfma_f32_16x16x32_bf16 v[104:107], a[72:75], a[232:235], v[104:107]
    v_mov_b32 v31, 0
    buffer_atomic_add v31, v30, s[4:7], s74 offen offset:384 sc0 sc1
    v_mfma_f32_16x16x32_bf16 v[104:107], a[76:79], a[248:251], v[104:107]
    v_mfma_f32_16x16x32_bf16 v[108:111], a[76:79], a[252:255], v[108:111]
    buffer_load_dwordx4 v17, s[28:31], s61 offen offset:3072 lds
    v_mfma_f32_16x16x32_bf16 v[108:111], a[72:75], a[236:239], v[108:111]
    s_waitcnt lgkmcnt(0)
    v_mfma_f32_16x16x32_bf16 v[124:127], a[80:83], a[236:239], v[124:127]
    ds_read_b64_tr_b16 a[72:73], v9 offset:49152
    v_mfma_f32_16x16x32_bf16 v[124:127], a[84:87], a[252:255], v[124:127]
    ds_read_b64_tr_b16 a[74:75], v9 offset:53248
    v_mfma_f32_16x16x32_bf16 v[120:123], a[84:87], a[248:251], v[120:123]
    ds_read_b64_tr_b16 a[76:77], v9 offset:57344
    v_mfma_f32_16x16x32_bf16 v[120:123], a[80:83], a[232:235], v[120:123]
    ds_read_b64_tr_b16 a[78:79], v9 offset:61440
    v_mfma_f32_16x16x32_bf16 v[116:119], a[80:83], a[228:231], v[116:119]
    s_add_u32 m0, s63, 16384
    s_xor_b32 s61, s62, 128
    v_mfma_f32_16x16x32_bf16 v[116:119], a[84:87], a[244:247], v[116:119]
    buffer_load_dwordx4 v14, s[32:35], s61 offen offset:0 lds
    v_mfma_f32_16x16x32_bf16 v[112:115], a[84:87], a[240:243], v[112:115]
    v_mfma_f32_16x16x32_bf16 v[112:115], a[80:83], a[224:227], v[112:115]
    v_mfma_f32_16x16x32_bf16 v[128:131], a[64:67], a[224:227], v[128:131]
    ds_read_b64_tr_b16 a[80:81], v10 offset:49152
    v_mfma_f32_16x16x32_bf16 v[128:131], a[68:71], a[240:243], v[128:131]
    ds_read_b64_tr_b16 a[82:83], v10 offset:53248
    v_mfma_f32_16x16x32_bf16 v[132:135], a[68:71], a[244:247], v[132:135]
    ds_read_b64_tr_b16 a[84:85], v10 offset:57344
    v_mfma_f32_16x16x32_bf16 v[132:135], a[64:67], a[228:231], v[132:135]
    ds_read_b64_tr_b16 a[86:87], v10 offset:61440
    v_mfma_f32_16x16x32_bf16 v[136:139], a[64:67], a[232:235], v[136:139]
    buffer_load_dwordx4 v15, s[32:35], s61 offen offset:1024 lds
    v_mfma_f32_16x16x32_bf16 v[136:139], a[68:71], a[248:251], v[136:139]
    v_mfma_f32_16x16x32_bf16 v[140:143], a[68:71], a[252:255], v[140:143]
    buffer_load_dwordx4 v16, s[32:35], s61 offen offset:2048 lds
    v_mfma_f32_16x16x32_bf16 v[140:143], a[64:67], a[236:239], v[140:143]
    s_waitcnt lgkmcnt(0)
    v_mfma_f32_16x16x32_bf16 v[156:159], a[72:75], a[236:239], v[156:159]
    ds_read_b64_tr_b16 a[64:65], v11 offset:49152
    s_waitcnt vmcnt(16)
    v_mfma_f32_16x16x32_bf16 v[156:159], a[76:79], a[252:255], v[156:159]
    ds_read_b64_tr_b16 a[66:67], v11 offset:53248
    v_mfma_f32_16x16x32_bf16 v[152:155], a[76:79], a[248:251], v[152:155]
    ds_read_b64_tr_b16 a[68:69], v11 offset:57344
    v_mfma_f32_16x16x32_bf16 v[152:155], a[72:75], a[232:235], v[152:155]
    ds_read_b64_tr_b16 a[70:71], v11 offset:61440
    v_mfma_f32_16x16x32_bf16 v[148:151], a[72:75], a[228:231], v[148:151]
    buffer_load_dwordx4 v17, s[32:35], s61 offen offset:3072 lds
    v_mfma_f32_16x16x32_bf16 v[148:151], a[76:79], a[244:247], v[148:151]
    v_swap_b32 v34, v36
    v_mfma_f32_16x16x32_bf16 v[144:147], a[76:79], a[240:243], v[144:147]
    v_swap_b32 v35, v37
    v_mfma_f32_16x16x32_bf16 v[144:147], a[72:75], a[224:227], v[144:147]
    v_swap_b32 v42, v44
    v_mfma_f32_16x16x32_bf16 v[160:163], a[80:83], a[224:227], v[160:163]
    ds_read_b64_tr_b16 a[72:73], v12 offset:49152
    v_mfma_f32_16x16x32_bf16 v[160:163], a[84:87], a[240:243], v[160:163]
    ds_read_b64_tr_b16 a[74:75], v12 offset:53248
    v_mfma_f32_16x16x32_bf16 v[164:167], a[84:87], a[244:247], v[164:167]
    ds_read_b64_tr_b16 a[76:77], v12 offset:57344
    v_mfma_f32_16x16x32_bf16 v[164:167], a[80:83], a[228:231], v[164:167]
    ds_read_b64_tr_b16 a[78:79], v12 offset:61440
    v_mfma_f32_16x16x32_bf16 v[168:171], a[80:83], a[232:235], v[168:171]
    v_swap_b32 v43, v45
    v_mfma_f32_16x16x32_bf16 v[168:171], a[84:87], a[248:251], v[168:171]
    v_swap_b32 v50, v52
    v_mfma_f32_16x16x32_bf16 v[172:175], a[84:87], a[252:255], v[172:175]
    v_swap_b32 v51, v53
    v_mfma_f32_16x16x32_bf16 v[172:175], a[80:83], a[236:239], v[172:175]
    v_swap_b32 v58, v60
    s_waitcnt lgkmcnt(0)
    v_mfma_f32_16x16x32_bf16 v[188:191], a[64:67], a[236:239], v[188:191]
    ds_read_b64_tr_b16 a[80:81], v13 offset:49152
    v_mfma_f32_16x16x32_bf16 v[188:191], a[68:71], a[252:255], v[188:191]
    ds_read_b64_tr_b16 a[82:83], v13 offset:53248
    v_mfma_f32_16x16x32_bf16 v[184:187], a[68:71], a[248:251], v[184:187]
    ds_read_b64_tr_b16 a[84:85], v13 offset:57344
    v_mfma_f32_16x16x32_bf16 v[184:187], a[64:67], a[232:235], v[184:187]
    ds_read_b64_tr_b16 a[86:87], v13 offset:61440
    v_mfma_f32_16x16x32_bf16 v[180:183], a[64:67], a[228:231], v[180:183]
    v_swap_b32 v59, v61
    v_mfma_f32_16x16x32_bf16 v[180:183], a[68:71], a[244:247], v[180:183]
    v_mfma_f32_16x16x32_bf16 v[176:179], a[68:71], a[240:243], v[176:179]
    v_mfma_f32_16x16x32_bf16 v[176:179], a[64:67], a[224:227], v[176:179]
    v_xor_b32 v6, 0x10000, v6
    v_mfma_f32_16x16x32_bf16 v[192:195], a[72:75], a[224:227], v[192:195]
    ds_read_b64_tr_b16 a[64:65], v6 offset:0
    v_mfma_f32_16x16x32_bf16 v[192:195], a[76:79], a[240:243], v[192:195]
    ds_read_b64_tr_b16 a[66:67], v6 offset:4096
    v_mfma_f32_16x16x32_bf16 v[196:199], a[76:79], a[244:247], v[196:199]
    ds_read_b64_tr_b16 a[68:69], v6 offset:8192
    v_mfma_f32_16x16x32_bf16 v[196:199], a[72:75], a[228:231], v[196:199]
    ds_read_b64_tr_b16 a[70:71], v6 offset:12288
    v_mfma_f32_16x16x32_bf16 v[200:203], a[72:75], a[232:235], v[200:203]
    v_mfma_f32_16x16x32_bf16 v[200:203], a[76:79], a[248:251], v[200:203]
    v_mfma_f32_16x16x32_bf16 v[204:207], a[76:79], a[252:255], v[204:207]
    v_mfma_f32_16x16x32_bf16 v[204:207], a[72:75], a[236:239], v[204:207]
    v_xor_b32 v7, 0x10000, v7
    s_waitcnt lgkmcnt(0)
    v_mfma_f32_16x16x32_bf16 v[220:223], a[80:83], a[236:239], v[220:223]
    ds_read_b64_tr_b16 a[72:73], v7 offset:0
    v_mfma_f32_16x16x32_bf16 v[220:223], a[84:87], a[252:255], v[220:223]
    ds_read_b64_tr_b16 a[74:75], v7 offset:4096
    v_mfma_f32_16x16x32_bf16 v[216:219], a[84:87], a[248:251], v[216:219]
    ds_read_b64_tr_b16 a[76:77], v7 offset:8192
    v_mfma_f32_16x16x32_bf16 v[216:219], a[80:83], a[232:235], v[216:219]
    ds_read_b64_tr_b16 a[78:79], v7 offset:12288
    v_mfma_f32_16x16x32_bf16 v[212:215], a[80:83], a[228:231], v[212:215]
    v_mfma_f32_16x16x32_bf16 v[212:215], a[84:87], a[244:247], v[212:215]
    v_mfma_f32_16x16x32_bf16 v[208:211], a[84:87], a[240:243], v[208:211]
    v_mfma_f32_16x16x32_bf16 v[208:211], a[80:83], a[224:227], v[208:211]
    v_xor_b32 v8, 0x10000, v8
    v_mfma_f32_16x16x32_bf16 v[96:99], a[64:67], v[32:35], v[96:99]
    s_waitcnt vmcnt(5)
    v_cmp_ne_u32 vcc, 1, v31
    s_and_b64 vcc, vcc, 0xff
    s_cbranch_vccnz L_far8
L_back8:
    ds_read_b64_tr_b16 a[80:81], v8 offset:0
    v_mfma_f32_16x16x32_bf16 v[96:99], a[68:71], v[48:51], v[96:99]
    ds_read_b64_tr_b16 a[82:83], v8 offset:4096
    v_mfma_f32_16x16x32_bf16 v[100:103], a[68:71], v[52:55], v[100:103]
    ds_read_b64_tr_b16 a[84:85], v8 offset:8192
    v_mfma_f32_16x16x32_bf16 v[100:103], a[64:67], v[36:39], v[100:103]
    ds_read_b64_tr_b16 a[86:87], v8 offset:12288
    s_xor_b32 s60, s64, 0
    s_add_u32 s60, s60, s70
    v_mfma_f32_16x16x32_bf16 v[104:107], a[64:67], v[40:43], v[104:107]
    buffer_load_dwordx4 a[192:195], v1, s[4:7], s60 offen offset:0 sc1
    v_mfma_f32_16x16x32_bf16 v[104:107], a[68:71], v[56:59], v[104:107]
    v_mfma_f32_16x16x32_bf16 v[108:111], a[68:71], v[60:63], v[108:111]
    buffer_load_dwordx4 a[196:199], v1, s[4:7], s60 offen offset:1024 sc1
    v_mfma_f32_16x16x32_bf16 v[108:111], a[64:67], v[44:47], v[108:111]
    v_xor_b32 v9, 0x10000, v9
    s_waitcnt lgkmcnt(0)
    v_mfma_f32_16x16x32_bf16 v[124:127], a[72:75], v[44:47], v[124:127]
    ds_read_b64_tr_b16 a[64:65], v9 offset:0
    v_mfma_f32_16x16x32_bf16 v[124:127], a[76:79], v[60:63], v[124:127]
    ds_read_b64_tr_b16 a[66:67], v9 offset:4096
    v_mfma_f32_16x16x32_bf16 v[120:123], a[76:79], v[56:59], v[120:123]
    ds_read_b64_tr_b16 a[68:69], v9 offset:8192
    v_mfma_f32_16x16x32_bf16 v[120:123], a[72:75], v[40:43], v[120:123]
    ds_read_b64_tr_b16 a[70:71], v9 offset:12288
    v_mfma_f32_16x16x32_bf16 v[116:119], a[72:75], v[36:39], v[116:119]
    buffer_load_dwordx4 a[200:203], v1, s[4:7], s60 offen offset:2048 sc1
    v_mfma_f32_16x16x32_bf16 v[116:119], a[76:79], v[52:55], v[116:119]
    v_mfma_f32_16x16x32_bf16 v[112:115], a[76:79], v[48:51], v[112:115]
    buffer_load_dwordx4 a[204:207], v1, s[4:7], s60 offen offset:3072 sc1
    v_mfma_f32_16x16x32_bf16 v[112:115], a[72:75], v[32:35], v[112:115]
    v_xor_b32 v10, 0x10000, v10
    v_mfma_f32_16x16x32_bf16 v[128:131], a[80:83], v[32:35], v[128:131]
    ds_read_b64_tr_b16 a[72:73], v10 offset:0
    v_mfma_f32_16x16x32_bf16 v[128:131], a[84:87], v[48:51], v[128:131]
    ds_read_b64_tr_b16 a[74:75], v10 offset:4096
    v_mfma_f32_16x16x32_bf16 v[132:135], a[84:87], v[52:55], v[132:135]
    ds_read_b64_tr_b16 a[76:77], v10 offset:8192
    v_mfma_f32_16x16x32_bf16 v[132:135], a[80:83], v[36:39], v[132:135]
    ds_read_b64_tr_b16 a[78:79], v10 offset:12288
    s_xor_b32 s60, s64, 4096
    s_add_u32 s60, s60, s70
    v_mfma_f32_16x16x32_bf16 v[136:139], a[80:83], v[40:43], v[136:139]
    buffer_load_dwordx4 a[208:211], v1, s[4:7], s60 offen offset:0 sc1
    v_mfma_f32_16x16x32_bf16 v[136:139], a[84:87], v[56:59], v[136:139]
    v_mfma_f32_16x16x32_bf16 v[140:143], a[84:87], v[60:63], v[140:143]
    buffer_load_dwordx4 a[212:215], v1, s[4:7], s60 offen offset:1024 sc1
    v_mfma_f32_16x16x32_bf16 v[140:143], a[80:83], v[44:47], v[140:143]
    v_xor_b32 v11, 0x10000, v11
    s_waitcnt lgkmcnt(0)
    v_mfma_f32_16x16x32_bf16 v[156:159], a[64:67], v[44:47], v[156:159]
    ds_read_b64_tr_b16 a[80:81], v11 offset:0
    v_mfma_f32_16x16x32_bf16 v[156:159], a[68:71], v[60:63], v[156:159]
    ds_read_b64_tr_b16 a[82:83], v11 offset:4096
    v_mfma_f32_16x16x32_bf16 v[152:155], a[68:71], v[56:59], v[152:155]
    ds_read_b64_tr_b16 a[84:85], v11 offset:8192
    v_mfma_f32_16x16x32_bf16 v[152:155], a[64:67], v[40:43], v[152:155]
    ds_read_b64_tr_b16 a[86:87], v11 offset:12288
    v_mfma_f32_16x16x32_bf16 v[148:151], a[64:67], v[36:39], v[148:151]
    buffer_load_dwordx4 a[216:219], v1, s[4:7], s60 offen offset:2048 sc1
    v_mfma_f32_16x16x32_bf16 v[148:151], a[68:71], v[52:55], v[148:151]
    v_swap_b32 v66, v68
    v_mfma_f32_16x16x32_bf16 v[144:147], a[68:71], v[48:51], v[144:147]
    buffer_load_dwordx4 a[220:223], v1, s[4:7], s60 offen offset:3072 sc1
    v_mfma_f32_16x16x32_bf16 v[144:147], a[64:67], v[32:35], v[144:147]
    v_xor_b32 v12, 0x10000, v12
    v_mfma_f32_16x16x32_bf16 v[160:163], a[72:75], v[32:35], v[160:163]
    ds_read_b64_tr_b16 a[64:65], v12 offset:0
    v_mfma_f32_16x16x32_bf16 v[160:163], a[76:79], v[48:51], v[160:163]
    ds_read_b64_tr_b16 a[66:67], v12 offset:4096
    v_mfma_f32_16x16x32_bf16 v[164:167], a[76:79], v[52:55], v[164:167]
    ds_read_b64_tr_b16 a[68:69], v12 offset:8192
    v_mfma_f32_16x16x32_bf16 v[164:167], a[72:75], v[36:39], v[164:167]
    ds_read_b64_tr_b16 a[70:71], v12 offset:12288
    s_xor_b32 s60, s64, 8192
    s_add_u32 s60, s60, s70
    v_mfma_f32_16x16x32_bf16 v[168:171], a[72:75], v[40:43], v[168:171]
    buffer_load_dwordx4 a[224:227], v1, s[4:7], s60 offen offset:0 sc1
    v_mfma_f32_16x16x32_bf16 v[168:171], a[76:79], v[56:59], v[168:171]
    v_swap_b32 v67, v69
    v_mfma_f32_16x16x32_bf16 v[172:175], a[76:79], v[60:63], v[172:175]
    buffer_load_dwordx4 a[228:231], v1, s[4:7], s60 offen offset:1024 sc1
    v_mfma_f32_16x16x32_bf16 v[172:175], a[72:75], v[44:47], v[172:175]
    v_xor_b32 v13, 0x10000, v13
L_pad10:
    s_cbranch_execz L_warm_ret
    s_waitcnt lgkmcnt(0)
    v_mfma_f32_16x16x32_bf16 v[188:191], a[80:83], v[44:47], v[188:191]
    ds_read_b64_tr_b16 a[72:73], v13 offset:0
    v_mfma_f32_16x16x32_bf16 v[188:191], a[84:87], v[60:63], v[188:191]
    ds_read_b64_tr_b16 a[74:75], v13 offset:4096
    v_mfma_f32_16x16x32_bf16 v[184:187], a[84:87], v[56:59], v[184:187]
    ds_read_b64_tr_b16 a[76:77], v13 offset:8192
    v_mfma_f32_16x16x32_bf16 v[184:187], a[80:83], v[40:43], v[184:187]
    ds_read_b64_tr_b16 a[78:79], v13 offset:12288
    v_mfma_f32_16x16x32_bf16 v[180:183], a[80:83], v[36:39], v[180:183]
    buffer_load_dwordx4 a[232:235], v1, s[4:7], s60 offen offset:2048 sc1
    v_mfma_f32_16x16x32_bf16 v[180:183], a[84:87], v[52:55], v[180:183]
    v_swap_b32 v74, v76
    v_mfma_f32_16x16x32_bf16 v[176:179], a[84:87], v[48:51], v[176:179]
    buffer_load_dwordx4 a[236:239], v1, s[4:7], s60 offen offset:3072 sc1
    v_mfma_f32_16x16x32_bf16 v[176:179], a[80:83], v[32:35], v[176:179]
    v_swap_b32 v75, v77
    v_mfma_f32_16x16x32_bf16 v[192:195], a[64:67], v[32:35], v[192:195]
    s_barrier
    ds_read_b64_tr_b16 a[80:81], v6 offset:16384
    v_mfma_f32_16x16x32_bf16 v[192:195], a[68:71], v[48:51], v[192:195]
    ds_read_b64_tr_b16 a[82:83], v6 offset:20480
    v_mfma_f32_16x16x32_bf16 v[196:199], a[68:71], v[52:55], v[196:199]
    ds_read_b64_tr_b16 a[84:85], v6 offset:24576
    v_mfma_f32_16x16x32_bf16 v[196:199], a[64:67], v[36:39], v[196:199]
    ds_read_b64_tr_b16 a[86:87], v6 offset:28672
    s_xor_b32 s60, s64, 12288
    s_add_u32 s60, s60, s70
    v_mfma_f32_16x16x32_bf16 v[200:203], a[64:67], v[40:43], v[200:203]
    buffer_load_dwordx4 a[240:243], v1, s[4:7], s60 offen offset:0 sc1
    v_mfma_f32_16x16x32_bf16 v[200:203], a[68:71], v[56:59], v[200:203]
    v_swap_b32 v82, v84
    v_mfma_f32_16x16x32_bf16 v[204:207], a[68:71], v[60:63], v[204:207]
    buffer_load_dwordx4 a[244:247], v1, s[4:7], s60 offen offset:1024 sc1
    v_mfma_f32_16x16x32_bf16 v[204:207], a[64:67], v[44:47], v[204:207]
    v_swap_b32 v83, v85
    s_waitcnt lgkmcnt(0)
    v_mfma_f32_16x16x32_bf16 v[220:223], a[72:75], v[44:47], v[220:223]
    ds_read_b64_tr_b16 a[64:65], v7 offset:16384
    v_mfma_f32_16x16x32_bf16 v[220:223], a[76:79], v[60:63], v[220:223]
    ds_read_b64_tr_b16 a[66:67], v7 offset:20480
    v_mfma_f32_16x16x32_bf16 v[216:219], a[76:79], v[56:59], v[216:219]
    ds_read_b64_tr_b16 a[68:69], v7 offset:24576
    v_mfma_f32_16x16x32_bf16 v[216:219], a[72:75], v[40:43], v[216:219]
    ds_read_b64_tr_b16 a[70:71], v7 offset:28672
    v_mfma_f32_16x16x32_bf16 v[212:215], a[72:75], v[36:39], v[212:215]
    buffer_load_dwordx4 a[248:251], v1, s[4:7], s60 offen offset:2048 sc1
    v_mfma_f32_16x16x32_bf16 v[212:215], a[76:79], v[52:55], v[212:215]
    v_swap_b32 v90, v92
    v_mfma_f32_16x16x32_bf16 v[208:211], a[76:79], v[48:51], v[208:211]
    buffer_load_dwordx4 a[252:255], v1, s[4:7], s60 offen offset:3072 sc1
    v_mfma_f32_16x16x32_bf16 v[208:211], a[72:75], v[32:35], v[208:211]
    v_swap_b32 v91, v93
    v_mfma_f32_16x16x32_bf16 v[96:99], a[80:83], v[64:67], v[96:99]
    ds_read_b64_tr_b16 a[72:73], v8 offset:16384
    v_mfma_f32_16x16x32_bf16 v[96:99], a[84:87], v[80:83], v[96:99]
    ds_read_b64_tr_b16 a[74:75], v8 offset:20480
    v_mfma_f32_16x16x32_bf16 v[100:103], a[84:87], v[84:87], v[100:103]
    ds_read_b64_tr_b16 a[76:77], v8 offset:24576
    v_mfma_f32_16x16x32_bf16 v[100:103], a[80:83], v[68:71], v[100:103]
    ds_read_b64_tr_b16 a[78:79], v8 offset:28672
    s_add_u32 m0, s63, 32768
    s_xor_b32 s61, s62, 256
    v_mfma_f32_16x16x32_bf16 v[104:107], a[80:83], v[72:75], v[104:107]
    buffer_load_dwordx4 v14, s[28:31], s61 offen offset:0 lds
    v_mfma_f32_16x16x32_bf16 v[104:107], a[84:87], v[88:91], v[104:107]
    v_mfma_f32_16x16x32_bf16 v[108:111], a[84:87], v[92:95], v[108:111]
    buffer_load_dwordx4 v15, s[28:31], s61 offen offset:1024 lds
    v_mfma_f32_16x16x32_bf16 v[108:111], a[80:83], v[76:79], v[108:111]
    s_waitcnt lgkmcnt(0)
    v_mfma_f32_16x16x32_bf16 v[124:127], a[64:67], v[76:79], v[124:127]
    ds_read_b64_tr_b16 a[80:81], v9 offset:16384
    v_mfma_f32_16x16x32_bf16 v[124:127], a[68:71], v[92:95], v[124:127]
    ds_read_b64_tr_b16 a[82:83], v9 offset:20480
    v_mfma_f32_16x16x32_bf16 v[120:123], a[68:71], v[88:91], v[120:123]
    ds_read_b64_tr_b16 a[84:85], v9 offset:24576
    v_mfma_f32_16x16x32_bf16 v[120:123], a[64:67], v[72:75], v[120:123]
    ds_read_b64_tr_b16 a[86:87], v9 offset:28672
    v_mfma_f32_16x16x32_bf16 v[116:119], a[64:67], v[68:71], v[116:119]
    buffer_load_dwordx4 v16, s[28:31], s61 offen offset:2048 lds
    v_mfma_f32_16x16x32_bf16 v[116:119], a[68:71], v[84:87], v[116:119]
    v_mfma_f32_16x16x32_bf16 v[112:115], a[68:71], v[80:83], v[112:115]
    buffer_load_dwordx4 v17, s[28:31], s61 offen offset:3072 lds
    v_mfma_f32_16x16x32_bf16 v[112:115], a[64:67], v[64:67], v[112:115]
    v_mfma_f32_16x16x32_bf16 v[128:131], a[72:75], v[64:67], v[128:131]
    ds_read_b64_tr_b16 a[64:65], v10 offset:16384
    v_mfma_f32_16x16x32_bf16 v[128:131], a[76:79], v[80:83], v[128:131]
    ds_read_b64_tr_b16 a[66:67], v10 offset:20480
    v_mfma_f32_16x16x32_bf16 v[132:135], a[76:79], v[84:87], v[132:135]
    ds_read_b64_tr_b16 a[68:69], v10 offset:24576
    v_mfma_f32_16x16x32_bf16 v[132:135], a[72:75], v[68:71], v[132:135]
    ds_read_b64_tr_b16 a[70:71], v10 offset:28672
    s_add_u32 m0, s63, 49152
    s_xor_b32 s61, s62, 256
    v_mfma_f32_16x16x32_bf16 v[136:139], a[72:75], v[72:75], v[136:139]
    buffer_load_dwordx4 v14, s[32:35], s61 offen offset:0 lds
    v_mfma_f32_16x16x32_bf16 v[136:139], a[76:79], v[88:91], v[136:139]
    v_mfma_f32_16x16x32_bf16 v[140:143], a[76:79], v[92:95], v[140:143]
    buffer_load_dwordx4 v15, s[32:35], s61 offen offset:1024 lds
    v_mfma_f32_16x16x32_bf16 v[140:143], a[72:75], v[76:79], v[140:143]
    s_waitcnt lgkmcnt(0)
    v_mfma_f32_16x16x32_bf16 v[156:159], a[80:83], v[76:79], v[156:159]
    ds_read_b64_tr_b16 a[72:73], v11 offset:16384
    v_mfma_f32_16x16x32_bf16 v[156:159], a[84:87], v[92:95], v[156:159]
    ds_read_b64_tr_b16 a[74:75], v11 offset:20480
    v_mfma_f32_16x16x32_bf16 v[152:155], a[84:87], v[88:91], v[152:155]
    ds_read_b64_tr_b16 a[76:77], v11 offset:24576
    v_mfma_f32_16x16x32_bf16 v[152:155], a[80:83], v[72:75], v[152:155]
    ds_read_b64_tr_b16 a[78:79], v11 offset:28672
    v_mfma_f32_16x16x32_bf16 v[148:151], a[80:83], v[68:71], v[148:151]
    buffer_load_dwordx4 v16, s[32:35], s61 offen offset:2048 lds
    v_mfma_f32_16x16x32_bf16 v[148:151], a[84:87], v[84:87], v[148:151]
    v_mfma_f32_16x16x32_bf16 v[144:147], a[84:87], v[80:83], v[144:147]
    buffer_load_dwordx4 v17, s[32:35], s61 offen offset:3072 lds
    v_mfma_f32_16x16x32_bf16 v[144:147], a[80:83], v[64:67], v[144:147]
    v_mfma_f32_16x16x32_bf16 v[160:163], a[64:67], v[64:67], v[160:163]
    ds_read_b64_tr_b16 a[80:81], v12 offset:16384
    v_mfma_f32_16x16x32_bf16 v[160:163], a[68:71], v[80:83], v[160:163]
    ds_read_b64_tr_b16 a[82:83], v12 offset:20480
    v_mfma_f32_16x16x32_bf16 v[164:167], a[68:71], v[84:87], v[164:167]
    ds_read_b64_tr_b16 a[84:85], v12 offset:24576
    v_mfma_f32_16x16x32_bf16 v[164:167], a[64:67], v[68:71], v[164:167]
    ds_read_b64_tr_b16 a[86:87], v12 offset:28672
    s_xor_b32 s60, s64, 16384
    s_add_u32 s60, s60, s70
    v_mfma_f32_16x16x32_bf16 v[168:171], a[64:67], v[72:75], v[168:171]
    buffer_load_dwordx4 a[128:131], v1, s[4:7], s60 offen offset:0 sc1
    v_mfma_f32_16x16x32_bf16 v[168:171], a[68:71], v[88:91], v[168:171]
    v_mfma_f32_16x16x32_bf16 v[172:175], a[68:71], v[92:95], v[172:175]
    buffer_load_dwordx4 a[132:135], v1, s[4:7], s60 offen offset:1024 sc1
    v_mfma_f32_16x16x32_bf16 v[172:175], a[64:67], v[76:79], v[172:175]
    s_waitcnt lgkmcnt(0)
    v_mfma_f32_16x16x32_bf16 v[188:191], a[72:75], v[76:79], v[188:191]
    ds_read_b64_tr_b16 a[64:65], v13 offset:16384
    v_mfma_f32_16x16x32_bf16 v[188:191], a[76:79], v[92:95], v[188:191]
    ds_read_b64_tr_b16 a[66:67], v13 offset:20480
    v_mfma_f32_16x16x32_bf16 v[184:187], a[76:79], v[88:91], v[184:187]
    ds_read_b64_tr_b16 a[68:69], v13 offset:24576
    v_mfma_f32_16x16x32_bf16 v[184:187], a[72:75], v[72:75], v[184:187]
    ds_read_b64_tr_b16 a[70:71], v13 offset:28672
    v_mfma_f32_16x16x32_bf16 v[180:183], a[72:75], v[68:71], v[180:183]
    buffer_load_dwordx4 a[136:139], v1, s[4:7], s60 offen offset:2048 sc1
    v_mfma_f32_16x16x32_bf16 v[180:183], a[76:79], v[84:87], v[180:183]
    v_mfma_f32_16x16x32_bf16 v[176:179], a[76:79], v[80:83], v[176:179]
    buffer_load_dwordx4 a[140:143], v1, s[4:7], s60 offen offset:3072 sc1
    v_mfma_f32_16x16x32_bf16 v[176:179], a[72:75], v[64:67], v[176:179]
    v_mfma_f32_16x16x32_bf16 v[192:195], a[80:83], v[64:67], v[192:195]
    ds_read_b128 a[72:75], v22 offset:32768
    v_mfma_f32_16x16x32_bf16 v[192:195], a[84:87], v[80:83], v[192:195]
    ds_read_b128 a[76:79], v23 offset:32768
    v_mfma_f32_16x16x32_bf16 v[196:199], a[84:87], v[84:87], v[196:199]
    v_mfma_f32_16x16x32_bf16 v[196:199], a[80:83], v[68:71], v[196:199]
    s_xor_b32 s60, s64, 20480
    s_add_u32 s60, s60, s70
    v_mfma_f32_16x16x32_bf16 v[200:203], a[80:83], v[72:75], v[200:203]
    buffer_load_dwordx4 a[144:147], v1, s[4:7], s60 offen offset:0 sc1
    v_mfma_f32_16x16x32_bf16 v[200:203], a[84:87], v[88:91], v[200:203]
    v_mfma_f32_16x16x32_bf16 v[204:207], a[84:87], v[92:95], v[204:207]
    buffer_load_dwordx4 a[148:151], v1, s[4:7], s60 offen offset:1024 sc1
    v_mfma_f32_16x16x32_bf16 v[204:207], a[80:83], v[76:79], v[204:207]
    s_waitcnt lgkmcnt(0)
    v_mfma_f32_16x16x32_bf16 v[220:223], a[64:67], v[76:79], v[220:223]
    ds_read_b128 a[80:83], v22 offset:34816
    v_mfma_f32_16x16x32_bf16 v[220:223], a[68:71], v[92:95], v[220:223]
    ds_read_b128 a[84:87], v23 offset:34816
    v_mfma_f32_16x16x32_bf16 v[216:219], a[68:71], v[88:91], v[216:219]
    v_mfma_f32_16x16x32_bf16 v[216:219], a[64:67], v[72:75], v[216:219]
    v_mfma_f32_16x16x32_bf16 v[212:215], a[64:67], v[68:71], v[212:215]
    buffer_load_dwordx4 a[152:155], v1, s[4:7], s60 offen offset:2048 sc1
    v_mfma_f32_16x16x32_bf16 v[212:215], a[68:71], v[84:87], v[212:215]
    v_mfma_f32_16x16x32_bf16 v[208:211], a[68:71], v[80:83], v[208:211]
    buffer_load_dwordx4 a[156:159], v1, s[4:7], s60 offen offset:3072 sc1
    v_mfma_f32_16x16x32_bf16 v[208:211], a[64:67], v[64:67], v[208:211]
    s_waitcnt vmcnt(24)
    v_mfma_f32_16x16x32_bf16 v[96:99], a[72:75], a[192:195], v[96:99]
    ds_read_b128 a[64:67], v22 offset:36864
    v_mfma_f32_16x16x32_bf16 v[96:99], a[76:79], a[208:211], v[96:99]
    ds_read_b128 a[68:71], v23 offset:36864
    v_mfma_f32_16x16x32_bf16 v[100:103], a[76:79], a[212:215], v[100:103]
    v_mfma_f32_16x16x32_bf16 v[100:103], a[72:75], a[196:199], v[100:103]
    s_xor_b32 s60, s64, 24576
    s_add_u32 s60, s60, s70
    v_mfma_f32_16x16x32_bf16 v[104:107], a[72:75], a[200:203], v[104:107]
    buffer_load_dwordx4 a[160:163], v1, s[4:7], s60 offen offset:0 sc1
    v_mfma_f32_16x16x32_bf16 v[104:107], a[76:79], a[216:219], v[104:107]
    v_mfma_f32_16x16x32_bf16 v[108:111], a[76:79], a[220:223], v[108:111]
    buffer_load_dwordx4 a[164:167], v1, s[4:7], s60 offen offset:1024 sc1
    v_mfma_f32_16x16x32_bf16 v[108:111], a[72:75], a[204:207], v[108:111]
    s_waitcnt lgkmcnt(0)
    v_mfma_f32_16x16x32_bf16 v[124:127], a[80:83], a[204:207], v[124:127]
    ds_read_b128 a[72:75], v22 offset:38912
    v_mfma_f32_16x16x32_bf16 v[124:127], a[84:87], a[220:223], v[124:127]
    ds_read_b128 a[76:79], v23 offset:38912
    v_mfma_f32_16x16x32_bf16 v[120:123], a[84:87], a[216:219], v[120:123]
    v_mfma_f32_16x16x32_bf16 v[120:123], a[80:83], a[200:203], v[120:123]
    v_mfma_f32_16x16x32_bf16 v[116:119], a[80:83], a[196:199], v[116:119]
    buffer_load_dwordx4 a[168:171], v1, s[4:7], s60 offen offset:2048 sc1
    v_mfma_f32_16x16x32_bf16 v[116:119], a[84:87], a[212:215], v[116:119]
    v_mfma_f32_16x16x32_bf16 v[112:115], a[84:87], a[208:211], v[112:115]
    buffer_load_dwordx4 a[172:175], v1, s[4:7], s60 offen offset:3072 sc1
    v_mfma_f32_16x16x32_bf16 v[112:115], a[80:83], a[192:195], v[112:115]
    v_mfma_f32_16x16x32_bf16 v[128:131], a[64:67], a[192:195], v[128:131]
    ds_read_b128 a[80:83], v22 offset:40960
    v_mfma_f32_16x16x32_bf16 v[128:131], a[68:71], a[208:211], v[128:131]
    ds_read_b128 a[84:87], v23 offset:40960
    v_mfma_f32_16x16x32_bf16 v[132:135], a[68:71], a[212:215], v[132:135]
    v_mfma_f32_16x16x32_bf16 v[132:135], a[64:67], a[196:199], v[132:135]
    s_xor_b32 s60, s64, 28672
    s_add_u32 s60, s60, s70
    v_mfma_f32_16x16x32_bf16 v[136:139], a[64:67], a[200:203], v[136:139]
    buffer_load_dwordx4 a[176:179], v1, s[4:7], s60 offen offset:0 sc1
    v_mfma_f32_16x16x32_bf16 v[136:139], a[68:71], a[216:219], v[136:139]
    v_mfma_f32_16x16x32_bf16 v[140:143], a[68:71], a[220:223], v[140:143]
    buffer_load_dwordx4 a[180:183], v1, s[4:7], s60 offen offset:1024 sc1
    v_mfma_f32_16x16x32_bf16 v[140:143], a[64:67], a[204:207], v[140:143]
    s_waitcnt lgkmcnt(0)
    v_mfma_f32_16x16x32_bf16 v[156:159], a[72:75], a[204:207], v[156:159]
    ds_read_b128 a[64:67], v22 offset:43008
    v_mfma_f32_16x16x32_bf16 v[156:159], a[76:79], a[220:223], v[156:159]
    ds_read_b128 a[68:71], v23 offset:43008
    v_mfma_f32_16x16x32_bf16 v[152:155], a[76:79], a[216:219], v[152:155]
    v_mfma_f32_16x16x32_bf16 v[152:155], a[72:75], a[200:203], v[152:155]
    v_mfma_f32_16x16x32_bf16 v[148:151], a[72:75], a[196:199], v[148:151]
    buffer_load_dwordx4 a[184:187], v1, s[4:7], s60 offen offset:2048 sc1
    v_mfma_f32_16x16x32_bf16 v[148:151], a[76:79], a[212:215], v[148:151]
    v_mfma_f32_16x16x32_bf16 v[144:147], a[76:79], a[208:211], v[144:147]
    buffer_load_dwordx4 a[188:191], v1, s[4:7], s60 offen offset:3072 sc1
    v_mfma_f32_16x16x32_bf16 v[144:147], a[72:75], a[192:195], v[144:147]
    v_mfma_f32_16x16x32_bf16 v[160:163], a[80:83], a[192:195], v[160:163]
    ds_read_b128 a[72:75], v22 offset:45056
    v_mfma_f32_16x16x32_bf16 v[160:163], a[84:87], a[208:211], v[160:163]
    ds_read_b128 a[76:79], v23 offset:45056
    v_mfma_f32_16x16x32_bf16 v[164:167], a[84:87], a[212:215], v[164:167]
    v_mfma_f32_16x16x32_bf16 v[164:167], a[80:83], a[196:199], v[164:167]
    v_mfma_f32_16x16x32_bf16 v[168:171], a[80:83], a[200:203], v[168:171]
    v_mfma_f32_16x16x32_bf16 v[168:171], a[84:87], a[216:219], v[168:171]
    v_mfma_f32_16x16x32_bf16 v[172:175], a[84:87], a[220:223], v[172:175]
    v_mfma_f32_16x16x32_bf16 v[172:175], a[80:83], a[204:207], v[172:175]
    s_waitcnt lgkmcnt(0)
    v_mfma_f32_16x16x32_bf16 v[188:191], a[64:67], a[204:207], v[188:191]
    ds_read_b128 a[80:83], v22 offset:47104
    v_mfma_f32_16x16x32_bf16 v[188:191], a[68:71], a[220:223], v[188:191]
    ds_read_b128 a[84:87], v23 offset:47104
    v_mfma_f32_16x16x32_bf16 v[184:187], a[68:71], a[216:219], v[184:187]
    v_mfma_f32_16x16x32_bf16 v[184:187], a[64:67], a[200:203], v[184:187]
    v_mfma_f32_16x16x32_bf16 v[180:183], a[64:67], a[196:199], v[180:183]
    v_mfma_f32_16x16x32_bf16 v[180:183], a[68:71], a[212:215], v[180:183]
    v_mfma_f32_16x16x32_bf16 v[176:179], a[68:71], a[208:211], v[176:179]
    v_mfma_f32_16x16x32_bf16 v[176:179], a[64:67], a[192:195], v[176:179]
    v_mfma_f32_16x16x32_bf16 v[192:195], a[72:75], a[192:195], v[192:195]
    s_barrier
    ds_read_b128 a[64:67], v22 offset:49152
    v_mfma_f32_16x16x32_bf16 v[192:195], a[76:79], a[208:211], v[192:195]
    ds_read_b128 a[68:71], v23 offset:49152
    v_mfma_f32_16x16x32_bf16 v[196:199], a[76:79], a[212:215], v[196:199]
    v_mfma_f32_16x16x32_bf16 v[196:199], a[72:75], a[196:199], v[196:199]
    s_add_u32 m0, s63, 65536
    s_xor_b32 s61, s62, 384
    v_mfma_f32_16x16x32_bf16 v[200:203], a[72:75], a[200:203], v[200:203]
    buffer_load_dwordx4 v14, s[28:31], s61 offen offset:0 lds
    v_mfma_f32_16x16x32_bf16 v[200:203], a[76:79], a[216:219], v[200:203]
    v_mfma_f32_16x16x32_bf16 v[204:207], a[76:79], a[220:223], v[204:207]
    buffer_load_dwordx4 v15, s[28:31], s61 offen offset:1024 lds
    v_mfma_f32_16x16x32_bf16 v[204:207], a[72:75], a[204:207], v[204:207]
    s_waitcnt lgkmcnt(0)
    v_mfma_f32_16x16x32_bf16 v[220:223], a[80:83], a[204:207], v[220:223]
    ds_read_b128 a[72:75], v22 offset:51200
    v_mfma_f32_16x16x32_bf16 v[220:223], a[84:87], a[220:223], v[220:223]
    ds_read_b128 a[76:79], v23 offset:51200
    v_mfma_f32_16x16x32_bf16 v[216:219], a[84:87], a[216:219], v[216:219]
    v_mfma_f32_16x16x32_bf16 v[216:219], a[80:83], a[200:203], v[216:219]
    v_mfma_f32_16x16x32_bf16 v[212:215], a[80:83], a[196:199], v[212:215]
    buffer_load_dwordx4 v16, s[28:31], s61 offen offset:2048 lds
    v_mfma_f32_16x16x32_bf16 v[212:215], a[84:87], a[212:215], v[212:215]
    v_mfma_f32_16x16x32_bf16 v[208:211], a[84:87], a[208:211], v[208:211]
    buffer_load_dwordx4 v17, s[28:31], s61 offen offset:3072 lds
    v_mfma_f32_16x16x32_bf16 v[208:211], a[80:83], a[192:195], v[208:211]
    s_waitcnt vmcnt(28)
    v_mfma_f32_16x16x32_bf16 v[96:99], a[64:67], a[224:227], v[96:99]
    ds_read_b128 a[80:83], v22 offset:53248
    v_mfma_f32_16x16x32_bf16 v[96:99], a[68:71], a[240:243], v[96:99]
    ds_read_b128 a[84:87], v23 offset:53248
    v_mfma_f32_16x16x32_bf16 v[100:103], a[68:71], a[244:247], v[100:103]
    v_mfma_f32_16x16x32_bf16 v[100:103], a[64:67], a[228:231], v[100:103]
    s_add_u32 m0, s63, 81920
    s_xor_b32 s61, s62, 384
    v_mfma_f32_16x16x32_bf16 v[104:107], a[64:67], a[232:235], v[104:107]
    buffer_load_dwordx4 v14, s[32:35], s61 offen offset:0 lds
    v_mfma_f32_16x16x32_bf16 v[104:107], a[68:71], a[248:251], v[104:107]
    v_mfma_f32_16x16x32_bf16 v[108:111], a[68:71], a[252:255], v[108:111]
    buffer_load_dwordx4 v15, s[32:35], s61 offen offset:1024 lds
    v_mfma_f32_16x16x32_bf16 v[108:111], a[64:67], a[236:239], v[108:111]
    s_waitcnt lgkmcnt(0)
    v_mfma_f32_16x16x32_bf16 v[124:127], a[72:75], a[236:239], v[124:127]
    ds_read_b128 a[64:67], v22 offset:55296
    v_mfma_f32_16x16x32_bf16 v[124:127], a[76:79], a[252:255], v[124:127]
    ds_read_b128 a[68:71], v23 offset:55296
    v_mfma_f32_16x16x32_bf16 v[120:123], a[76:79], a[248:251], v[120:123]
    v_mfma_f32_16x16x32_bf16 v[120:123], a[72:75], a[232:235], v[120:123]
    v_mfma_f32_16x16x32_bf16 v[116:119], a[72:75], a[228:231], v[116:119]
    buffer_load_dwordx4 v16, s[32:35], s61 offen offset:2048 lds
    v_mfma_f32_16x16x32_bf16 v[116:119], a[76:79], a[244:247], v[116:119]
    v_mfma_f32_16x16x32_bf16 v[112:115], a[76:79], a[240:243], v[112:115]
    buffer_load_dwordx4 v17, s[32:35], s61 offen offset:3072 lds
    v_mfma_f32_16x16x32_bf16 v[112:115], a[72:75], a[224:227], v[112:115]
    v_mfma_f32_16x16x32_bf16 v[128:131], a[80:83], a[224:227], v[128:131]
    ds_read_b128 a[72:75], v22 offset:57344
    v_mfma_f32_16x16x32_bf16 v[128:131], a[84:87], a[240:243], v[128:131]
    ds_read_b128 a[76:79], v23 offset:57344
    v_mfma_f32_16x16x32_bf16 v[132:135], a[84:87], a[244:247], v[132:135]
    v_mfma_f32_16x16x32_bf16 v[132:135], a[80:83], a[228:231], v[132:135]
    s_xor_b32 s60, s64, 32768
    s_add_u32 s60, s60, s70
    v_mfma_f32_16x16x32_bf16 v[136:139], a[80:83], a[232:235], v[136:139]
    buffer_load_dwordx4 a[192:195], v1, s[4:7], s60 offen offset:0 sc1
    v_mfma_f32_16x16x32_bf16 v[136:139], a[84:87], a[248:251], v[136:139]
    v_mfma_f32_16x16x32_bf16 v[140:143], a[84:87], a[252:255], v[140:143]
    buffer_load_dwordx4 a[196:199], v1, s[4:7], s60 offen offset:1024 sc1
    v_mfma_f32_16x16x32_bf16 v[140:143], a[80:83], a[236:239], v[140:143]
    s_waitcnt lgkmcnt(0)
    v_mfma_f32_16x16x32_bf16 v[156:159], a[64:67], a[236:239], v[156:159]
    ds_read_b128 a[80:83], v22 offset:59392
    v_mfma_f32_16x16x32_bf16 v[156:159], a[68:71], a[252:255], v[156:159]
    ds_read_b128 a[84:87], v23 offset:59392
    v_mfma_f32_16x16x32_bf16 v[152:155], a[68:71], a[248:251], v[152:155]
    v_mfma_f32_16x16x32_bf16 v[152:155], a[64:67], a[232:235], v[152:155]
    v_mfma_f32_16x16x32_bf16 v[148:151], a[64:67], a[228:231], v[148:151]
    buffer_load_dwordx4 a[200:203], v1, s[4:7], s60 offen offset:2048 sc1
    v_mfma_f32_16x16x32_bf16 v[148:151], a[68:71], a[244:247], v[148:151]
    v_mfma_f32_16x16x32_bf16 v[144:147], a[68:71], a[240:243], v[144:147]
    buffer_load_dwordx4 a[204:207], v1, s[4:7], s60 offen offset:3072 sc1
    v_mfma_f32_16x16x32_bf16 v[144:147], a[64:67], a[224:227], v[144:147]
    v_mfma_f32_16x16x32_bf16 v[160:163], a[72:75], a[224:227], v[160:163]
    ds_read_b128 a[64:67], v22 offset:61440
    v_mfma_f32_16x16x32_bf16 v[160:163], a[76:79], a[240:243], v[160:163]
    ds_read_b128 a[68:71], v23 offset:61440
    v_mfma_f32_16x16x32_bf16 v[164:167], a[76:79], a[244:247], v[164:167]
    v_mfma_f32_16x16x32_bf16 v[164:167], a[72:75], a[228:231], v[164:167]
    s_xor_b32 s60, s64, 36864
    s_add_u32 s60, s60, s70
    v_mfma_f32_16x16x32_bf16 v[168:171], a[72:75], a[232:235], v[168:171]
    buffer_load_dwordx4 a[208:211], v1, s[4:7], s60 offen offset:0 sc1
    v_mfma_f32_16x16x32_bf16 v[168:171], a[76:79], a[248:251], v[168:171]
    v_mfma_f32_16x16x32_bf16 v[172:175], a[76:79], a[252:255], v[172:175]
    buffer_load_dwordx4 a[212:215], v1, s[4:7], s60 offen offset:1024 sc1
    v_mfma_f32_16x16x32_bf16 v[172:175], a[72:75], a[236:239], v[172:175]
    s_waitcnt lgkmcnt(0)
    v_mfma_f32_16x16x32_bf16 v[188:191], a[80:83], a[236:239], v[188:191]
    ds_read_b128 a[72:75], v22 offset:63488
    v_mfma_f32_16x16x32_bf16 v[188:191], a[84:87], a[252:255], v[188:191]
    ds_read_b128 a[76:79], v23 offset:63488
    v_mfma_f32_16x16x32_bf16 v[184:187], a[84:87], a[248:251], v[184:187]
    v_mfma_f32_16x16x32_bf16 v[184:187], a[80:83], a[232:235], v[184:187]
    v_mfma_f32_16x16x32_bf16 v[180:183], a[80:83], a[228:231], v[180:183]
    buffer_load_dwordx4 a[216:219], v1, s[4:7], s60 offen offset:2048 sc1
    v_mfma_f32_16x16x32_bf16 v[180:183], a[84:87], a[244:247], v[180:183]
    v_mfma_f32_16x16x32_bf16 v[176:179], a[84:87], a[240:243], v[176:179]
    buffer_load_dwordx4 a[220:223], v1, s[4:7], s60 offen offset:3072 sc1
    v_mfma_f32_16x16x32_bf16 v[176:179], a[80:83], a[224:227], v[176:179]
    v_mfma_f32_16x16x32_bf16 v[192:195], a[64:67], a[224:227], v[192:195]
    ds_read_b128 a[80:83], v20 offset:0
    v_mfma_f32_16x16x32_bf16 v[192:195], a[68:71], a[240:243], v[192:195]
    ds_read_b128 a[84:87], v21 offset:0
    v_mfma_f32_16x16x32_bf16 v[196:199], a[68:71], a[244:247], v[196:199]
    v_mfma_f32_16x16x32_bf16 v[196:199], a[64:67], a[228:231], v[196:199]
    s_xor_b32 s60, s64, 40960
    s_add_u32 s60, s60, s70
    v_mfma_f32_16x16x32_bf16 v[200:203], a[64:67], a[232:235], v[200:203]
    buffer_load_dwordx4 v[64:67], v1, s[4:7], s60 offen offset:0 sc1
    v_mfma_f32_16x16x32_bf16 v[200:203], a[68:71], a[248:251], v[200:203]
    v_mfma_f32_16x16x32_bf16 v[204:207], a[68:71], a[252:255], v[204:207]
    buffer_load_dwordx4 v[68:71], v1, s[4:7], s60 offen offset:1024 sc1
    v_mfma_f32_16x16x32_bf16 v[204:207], a[64:67], a[236:239], v[204:207]
    s_waitcnt lgkmcnt(0)
    v_mfma_f32_16x16x32_bf16 v[220:223], a[72:75], a[236:239], v[220:223]
    ds_read_b128 a[64:67], v20 offset:2048
    v_mfma_f32_16x16x32_bf16 v[220:223], a[76:79], a[252:255], v[220:223]
    ds_read_b128 a[68:71], v21 offset:2048
    v_mfma_f32_16x16x32_bf16 v[216:219], a[76:79], a[248:251], v[216:219]
    v_mfma_f32_16x16x32_bf16 v[216:219], a[72:75], a[232:235], v[216:219]
    v_mfma_f32_16x16x32_bf16 v[212:215], a[72:75], a[228:231], v[212:215]
    buffer_load_dwordx4 v[72:75], v1, s[4:7], s60 offen offset:2048 sc1
    v_mfma_f32_16x16x32_bf16 v[212:215], a[76:79], a[244:247], v[212:215]
    v_mfma_f32_16x16x32_bf16 v[208:211], a[76:79], a[240:243], v[208:211]
    buffer_load_dwordx4 v[76:79], v1, s[4:7], s60 offen offset:3072 sc1
    v_mfma_f32_16x16x32_bf16 v[208:211], a[72:75], a[224:227], v[208:211]
    s_waitcnt vmcnt(28)
    v_mfma_f32_16x16x32_bf16 v[96:99], a[80:83], a[128:131], v[96:99]
    ds_read_b128 a[72:75], v20 offset:4096
    v_mfma_f32_16x16x32_bf16 v[96:99], a[84:87], a[144:147], v[96:99]
    ds_read_b128 a[76:79], v21 offset:4096
    v_mfma_f32_16x16x32_bf16 v[100:103], a[84:87], a[148:151], v[100:103]
    v_mfma_f32_16x16x32_bf16 v[100:103], a[80:83], a[132:135], v[100:103]
    s_xor_b32 s60, s64, 45056
    s_add_u32 s60, s60, s70
    v_mfma_f32_16x16x32_bf16 v[104:107], a[80:83], a[136:139], v[104:107]
    buffer_load_dwordx4 v[80:83], v1, s[4:7], s60 offen offset:0 sc1
    v_mfma_f32_16x16x32_bf16 v[104:107], a[84:87], a[152:155], v[104:107]
    v_mfma_f32_16x16x32_bf16 v[108:111], a[84:87], a[156:159], v[108:111]
    buffer_load_dwordx4 v[84:87], v1, s[4:7], s60 offen offset:1024 sc1
    v_mfma_f32_16x16x32_bf16 v[108:111], a[80:83], a[140:143], v[108:111]
    s_waitcnt lgkmcnt(0)
    v_mfma_f32_16x16x32_bf16 v[124:127], a[64:67], a[140:143], v[124:127]
    ds_read_b128 a[80:83], v20 offset:6144
    v_mfma_f32_16x16x32_bf16 v[124:127], a[68:71], a[156:159], v[124:127]
    ds_read_b128 a[84:87], v21 offset:6144
    v_mfma_f32_16x16x32_bf16 v[120:123], a[68:71], a[152:155], v[120:123]
    v_mfma_f32_16x16x32_bf16 v[120:123], a[64:67], a[136:139], v[120:123]
    v_mfma_f32_16x16x32_bf16 v[116:119], a[64:67], a[132:135], v[116:119]
    buffer_load_dwordx4 v[88:91], v1, s[4:7], s60 offen offset:2048 sc1
    v_mfma_f32_16x16x32_bf16 v[116:119], a[68:71], a[148:151], v[116:119]
    v_mfma_f32_16x16x32_bf16 v[112:115], a[68:71], a[144:147], v[112:115]
    buffer_load_dwordx4 v[92:95], v1, s[4:7], s60 offen offset:3072 sc1
    v_mfma_f32_16x16x32_bf16 v[112:115], a[64:67], a[128:131], v[112:115]
    v_mfma_f32_16x16x32_bf16 v[128:131], a[72:75], a[128:131], v[128:131]
    ds_read_b128 a[64:67], v20 offset:8192
    v_mfma_f32_16x16x32_bf16 v[128:131], a[76:79], a[144:147], v[128:131]
    ds_read_b128 a[68:71], v21 offset:8192
    v_mfma_f32_16x16x32_bf16 v[132:135], a[76:79], a[148:151], v[132:135]
    v_mfma_f32_16x16x32_bf16 v[132:135], a[72:75], a[132:135], v[132:135]
    s_xor_b32 s60, s64, 49152
    s_add_u32 s60, s60, s70
    v_mfma_f32_16x16x32_bf16 v[136:139], a[72:75], a[136:139], v[136:139]
    buffer_load_dwordx4 v[32:35], v1, s[4:7], s60 offen offset:0 sc1
    v_mfma_f32_16x16x32_bf16 v[136:139], a[76:79], a[152:155], v[136:139]
    v_mfma_f32_16x16x32_bf16 v[140:143], a[76:79], a[156:159], v[140:143]
    buffer_load_dwordx4 v[36:39], v1, s[4:7], s60 offen offset:1024 sc1
    v_mfma_f32_16x16x32_bf16 v[140:143], a[72:75], a[140:143], v[140:143]
    s_waitcnt lgkmcnt(0)
    v_mfma_f32_16x16x32_bf16 v[156:159], a[80:83], a[140:143], v[156:159]
    ds_read_b128 a[72:75], v20 offset:10240
    v_mfma_f32_16x16x32_bf16 v[156:159], a[84:87], a[156:159], v[156:159]
    ds_read_b128 a[76:79], v21 offset:10240
    v_mfma_f32_16x16x32_bf16 v[152:155], a[84:87], a[152:155], v[152:155]
    v_mfma_f32_16x16x32_bf16 v[152:155], a[80:83], a[136:139], v[152:155]
    v_mfma_f32_16x16x32_bf16 v[148:151], a[80:83], a[132:135], v[148:151]
    buffer_load_dwordx4 v[40:43], v1, s[4:7], s60 offen offset:2048 sc1
    v_mfma_f32_16x16x32_bf16 v[148:151], a[84:87], a[148:151], v[148:151]
    v_mfma_f32_16x16x32_bf16 v[144:147], a[84:87], a[144:147], v[144:147]
    buffer_load_dwordx4 v[44:47], v1, s[4:7], s60 offen offset:3072 sc1
    v_mfma_f32_16x16x32_bf16 v[144:147], a[80:83], a[128:131], v[144:147]
    v_mfma_f32_16x16x32_bf16 v[160:163], a[64:67], a[128:131], v[160:163]
    ds_read_b128 a[80:83], v20 offset:12288
    v_mfma_f32_16x16x32_bf16 v[160:163], a[68:71], a[144:147], v[160:163]
    ds_read_b128 a[84:87], v21 offset:12288
    v_mfma_f32_16x16x32_bf16 v[164:167], a[68:71], a[148:151], v[164:167]
    v_mfma_f32_16x16x32_bf16 v[164:167], a[64:67], a[132:135], v[164:167]
    s_xor_b32 s60, s64, 53248
    s_add_u32 s60, s60, s70
    v_mfma_f32_16x16x32_bf16 v[168:171], a[64:67], a[136:139], v[168:171]
    buffer_load_dwordx4 v[48:51], v1, s[4:7], s60 offen offset:0 sc1
    v_mfma_f32_16x16x32_bf16 v[168:171], a[68:71], a[152:155], v[168:171]
    v_mfma_f32_16x16x32_bf16 v[172:175], a[68:71], a[156:159], v[172:175]
    buffer_load_dwordx4 v[52:55], v1, s[4:7], s60 offen offset:1024 sc1
    v_mfma_f32_16x16x32_bf16 v[172:175], a[64:67], a[140:143], v[172:175]
    s_waitcnt lgkmcnt(0)
    v_mfma_f32_16x16x32_bf16 v[188:191], a[72:75], a[140:143], v[188:191]
    ds_read_b128 a[64:67], v20 offset:14336
    v_mfma_f32_16x16x32_bf16 v[188:191], a[76:79], a[156:159], v[188:191]
    ds_read_b128 a[68:71], v21 offset:14336
    v_mfma_f32_16x16x32_bf16 v[184:187], a[76:79], a[152:155], v[184:187]
    v_mfma_f32_16x16x32_bf16 v[184:187], a[72:75], a[136:139], v[184:187]
    v_mfma_f32_16x16x32_bf16 v[180:183], a[72:75], a[132:135], v[180:183]
    buffer_load_dwordx4 v[56:59], v1, s[4:7], s60 offen offset:2048 sc1
    v_mfma_f32_16x16x32_bf16 v[180:183], a[76:79], a[148:151], v[180:183]
    v_mfma_f32_16x16x32_bf16 v[176:179], a[76:79], a[144:147], v[176:179]
    buffer_load_dwordx4 v[60:63], v1, s[4:7], s60 offen offset:3072 sc1
    v_mfma_f32_16x16x32_bf16 v[176:179], a[72:75], a[128:131], v[176:179]
    v_mfma_f32_16x16x32_bf16 v[192:195], a[80:83], a[128:131], v[192:195]
    s_waitcnt vmcnt(24)
    s_barrier
    ds_read_b128 a[72:75], v20 offset:20480
    v_mfma_f32_16x16x32_bf16 v[192:195], a[84:87], a[144:147], v[192:195]
    ds_read_b128 a[76:79], v21 offset:20480
    v_mfma_f32_16x16x32_bf16 v[196:199], a[84:87], a[148:151], v[196:199]
    v_mfma_f32_16x16x32_bf16 v[196:199], a[80:83], a[132:135], v[196:199]
    s_xor_b32 s60, s64, 57344
    s_add_u32 s60, s60, s70
    v_mfma_f32_16x16x32_bf16 v[200:203], a[80:83], a[136:139], v[200:203]
    buffer_load_dwordx4 a[224:227], v1, s[4:7], s60 offen offset:0 sc1
    v_mfma_f32_16x16x32_bf16 v[200:203], a[84:87], a[152:155], v[200:203]
    v_mfma_f32_16x16x32_bf16 v[204:207], a[84:87], a[156:159], v[204:207]
    buffer_load_dwordx4 a[228:231], v1, s[4:7], s60 offen offset:1024 sc1
    v_mfma_f32_16x16x32_bf16 v[204:207], a[80:83], a[140:143], v[204:207]
    s_waitcnt lgkmcnt(0)
    v_mfma_f32_16x16x32_bf16 v[220:223], a[64:67], a[140:143], v[220:223]
    ds_read_b128 a[80:83], v20 offset:22528
    v_mfma_f32_16x16x32_bf16 v[220:223], a[68:71], a[156:159], v[220:223]
    ds_read_b128 a[84:87], v21 offset:22528
    v_mfma_f32_16x16x32_bf16 v[216:219], a[68:71], a[152:155], v[216:219]
    v_mfma_f32_16x16x32_bf16 v[216:219], a[64:67], a[136:139], v[216:219]
    v_mfma_f32_16x16x32_bf16 v[212:215], a[64:67], a[132:135], v[212:215]
    buffer_load_dwordx4 a[232:235], v1, s[4:7], s60 offen offset:2048 sc1
    v_mfma_f32_16x16x32_bf16 v[212:215], a[68:71], a[148:151], v[212:215]
    v_mfma_f32_16x16x32_bf16 v[208:211], a[68:71], a[144:147], v[208:211]
    buffer_load_dwordx4 a[236:239], v1, s[4:7], s60 offen offset:3072 sc1
    v_mfma_f32_16x16x32_bf16 v[208:211], a[64:67], a[128:131], v[208:211]
    v_mfma_f32_16x16x32_bf16 v[128:131], a[72:75], a[160:163], v[128:131]
    ds_read_b128 a[64:67], v20 offset:36864
    v_mfma_f32_16x16x32_bf16 v[128:131], a[76:79], a[176:179], v[128:131]
    ds_read_b128 a[68:71], v21 offset:36864
    v_mfma_f32_16x16x32_bf16 v[132:135], a[76:79], a[180:183], v[132:135]
    v_mfma_f32_16x16x32_bf16 v[132:135], a[72:75], a[164:167], v[132:135]
    s_xor_b32 s60, s64, 61440
    s_add_u32 s60, s60, s70
    v_mfma_f32_16x16x32_bf16 v[136:139], a[72:75], a[168:171], v[136:139]
    buffer_load_dwordx4 a[240:243], v1, s[4:7], s60 offen offset:0 sc1
    v_mfma_f32_16x16x32_bf16 v[136:139], a[76:79], a[184:187], v[136:139]
    v_mfma_f32_16x16x32_bf16 v[140:143], a[76:79], a[188:191], v[140:143]
    buffer_load_dwordx4 a[244:247], v1, s[4:7], s60 offen offset:1024 sc1
    v_mfma_f32_16x16x32_bf16 v[140:143], a[72:75], a[172:175], v[140:143]
    s_waitcnt lgkmcnt(0)
    v_mfma_f32_16x16x32_bf16 v[156:159], a[80:83], a[172:175], v[156:159]
    ds_read_b128 a[72:75], v20 offset:38912
    v_mfma_f32_16x16x32_bf16 v[156:159], a[84:87], a[188:191], v[156:159]
    ds_read_b128 a[76:79], v21 offset:38912
    v_mfma_f32_16x16x32_bf16 v[152:155], a[84:87], a[184:187], v[152:155]
    v_mfma_f32_16x16x32_bf16 v[152:155], a[80:83], a[168:171], v[152:155]
    v_mfma_f32_16x16x32_bf16 v[148:151], a[80:83], a[164:167], v[148:151]
    buffer_load_dwordx4 a[248:251], v1, s[4:7], s60 offen offset:2048 sc1
    v_mfma_f32_16x16x32_bf16 v[148:151], a[84:87], a[180:183], v[148:151]
    v_mfma_f32_16x16x32_bf16 v[144:147], a[84:87], a[176:179], v[144:147]
    buffer_load_dwordx4 a[252:255], v1, s[4:7], s60 offen offset:3072 sc1
    v_mfma_f32_16x16x32_bf16 v[144:147], a[80:83], a[160:163], v[144:147]
    s_waitcnt vmcnt(24)
    v_mfma_f32_16x16x32_bf16 v[128:131], a[64:67], a[192:195], v[128:131]
    ds_read_b128 a[80:83], v20 offset:53248
    v_mfma_f32_16x16x32_bf16 v[128:131], a[68:71], a[208:211], v[128:131]
    ds_read_b128 a[84:87], v21 offset:53248
    v_mfma_f32_16x16x32_bf16 v[132:135], a[68:71], a[212:215], v[132:135]
    v_mfma_f32_16x16x32_bf16 v[132:135], a[64:67], a[196:199], v[132:135]
    v_mfma_f32_16x16x32_bf16 v[136:139], a[64:67], a[200:203], v[136:139]
    buffer_load_ushort v224, v27, s[48:51], s54 offen offset:0
    v_mfma_f32_16x16x32_bf16 v[136:139], a[68:71], a[216:219], v[136:139]
L_pad11:
    s_cbranch_execz L_warm_ret
    v_mfma_f32_16x16x32_bf16 v[140:143], a[68:71], a[220:223], v[140:143]
    buffer_load_ushort v225, v27, s[48:51], s54 offen offset:32
    v_mfma_f32_16x16x32_bf16 v[140:143], a[64:67], a[204:207], v[140:143]
    s_waitcnt lgkmcnt(0)
    v_mfma_f32_16x16x32_bf16 v[156:159], a[72:75], a[204:207], v[156:159]
    ds_read_b128 a[64:67], v20 offset:55296
    v_mfma_f32_16x16x32_bf16 v[156:159], a[76:79], a[220:223], v[156:159]
    ds_read_b128 a[68:71], v21 offset:55296
    v_mfma_f32_16x16x32_bf16 v[152:155], a[76:79], a[216:219], v[152:155]
    v_mfma_f32_16x16x32_bf16 v[152:155], a[72:75], a[200:203], v[152:155]
    v_mfma_f32_16x16x32_bf16 v[148:151], a[72:75], a[196:199], v[148:151]
    buffer_load_dwordx4 a[16:19], v1, s[4:7], s81 offen offset:0 sc1
    v_mfma_f32_16x16x32_bf16 v[148:151], a[76:79], a[212:215], v[148:151]
    v_mfma_f32_16x16x32_bf16 v[144:147], a[76:79], a[208:211], v[144:147]
    buffer_load_dwordx4 a[20:23], v1, s[4:7], s81 offen offset:1024 sc1
    v_mfma_f32_16x16x32_bf16 v[144:147], a[72:75], a[192:195], v[144:147]
    s_waitcnt vmcnt(20)
    v_mfma_f32_16x16x32_bf16 v[128:131], a[80:83], v[64:67], v[128:131]
    ds_read_b128 a[72:75], v22 offset:4096
    v_mfma_f32_16x16x32_bf16 v[128:131], a[84:87], v[80:83], v[128:131]
    ds_read_b128 a[76:79], v23 offset:4096
    v_mfma_f32_16x16x32_bf16 v[132:135], a[84:87], v[84:87], v[132:135]
    v_mfma_f32_16x16x32_bf16 v[132:135], a[80:83], v[68:71], v[132:135]
    v_mfma_f32_16x16x32_bf16 v[136:139], a[80:83], v[72:75], v[136:139]
    buffer_load_dwordx4 a[24:27], v1, s[4:7], s81 offen offset:2048 sc1
    v_mfma_f32_16x16x32_bf16 v[136:139], a[84:87], v[88:91], v[136:139]
    v_mfma_f32_16x16x32_bf16 v[140:143], a[84:87], v[92:95], v[140:143]
    buffer_load_dwordx4 a[28:31], v1, s[4:7], s81 offen offset:3072 sc1
    v_mfma_f32_16x16x32_bf16 v[140:143], a[80:83], v[76:79], v[140:143]
    s_waitcnt lgkmcnt(0)
    v_mfma_f32_16x16x32_bf16 v[156:159], a[64:67], v[76:79], v[156:159]
    ds_read_b128 a[80:83], v22 offset:6144
    v_mfma_f32_16x16x32_bf16 v[156:159], a[68:71], v[92:95], v[156:159]
    ds_read_b128 a[84:87], v23 offset:6144
    v_mfma_f32_16x16x32_bf16 v[152:155], a[68:71], v[88:91], v[152:155]
    v_mfma_f32_16x16x32_bf16 v[152:155], a[64:67], v[72:75], v[152:155]
    v_mfma_f32_16x16x32_bf16 v[148:151], a[64:67], v[68:71], v[148:151]
    v_mfma_f32_16x16x32_bf16 v[148:151], a[68:71], v[84:87], v[148:151]
    v_mfma_f32_16x16x32_bf16 v[144:147], a[68:71], v[80:83], v[144:147]
    v_mfma_f32_16x16x32_bf16 v[144:147], a[64:67], v[64:67], v[144:147]
    s_waitcnt vmcnt(14)
    v_mfma_f32_16x16x32_bf16 v[128:131], a[72:75], v[32:35], v[128:131]
    ds_read_b128 a[64:67], v22 offset:20480
    v_mfma_f32_16x16x32_bf16 v[128:131], a[76:79], v[48:51], v[128:131]
    ds_read_b128 a[68:71], v23 offset:20480
    v_mfma_f32_16x16x32_bf16 v[132:135], a[76:79], v[52:55], v[132:135]
    v_mfma_f32_16x16x32_bf16 v[132:135], a[72:75], v[36:39], v[132:135]
    v_mfma_f32_16x16x32_bf16 v[136:139], a[72:75], v[40:43], v[136:139]
    v_mfma_f32_16x16x32_bf16 v[136:139], a[76:79], v[56:59], v[136:139]
    v_mfma_f32_16x16x32_bf16 v[140:143], a[76:79], v[60:63], v[140:143]
    v_mfma_f32_16x16x32_bf16 v[140:143], a[72:75], v[44:47], v[140:143]
    s_waitcnt lgkmcnt(0)
    v_mfma_f32_16x16x32_bf16 v[156:159], a[80:83], v[44:47], v[156:159]
    ds_read_b128 a[72:75], v22 offset:22528
    v_mfma_f32_16x16x32_bf16 v[156:159], a[84:87], v[60:63], v[156:159]
    ds_read_b128 a[76:79], v23 offset:22528
    v_mfma_f32_16x16x32_bf16 v[152:155], a[84:87], v[56:59], v[152:155]
    v_mfma_f32_16x16x32_bf16 v[152:155], a[80:83], v[40:43], v[152:155]
    v_mfma_f32_16x16x32_bf16 v[148:151], a[80:83], v[36:39], v[148:151]
    v_mfma_f32_16x16x32_bf16 v[148:151], a[84:87], v[52:55], v[148:151]
    v_mfma_f32_16x16x32_bf16 v[144:147], a[84:87], v[48:51], v[144:147]
    v_mfma_f32_16x16x32_bf16 v[144:147], a[80:83], v[32:35], v[144:147]
    s_waitcnt vmcnt(6)
    v_mfma_f32_16x16x32_bf16 v[128:131], a[64:67], a[224:227], v[128:131]
    ds_read_b128 a[80:83], v20 offset:24576
    v_mfma_f32_16x16x32_bf16 v[128:131], a[68:71], a[240:243], v[128:131]
    ds_read_b128 a[84:87], v21 offset:24576
    v_mfma_f32_16x16x32_bf16 v[132:135], a[68:71], a[244:247], v[132:135]
    v_mfma_f32_16x16x32_bf16 v[132:135], a[64:67], a[228:231], v[132:135]
    v_mfma_f32_16x16x32_bf16 v[136:139], a[64:67], a[232:235], v[136:139]
    v_mfma_f32_16x16x32_bf16 v[136:139], a[68:71], a[248:251], v[136:139]
    v_mfma_f32_16x16x32_bf16 v[140:143], a[68:71], a[252:255], v[140:143]
    v_mfma_f32_16x16x32_bf16 v[140:143], a[64:67], a[236:239], v[140:143]
    s_waitcnt lgkmcnt(0)
    v_mfma_f32_16x16x32_bf16 v[156:159], a[72:75], a[236:239], v[156:159]
    ds_read_b128 a[64:67], v20 offset:40960
    v_mfma_f32_16x16x32_bf16 v[156:159], a[76:79], a[252:255], v[156:159]
    ds_read_b128 a[68:71], v21 offset:40960
    v_mfma_f32_16x16x32_bf16 v[152:155], a[76:79], a[248:251], v[152:155]
    v_mfma_f32_16x16x32_bf16 v[152:155], a[72:75], a[232:235], v[152:155]
    v_mfma_f32_16x16x32_bf16 v[148:151], a[72:75], a[228:231], v[148:151]
    v_mfma_f32_16x16x32_bf16 v[148:151], a[76:79], a[244:247], v[148:151]
    v_mfma_f32_16x16x32_bf16 v[144:147], a[76:79], a[240:243], v[144:147]
    v_mfma_f32_16x16x32_bf16 v[144:147], a[72:75], a[224:227], v[144:147]
    v_mfma_f32_16x16x32_bf16 v[160:163], a[80:83], a[160:163], v[160:163]
    ds_read_b128 a[72:75], v20 offset:57344
    v_mfma_f32_16x16x32_bf16 v[160:163], a[84:87], a[176:179], v[160:163]
    ds_read_b128 a[76:79], v21 offset:57344
    v_mfma_f32_16x16x32_bf16 v[164:167], a[84:87], a[180:183], v[164:167]
    v_mfma_f32_16x16x32_bf16 v[164:167], a[80:83], a[164:167], v[164:167]
    s_xor_b32 s21, s76, 8
    s_lshl_b32 s21, s21, 12
    v_mfma_f32_16x16x32_bf16 v[168:171], a[80:83], a[168:171], v[168:171]
    s_add_u32 s21, s21, 37748736
    v_cvt_pk_bf16_f32 v128, v128, v129
    v_mfma_f32_16x16x32_bf16 v[168:171], a[84:87], a[184:187], v[168:171]
    v_cvt_pk_bf16_f32 v129, v130, v131
    v_cvt_pk_bf16_f32 v130, v132, v133
    v_mfma_f32_16x16x32_bf16 v[172:175], a[84:87], a[188:191], v[172:175]
    v_cvt_pk_bf16_f32 v131, v134, v135
    v_mfma_f32_16x16x32_bf16 v[172:175], a[80:83], a[172:175], v[172:175]
    buffer_store_dwordx4 v[128:131], v1, s[4:7], s21 offen offset:0 sc1
    s_waitcnt lgkmcnt(0)
    v_mfma_f32_16x16x32_bf16 v[172:175], a[64:67], a[204:207], v[172:175]
    ds_read_b128 a[80:83], v22 offset:8192
    v_cvt_pk_bf16_f32 v136, v136, v137
    v_mfma_f32_16x16x32_bf16 v[172:175], a[68:71], a[220:223], v[172:175]
    ds_read_b128 a[84:87], v23 offset:8192
    v_cvt_pk_bf16_f32 v137, v138, v139
    v_mfma_f32_16x16x32_bf16 v[168:171], a[68:71], a[216:219], v[168:171]
    v_cvt_pk_bf16_f32 v138, v140, v141
    v_cvt_pk_bf16_f32 v139, v142, v143
    v_mfma_f32_16x16x32_bf16 v[168:171], a[64:67], a[200:203], v[168:171]
    buffer_store_dwordx4 v[136:139], v1, s[4:7], s21 offen offset:1024 sc1
    v_mfma_f32_16x16x32_bf16 v[164:167], a[64:67], a[196:199], v[164:167]
    v_cvt_pk_bf16_f32 v144, v144, v145
    v_cvt_pk_bf16_f32 v145, v146, v147
    v_mfma_f32_16x16x32_bf16 v[164:167], a[68:71], a[212:215], v[164:167]
    v_cvt_pk_bf16_f32 v146, v148, v149
    v_cvt_pk_bf16_f32 v147, v150, v151
    v_mfma_f32_16x16x32_bf16 v[160:163], a[68:71], a[208:211], v[160:163]
    buffer_store_dwordx4 v[144:147], v1, s[4:7], s21 offen offset:2048 sc1
    v_mfma_f32_16x16x32_bf16 v[160:163], a[64:67], a[192:195], v[160:163]
    v_cvt_pk_bf16_f32 v152, v152, v153
    v_cvt_pk_bf16_f32 v153, v154, v155
    v_mfma_f32_16x16x32_bf16 v[160:163], a[72:75], v[64:67], v[160:163]
    ds_read_b128 a[64:67], v22 offset:24576
    v_cvt_pk_bf16_f32 v154, v156, v157
    v_mfma_f32_16x16x32_bf16 v[160:163], a[76:79], v[80:83], v[160:163]
    ds_read_b128 a[68:71], v23 offset:24576
    v_cvt_pk_bf16_f32 v155, v158, v159
    v_mfma_f32_16x16x32_bf16 v[164:167], a[76:79], v[84:87], v[164:167]
    buffer_store_dwordx4 v[152:155], v1, s[4:7], s21 offen offset:3072 sc1
    v_mfma_f32_16x16x32_bf16 v[164:167], a[72:75], v[68:71], v[164:167]
    ds_read_b128 a[0:3], v26 offset:0
    v_mfma_f32_16x16x32_bf16 v[168:171], a[72:75], v[72:75], v[168:171]
    ds_read_b128 a[4:7], v26 offset:1024
    v_mfma_f32_16x16x32_bf16 v[168:171], a[76:79], v[88:91], v[168:171]
    ds_read_b128 a[8:11], v26 offset:2048
    v_mfma_f32_16x16x32_bf16 v[172:175], a[76:79], v[92:95], v[172:175]
    ds_read_b128 a[12:15], v26 offset:3072
    s_waitcnt vmcnt(8)
    v_mfma_f32_16x16x32_bf16 v[172:175], a[72:75], v[76:79], v[172:175]
    v_bfe_u32 v226, v0, 1, 3
    v_lshlrev_b32 v227, 2, v18
    s_waitcnt lgkmcnt(3)
    v_mfma_f32_16x16x32_bf16 v[172:175], a[80:83], v[44:47], v[172:175]
    ds_read_b128 a[72:75], v20 offset:26624
    v_sub_u32 v226, v227, v226
    v_mfma_f32_16x16x32_bf16 v[172:175], a[84:87], v[60:63], v[172:175]
    ds_read_b128 a[76:79], v21 offset:26624
    v_and_b32 v227, 1, v0
    v_mfma_f32_16x16x32_bf16 v[168:171], a[84:87], v[56:59], v[168:171]
    v_lshlrev_b32 v227, 4, v227
    v_lshlrev_b32 v224, v227, v224
    v_mfma_f32_16x16x32_bf16 v[168:171], a[80:83], v[40:43], v[168:171]
    v_lshlrev_b32 v225, v227, v225
    v_mov_b32 v228, 0x3f80
    v_mfma_f32_16x16x32_bf16 v[164:167], a[80:83], v[36:39], v[164:167]
    v_lshlrev_b32 v228, v227, v228
    v_cmp_eq_i32 s[8:9], 0, v226
    v_mfma_f32_16x16x32_bf16 v[164:167], a[84:87], v[52:55], v[164:167]
    v_cmp_eq_i32 s[10:11], -1, v226
    v_cmp_eq_i32 s[12:13], -2, v226
    v_mfma_f32_16x16x32_bf16 v[160:163], a[84:87], v[48:51], v[160:163]
    v_cmp_eq_i32 s[14:15], -3, v226
    v_cndmask_b32 v232, 0, v228, s[8:9]
    v_mfma_f32_16x16x32_bf16 v[160:163], a[80:83], v[32:35], v[160:163]
    v_cndmask_b32 v233, 0, v228, s[10:11]
    v_cndmask_b32 v234, 0, v228, s[12:13]
    v_mfma_f32_16x16x32_bf16 v[160:163], a[64:67], a[224:227], v[160:163]
    ds_read_b128 a[80:83], v20 offset:43008
    v_cndmask_b32 v235, 0, v228, s[14:15]
    v_mfma_f32_16x16x32_bf16 v[160:163], a[68:71], a[240:243], v[160:163]
    ds_read_b128 a[84:87], v21 offset:43008
    v_cndmask_b32 v240, 0, v224, s[8:9]
    v_mfma_f32_16x16x32_bf16 v[164:167], a[68:71], a[244:247], v[164:167]
    v_cndmask_b32 v241, 0, v224, s[10:11]
    v_cndmask_b32 v242, 0, v224, s[12:13]
    v_mfma_f32_16x16x32_bf16 v[164:167], a[64:67], a[228:231], v[164:167]
    v_cndmask_b32 v243, 0, v224, s[14:15]
    v_cmp_eq_i32 s[8:9], 8, v226
    v_mfma_f32_16x16x32_bf16 v[168:171], a[64:67], a[232:235], v[168:171]
    v_cmp_eq_i32 s[10:11], 7, v226
    v_cmp_eq_i32 s[12:13], 6, v226
    v_mfma_f32_16x16x32_bf16 v[168:171], a[68:71], a[248:251], v[168:171]
    v_cmp_eq_i32 s[14:15], 5, v226
    v_cndmask_b32 v236, 0, v228, s[8:9]
    v_mfma_f32_16x16x32_bf16 v[172:175], a[68:71], a[252:255], v[172:175]
    v_cndmask_b32 v237, 0, v228, s[10:11]
    v_cndmask_b32 v238, 0, v228, s[12:13]
    v_mfma_f32_16x16x32_bf16 v[172:175], a[64:67], a[236:239], v[172:175]
    v_cndmask_b32 v239, 0, v228, s[14:15]
    v_cndmask_b32 v244, 0, v225, s[8:9]
    s_waitcnt lgkmcnt(0)
    v_mfma_f32_16x16x32_bf16 v[188:191], a[72:75], a[172:175], v[188:191]
    ds_read_b128 a[64:67], v20 offset:59392
    v_cndmask_b32 v245, 0, v225, s[10:11]
    v_mfma_f32_16x16x32_bf16 v[188:191], a[76:79], a[188:191], v[188:191]
    ds_read_b128 a[68:71], v21 offset:59392
    v_cndmask_b32 v246, 0, v225, s[12:13]
    v_mfma_f32_16x16x32_bf16 v[184:187], a[76:79], a[184:187], v[184:187]
    v_cndmask_b32 v247, 0, v225, s[14:15]
    s_lshl_b32 s65, s3, 13
    v_mfma_f32_16x16x32_bf16 v[184:187], a[72:75], a[168:171], v[184:187]
    s_add_u32 s23, s65, 98304
    v_and_b32 v229, 7, v0
    v_mfma_f32_16x16x32_bf16 v[180:183], a[72:75], a[164:167], v[180:183]
    v_xor_b32 v19, v18, v229
    v_lshlrev_b32 v19, 4, v19
    v_mfma_f32_16x16x32_bf16 v[180:183], a[76:79], a[180:183], v[180:183]
    v_lshl_add_u32 v19, v27, 6, v19
    v_add_u32 v6, s23, v19
    v_mfma_f32_16x16x32_bf16 v[176:179], a[76:79], a[176:179], v[176:179]
    v_xor_b32 v7, 64, v6
    v_lshrrev_b32 v230, 3, v0
    v_mfma_f32_16x16x32_bf16 v[176:179], a[72:75], a[160:163], v[176:179]
    v_xor_b32 v19, v230, v229
    v_lshlrev_b32 v19, 4, v19
    v_mfma_f32_16x16x32_bf16 v[176:179], a[80:83], a[192:195], v[176:179]
    ds_read_b128 a[72:75], v22 offset:10240
    v_lshl_add_u32 v8, v230, 7, v19
    v_mfma_f32_16x16x32_bf16 v[176:179], a[84:87], a[208:211], v[176:179]
    ds_read_b128 a[76:79], v23 offset:10240
    v_add_u32 v8, s23, v8
    v_mfma_f32_16x16x32_bf16 v[180:183], a[84:87], a[212:215], v[180:183]
    v_and_b32 v19, 3, v230
    v_lshrrev_b32 v24, 5, v0
    v_mfma_f32_16x16x32_bf16 v[180:183], a[80:83], a[196:199], v[180:183]
    v_lshl_add_u32 v19, v24, 4, v19
    v_lshlrev_b32 v19, 12, v19
    v_mfma_f32_16x16x32_bf16 v[184:187], a[80:83], a[200:203], v[184:187]
    v_lshl_add_u32 v24, v229, 4, v19
    v_add_u32 v25, 0x20000, v24
    v_mfma_f32_16x16x32_bf16 v[184:187], a[84:87], a[216:219], v[184:187]
    s_lshl_b32 s20, s72, 18
    s_lshl_b32 s65, s79, 7
    v_mfma_f32_16x16x32_bf16 v[188:191], a[84:87], a[220:223], v[188:191]
    s_add_u32 s20, s20, s65
    v_mov_b32 v19, 1
    v_mfma_f32_16x16x32_bf16 v[188:191], a[80:83], a[204:207], v[188:191]
    s_mov_b32 s8, 0x10001
    s_mov_b32 s9, 1
    s_waitcnt lgkmcnt(0)
    v_mfma_f32_16x16x32_bf16 v[188:191], a[64:67], v[76:79], v[188:191]
    ds_read_b128 a[80:83], v22 offset:26624
    v_lshlrev_b32 v229, 3, v0
    v_mfma_f32_16x16x32_bf16 v[188:191], a[68:71], v[92:95], v[188:191]
    ds_read_b128 a[84:87], v23 offset:26624
    v_cndmask_b32 v29, v28, v229, s[8:9]
    v_mfma_f32_16x16x32_bf16 v[184:187], a[68:71], v[88:91], v[184:187]
    v_mfma_f32_16x16x32_bf16 v[184:187], a[64:67], v[72:75], v[184:187]
    v_mfma_f32_16x16x32_bf16 v[180:183], a[64:67], v[68:71], v[180:183]
    v_mfma_f32_16x16x32_bf16 v[180:183], a[68:71], v[84:87], v[180:183]
    v_mfma_f32_16x16x32_bf16 v[176:179], a[68:71], v[80:83], v[176:179]
    v_mfma_f32_16x16x32_bf16 v[176:179], a[64:67], v[64:67], v[176:179]
    v_mfma_f32_16x16x32_bf16 v[176:179], a[72:75], v[32:35], v[176:179]
    ds_read_b128 a[64:67], v20 offset:28672
    s_xor_b32 s21, s76, 16
    v_mfma_f32_16x16x32_bf16 v[176:179], a[76:79], v[48:51], v[176:179]
    ds_read_b128 a[68:71], v21 offset:28672
    s_lshl_b32 s21, s21, 12
    v_mfma_f32_16x16x32_bf16 v[180:183], a[76:79], v[52:55], v[180:183]
    s_add_u32 s21, s21, 41943040
    v_cvt_pk_bf16_f32 v160, v160, v161
    v_mfma_f32_16x16x32_bf16 v[180:183], a[72:75], v[36:39], v[180:183]
    v_cvt_pk_bf16_f32 v161, v162, v163
    v_cvt_pk_bf16_f32 v162, v164, v165
    v_mfma_f32_16x16x32_bf16 v[184:187], a[72:75], v[40:43], v[184:187]
    v_cvt_pk_bf16_f32 v163, v166, v167
    v_mfma_f32_16x16x32_bf16 v[184:187], a[76:79], v[56:59], v[184:187]
    buffer_store_dwordx4 v[160:163], v1, s[4:7], s21 offen offset:0 sc1
    v_mfma_f32_16x16x32_bf16 v[188:191], a[76:79], v[60:63], v[188:191]
    v_cvt_pk_bf16_f32 v168, v168, v169
    v_cvt_pk_bf16_f32 v169, v170, v171
    v_mfma_f32_16x16x32_bf16 v[188:191], a[72:75], v[44:47], v[188:191]
    v_cvt_pk_bf16_f32 v170, v172, v173
    v_cvt_pk_bf16_f32 v171, v174, v175
    s_waitcnt lgkmcnt(0)
    v_mfma_f32_16x16x32_bf16 v[188:191], a[80:83], a[236:239], v[188:191]
    ds_read_b128 a[72:75], v20 offset:45056
    v_mfma_f32_16x16x32_bf16 v[188:191], a[84:87], a[252:255], v[188:191]
    ds_read_b128 a[76:79], v21 offset:45056
    v_mfma_f32_16x16x32_bf16 v[184:187], a[84:87], a[248:251], v[184:187]
    buffer_store_dwordx4 v[168:171], v1, s[4:7], s21 offen offset:1024 sc1
    v_mfma_f32_16x16x32_bf16 v[184:187], a[80:83], a[232:235], v[184:187]
    v_mfma_f32_16x16x32_bf16 v[180:183], a[80:83], a[228:231], v[180:183]
    v_mfma_f32_16x16x32_bf16 v[180:183], a[84:87], a[244:247], v[180:183]
    v_mfma_f32_16x16x32_bf16 v[176:179], a[84:87], a[240:243], v[176:179]
    v_mfma_f32_16x16x32_bf16 v[176:179], a[80:83], a[224:227], v[176:179]
    v_mfma_f32_16x16x32_bf16 v[192:195], a[64:67], a[160:163], v[192:195]
    ds_read_b128 a[80:83], v20 offset:61440
    v_mfma_f32_16x16x32_bf16 v[192:195], a[68:71], a[176:179], v[192:195]
    ds_read_b128 a[84:87], v21 offset:61440
    v_mfma_f32_16x16x32_bf16 v[196:199], a[68:71], a[180:183], v[196:199]
    v_mfma_f32_16x16x32_bf16 v[196:199], a[64:67], a[164:167], v[196:199]
    v_mfma_f32_16x16x32_bf16 v[200:203], a[64:67], a[168:171], v[200:203]
    v_mfma_f32_16x16x32_bf16 v[200:203], a[68:71], a[184:187], v[200:203]
    v_mfma_f32_16x16x32_bf16 v[204:207], a[68:71], a[188:191], v[204:207]
    s_xor_b32 s65, s77, 4096
    s_waitcnt vmcnt(2)
    v_mfma_f32_16x16x32_bf16 v[204:207], a[64:67], a[172:175], v[204:207]
    buffer_store_dword v19, v28, s[4:7], s65 offen offset:128 sc1
    s_waitcnt lgkmcnt(0)
    v_mfma_f32_16x16x32_bf16 v[204:207], a[72:75], a[204:207], v[204:207]
    ds_read_b128 a[64:67], v22 offset:12288
    v_mfma_f32_16x16x32_bf16 v[204:207], a[76:79], a[220:223], v[204:207]
    ds_read_b128 a[68:71], v23 offset:12288
    v_mfma_f32_16x16x32_bf16 v[200:203], a[76:79], a[216:219], v[200:203]
    v_mfma_f32_16x16x32_bf16 v[200:203], a[72:75], a[200:203], v[200:203]
    v_mfma_f32_16x16x32_bf16 v[196:199], a[72:75], a[196:199], v[196:199]
    v_mfma_f32_16x16x32_bf16 v[196:199], a[76:79], a[212:215], v[196:199]
    v_cvt_pk_bf16_f32 v176, v176, v177
    v_cvt_pk_bf16_f32 v177, v178, v179
    v_mfma_f32_16x16x32_bf16 v[192:195], a[76:79], a[208:211], v[192:195]
    v_cvt_pk_bf16_f32 v178, v180, v181
    v_cvt_pk_bf16_f32 v179, v182, v183
    v_mfma_f32_16x16x32_bf16 v[192:195], a[72:75], a[192:195], v[192:195]
    buffer_store_dwordx4 v[176:179], v1, s[4:7], s21 offen offset:2048 sc1
    v_mfma_f32_16x16x32_bf16 v[192:195], a[80:83], v[64:67], v[192:195]
    ds_read_b128 a[72:75], v22 offset:28672
    v_cvt_pk_bf16_f32 v184, v184, v185
    v_mfma_f32_16x16x32_bf16 v[192:195], a[84:87], v[80:83], v[192:195]
    ds_read_b128 a[76:79], v23 offset:28672
    v_cvt_pk_bf16_f32 v185, v186, v187
    v_mfma_f32_16x16x32_bf16 v[196:199], a[84:87], v[84:87], v[196:199]
    v_cvt_pk_bf16_f32 v186, v188, v189
    v_cvt_pk_bf16_f32 v187, v190, v191
    v_mfma_f32_16x16x32_bf16 v[196:199], a[80:83], v[68:71], v[196:199]
    buffer_store_dwordx4 v[184:187], v1, s[4:7], s21 offen offset:3072 sc1
    v_mfma_f32_16x16x32_bf16 v[200:203], a[80:83], v[72:75], v[200:203]
    v_mfma_f32_16x16x32_bf16 v[200:203], a[84:87], v[88:91], v[200:203]
    v_mfma_f32_16x16x32_bf16 v[204:207], a[84:87], v[92:95], v[204:207]
    v_mfma_f32_16x16x32_bf16 v[204:207], a[80:83], v[76:79], v[204:207]
    s_waitcnt lgkmcnt(0)
    v_mfma_f32_16x16x32_bf16 v[204:207], a[64:67], v[44:47], v[204:207]
    ds_read_b128 a[80:83], v20 offset:30720
    v_mfma_f32_16x16x32_bf16 v[204:207], a[68:71], v[60:63], v[204:207]
    ds_read_b128 a[84:87], v21 offset:30720
    v_mfma_f32_16x16x32_bf16 v[200:203], a[68:71], v[56:59], v[200:203]
    v_mfma_f32_16x16x32_bf16 v[200:203], a[64:67], v[40:43], v[200:203]
    v_mfma_f32_16x16x32_bf16 v[196:199], a[64:67], v[36:39], v[196:199]
    v_mfma_f32_16x16x32_bf16 v[196:199], a[68:71], v[52:55], v[196:199]
    v_mfma_f32_16x16x32_bf16 v[192:195], a[68:71], v[48:51], v[192:195]
    v_mfma_f32_16x16x32_bf16 v[192:195], a[64:67], v[32:35], v[192:195]
    v_mfma_f32_16x16x32_bf16 v[192:195], a[72:75], a[224:227], v[192:195]
    ds_read_b128 a[64:67], v20 offset:47104
    v_mfma_f32_16x16x32_bf16 v[192:195], a[76:79], a[240:243], v[192:195]
    ds_read_b128 a[68:71], v21 offset:47104
    v_mfma_f32_16x16x32_bf16 v[196:199], a[76:79], a[244:247], v[196:199]
    v_mfma_f32_16x16x32_bf16 v[196:199], a[72:75], a[228:231], v[196:199]
    v_mfma_f32_16x16x32_bf16 v[200:203], a[72:75], a[232:235], v[200:203]
    v_mfma_f32_16x16x32_bf16 v[200:203], a[76:79], a[248:251], v[200:203]
    v_mfma_f32_16x16x32_bf16 v[204:207], a[76:79], a[252:255], v[204:207]
    v_mfma_f32_16x16x32_bf16 v[204:207], a[72:75], a[236:239], v[204:207]
    s_waitcnt lgkmcnt(0)
    v_mfma_f32_16x16x32_bf16 v[220:223], a[80:83], a[172:175], v[220:223]
    ds_read_b128 a[72:75], v20 offset:63488
    v_mfma_f32_16x16x32_bf16 v[220:223], a[84:87], a[188:191], v[220:223]
    ds_read_b128 a[76:79], v21 offset:63488
    v_mfma_f32_16x16x32_bf16 v[216:219], a[84:87], a[184:187], v[216:219]
    v_mfma_f32_16x16x32_bf16 v[216:219], a[80:83], a[168:171], v[216:219]
    v_mfma_f32_16x16x32_bf16 v[212:215], a[80:83], a[164:167], v[212:215]
    v_mfma_f32_16x16x32_bf16 v[212:215], a[84:87], a[180:183], v[212:215]
    v_mfma_f32_16x16x32_bf16 v[208:211], a[84:87], a[176:179], v[208:211]
    s_xor_b32 s21, s76, 24
    s_lshl_b32 s21, s21, 12
    v_mfma_f32_16x16x32_bf16 v[208:211], a[80:83], a[160:163], v[208:211]
    s_add_u32 s21, s21, 46137344
    v_cvt_pk_bf16_f32 v192, v192, v193
    v_mfma_f32_16x16x32_bf16 v[208:211], a[64:67], a[192:195], v[208:211]
    ds_read_b128 a[80:83], v22 offset:14336
    v_cvt_pk_bf16_f32 v193, v194, v195
    v_mfma_f32_16x16x32_bf16 v[208:211], a[68:71], a[208:211], v[208:211]
    ds_read_b128 a[84:87], v23 offset:14336
    v_cvt_pk_bf16_f32 v194, v196, v197
    v_mfma_f32_16x16x32_bf16 v[212:215], a[68:71], a[212:215], v[212:215]
    v_cvt_pk_bf16_f32 v195, v198, v199
    v_mfma_f32_16x16x32_bf16 v[212:215], a[64:67], a[196:199], v[212:215]
    buffer_store_dwordx4 v[192:195], v1, s[4:7], s21 offen offset:0 sc1
    v_mfma_f32_16x16x32_bf16 v[216:219], a[64:67], a[200:203], v[216:219]
    v_cvt_pk_bf16_f32 v200, v200, v201
    v_cvt_pk_bf16_f32 v201, v202, v203
    v_mfma_f32_16x16x32_bf16 v[216:219], a[68:71], a[216:219], v[216:219]
    v_cvt_pk_bf16_f32 v202, v204, v205
    v_cvt_pk_bf16_f32 v203, v206, v207
    v_mfma_f32_16x16x32_bf16 v[220:223], a[68:71], a[220:223], v[220:223]
    buffer_store_dwordx4 v[200:203], v1, s[4:7], s21 offen offset:1024 sc1
    v_mfma_f32_16x16x32_bf16 v[220:223], a[64:67], a[204:207], v[220:223]
    s_waitcnt lgkmcnt(0)
    v_mfma_f32_16x16x32_bf16 v[220:223], a[72:75], v[76:79], v[220:223]
    ds_read_b128 a[64:67], v22 offset:30720
    v_mfma_f32_16x16x32_bf16 v[220:223], a[76:79], v[92:95], v[220:223]
    ds_read_b128 a[68:71], v23 offset:30720
    v_mfma_f32_16x16x32_bf16 v[216:219], a[76:79], v[88:91], v[216:219]
    v_mfma_f32_16x16x32_bf16 v[216:219], a[72:75], v[72:75], v[216:219]
    v_mfma_f32_16x16x32_bf16 v[212:215], a[72:75], v[68:71], v[212:215]
    v_mfma_f32_16x16x32_bf16 v[212:215], a[76:79], v[84:87], v[212:215]
    v_mfma_f32_16x16x32_bf16 v[208:211], a[76:79], v[80:83], v[208:211]
    v_mfma_f32_16x16x32_bf16 v[208:211], a[72:75], v[64:67], v[208:211]
    v_mfma_f32_16x16x32_bf16 v[208:211], a[80:83], v[32:35], v[208:211]
    ds_read_b128 a[72:75], v20 offset:16384
    v_mfma_f32_16x16x32_bf16 v[208:211], a[84:87], v[48:51], v[208:211]
    ds_read_b128 a[76:79], v21 offset:16384
    v_mfma_f32_16x16x32_bf16 v[212:215], a[84:87], v[52:55], v[212:215]
    s_xor_b32 s65, s77, 8192
    s_waitcnt vmcnt(2)
    v_mfma_f32_16x16x32_bf16 v[212:215], a[80:83], v[36:39], v[212:215]
    buffer_store_dword v19, v28, s[4:7], s65 offen offset:256 sc1
    v_mfma_f32_16x16x32_bf16 v[216:219], a[80:83], v[40:43], v[216:219]
    v_mfma_f32_16x16x32_bf16 v[216:219], a[84:87], v[56:59], v[216:219]
    v_mfma_f32_16x16x32_bf16 v[220:223], a[84:87], v[60:63], v[220:223]
    v_mfma_f32_16x16x32_bf16 v[220:223], a[80:83], v[44:47], v[220:223]
    s_waitcnt lgkmcnt(0)
    v_mfma_f32_16x16x32_bf16 v[220:223], a[64:67], a[236:239], v[220:223]
    ds_read_b128 a[80:83], v20 offset:18432
    v_mfma_f32_16x16x32_bf16 v[220:223], a[68:71], a[252:255], v[220:223]
    ds_read_b128 a[84:87], v21 offset:18432
    v_mfma_f32_16x16x32_bf16 v[216:219], a[68:71], a[248:251], v[216:219]
    v_mfma_f32_16x16x32_bf16 v[216:219], a[64:67], a[232:235], v[216:219]
    v_mfma_f32_16x16x32_bf16 v[212:215], a[64:67], a[228:231], v[212:215]
    v_mfma_f32_16x16x32_bf16 v[212:215], a[68:71], a[244:247], v[212:215]
    v_mfma_f32_16x16x32_bf16 v[208:211], a[68:71], a[240:243], v[208:211]
    v_mfma_f32_16x16x32_bf16 v[208:211], a[64:67], a[224:227], v[208:211]
    v_mfma_f32_16x16x32_bf16 v[96:99], a[72:75], a[160:163], v[96:99]
    ds_read_b128 a[64:67], v20 offset:32768
    v_mfma_f32_16x16x32_bf16 v[96:99], a[76:79], a[176:179], v[96:99]
    ds_read_b128 a[68:71], v21 offset:32768
    v_mfma_f32_16x16x32_bf16 v[100:103], a[76:79], a[180:183], v[100:103]
    v_mfma_f32_16x16x32_bf16 v[100:103], a[72:75], a[164:167], v[100:103]
    v_mfma_f32_16x16x32_bf16 v[104:107], a[72:75], a[168:171], v[104:107]
    v_mfma_f32_16x16x32_bf16 v[104:107], a[76:79], a[184:187], v[104:107]
    v_mfma_f32_16x16x32_bf16 v[108:111], a[76:79], a[188:191], v[108:111]
    v_cvt_pk_bf16_f32 v208, v208, v209
    v_cvt_pk_bf16_f32 v209, v210, v211
    v_mfma_f32_16x16x32_bf16 v[108:111], a[72:75], a[172:175], v[108:111]
    v_cvt_pk_bf16_f32 v210, v212, v213
    v_cvt_pk_bf16_f32 v211, v214, v215
    s_waitcnt lgkmcnt(0)
    v_mfma_f32_16x16x32_bf16 v[124:127], a[80:83], a[172:175], v[124:127]
    ds_read_b128 a[72:75], v20 offset:34816
    v_mfma_f32_16x16x32_bf16 v[124:127], a[84:87], a[188:191], v[124:127]
    ds_read_b128 a[76:79], v21 offset:34816
    v_mfma_f32_16x16x32_bf16 v[120:123], a[84:87], a[184:187], v[120:123]
    buffer_store_dwordx4 v[208:211], v1, s[4:7], s21 offen offset:2048 sc1
    v_mfma_f32_16x16x32_bf16 v[120:123], a[80:83], a[168:171], v[120:123]
    v_cvt_pk_bf16_f32 v216, v216, v217
    v_cvt_pk_bf16_f32 v217, v218, v219
    v_mfma_f32_16x16x32_bf16 v[116:119], a[80:83], a[164:167], v[116:119]
    v_cvt_pk_bf16_f32 v218, v220, v221
    v_cvt_pk_bf16_f32 v219, v222, v223
    v_mfma_f32_16x16x32_bf16 v[116:119], a[84:87], a[180:183], v[116:119]
    buffer_store_dwordx4 v[216:219], v1, s[4:7], s21 offen offset:3072 sc1
    v_mfma_f32_16x16x32_bf16 v[112:115], a[84:87], a[176:179], v[112:115]
    v_mfma_f32_16x16x32_bf16 v[112:115], a[80:83], a[160:163], v[112:115]
    v_mfma_f32_16x16x32_bf16 v[96:99], a[64:67], a[192:195], v[96:99]
    ds_read_b128 a[80:83], v20 offset:49152
    v_mfma_f32_16x16x32_bf16 v[96:99], a[68:71], a[208:211], v[96:99]
    ds_read_b128 a[84:87], v21 offset:49152
    v_mfma_f32_16x16x32_bf16 v[100:103], a[68:71], a[212:215], v[100:103]
    v_mfma_f32_16x16x32_bf16 v[100:103], a[64:67], a[196:199], v[100:103]
    v_mfma_f32_16x16x32_bf16 v[104:107], a[64:67], a[200:203], v[104:107]
    v_mfma_f32_16x16x32_bf16 v[104:107], a[68:71], a[216:219], v[104:107]
    v_mfma_f32_16x16x32_bf16 v[108:111], a[68:71], a[220:223], v[108:111]
    v_mfma_f32_16x16x32_bf16 v[108:111], a[64:67], a[204:207], v[108:111]
    s_waitcnt lgkmcnt(0)
    v_mfma_f32_16x16x32_bf16 v[124:127], a[72:75], a[204:207], v[124:127]
    ds_read_b128 a[64:67], v20 offset:51200
    v_mfma_f32_16x16x32_bf16 v[124:127], a[76:79], a[220:223], v[124:127]
    ds_read_b128 a[68:71], v21 offset:51200
    v_mfma_f32_16x16x32_bf16 v[120:123], a[76:79], a[216:219], v[120:123]
    v_mfma_f32_16x16x32_bf16 v[120:123], a[72:75], a[200:203], v[120:123]
    v_mfma_f32_16x16x32_bf16 v[116:119], a[72:75], a[196:199], v[116:119]
    v_mfma_f32_16x16x32_bf16 v[116:119], a[76:79], a[212:215], v[116:119]
    v_mov_b32 v248, 0
    v_mfma_f32_16x16x32_bf16 v[112:115], a[76:79], a[208:211], v[112:115]
    buffer_atomic_add v248, v29, s[4:7], s77 offen offset:128 sc0 sc1
    v_mfma_f32_16x16x32_bf16 v[112:115], a[72:75], a[192:195], v[112:115]
    v_mfma_f32_16x16x32_bf16 v[96:99], a[80:83], v[64:67], v[96:99]
    ds_read_b128 a[72:75], v22 offset:0
    v_mfma_f32_16x16x32_bf16 v[96:99], a[84:87], v[80:83], v[96:99]
    ds_read_b128 a[76:79], v23 offset:0
    v_mfma_f32_16x16x32_bf16 v[100:103], a[84:87], v[84:87], v[100:103]
    v_mfma_f32_16x16x32_bf16 v[100:103], a[80:83], v[68:71], v[100:103]
    v_mfma_f32_16x16x32_bf16 v[104:107], a[80:83], v[72:75], v[104:107]
    v_mfma_f32_16x16x32_bf16 v[104:107], a[84:87], v[88:91], v[104:107]
    v_mfma_f32_16x16x32_bf16 v[108:111], a[84:87], v[92:95], v[108:111]
    v_mfma_f32_16x16x32_bf16 v[108:111], a[80:83], v[76:79], v[108:111]
    s_waitcnt lgkmcnt(0)
    v_mfma_f32_16x16x32_bf16 v[124:127], a[64:67], v[76:79], v[124:127]
    ds_read_b128 a[80:83], v22 offset:2048
    v_mfma_f32_16x16x32_bf16 v[124:127], a[68:71], v[92:95], v[124:127]
    ds_read_b128 a[84:87], v23 offset:2048
    v_mfma_f32_16x16x32_bf16 v[120:123], a[68:71], v[88:91], v[120:123]
    v_mfma_f32_16x16x32_bf16 v[120:123], a[64:67], v[72:75], v[120:123]
    v_mfma_f32_16x16x32_bf16 v[116:119], a[64:67], v[68:71], v[116:119]
    v_mfma_f32_16x16x32_bf16 v[116:119], a[68:71], v[84:87], v[116:119]
    v_mfma_f32_16x16x32_bf16 v[112:115], a[68:71], v[80:83], v[112:115]
    v_mfma_f32_16x16x32_bf16 v[112:115], a[64:67], v[64:67], v[112:115]
    v_mfma_f32_16x16x32_bf16 v[96:99], a[72:75], v[32:35], v[96:99]
    ds_read_b128 a[64:67], v22 offset:16384
    v_mfma_f32_16x16x32_bf16 v[96:99], a[76:79], v[48:51], v[96:99]
    ds_read_b128 a[68:71], v23 offset:16384
    v_mfma_f32_16x16x32_bf16 v[100:103], a[76:79], v[52:55], v[100:103]
    v_mfma_f32_16x16x32_bf16 v[100:103], a[72:75], v[36:39], v[100:103]
    v_mfma_f32_16x16x32_bf16 v[104:107], a[72:75], v[40:43], v[104:107]
    v_mfma_f32_16x16x32_bf16 v[104:107], a[76:79], v[56:59], v[104:107]
    v_mfma_f32_16x16x32_bf16 v[108:111], a[76:79], v[60:63], v[108:111]
    s_xor_b32 s65, s77, 12288
    s_waitcnt vmcnt(1)
    v_mfma_f32_16x16x32_bf16 v[108:111], a[72:75], v[44:47], v[108:111]
    buffer_store_dword v19, v28, s[4:7], s65 offen offset:384 sc1
    s_waitcnt vmcnt(1)
    s_waitcnt lgkmcnt(0)
    v_mfma_f32_16x16x32_bf16 v[124:127], a[80:83], v[44:47], v[124:127]
    ds_read_b128 a[72:75], v22 offset:18432
    v_cmp_ne_u32 vcc, 1, v248
    s_mov_b32 s10, vcc_hi
    s_and_b64 vcc, vcc, 0x10001
    s_cbranch_vccnz L_far9
L_back9:
    v_mfma_f32_16x16x32_bf16 v[124:127], a[84:87], v[60:63], v[124:127]
    ds_read_b128 a[76:79], v23 offset:18432
    s_lshl_b32 s22, s76, 12
    v_mfma_f32_16x16x32_bf16 v[120:123], a[84:87], v[56:59], v[120:123]
    s_add_u32 s22, s22, 37748736
    buffer_load_dwordx4 v[132:135], v1, s[4:7], s22 offen offset:0 sc1
    v_mfma_f32_16x16x32_bf16 v[120:123], a[80:83], v[40:43], v[120:123]
    buffer_load_dwordx4 v[140:143], v1, s[4:7], s22 offen offset:1024 sc1
    v_mfma_f32_16x16x32_bf16 v[116:119], a[80:83], v[36:39], v[116:119]
    buffer_load_dwordx4 v[148:151], v1, s[4:7], s22 offen offset:2048 sc1
    v_mfma_f32_16x16x32_bf16 v[116:119], a[84:87], v[52:55], v[116:119]
    buffer_load_dwordx4 v[156:159], v1, s[4:7], s22 offen offset:3072 sc1
    s_lshl_b32 s22, s76, 12
    v_mfma_f32_16x16x32_bf16 v[112:115], a[84:87], v[48:51], v[112:115]
    s_add_u32 s22, s22, 41943040
    buffer_load_dwordx4 v[164:167], v1, s[4:7], s22 offen offset:0 sc1
    v_mfma_f32_16x16x32_bf16 v[112:115], a[80:83], v[32:35], v[112:115]
    buffer_load_dwordx4 v[172:175], v1, s[4:7], s22 offen offset:1024 sc1
    v_mfma_f32_16x16x32_bf16 v[96:99], a[64:67], a[224:227], v[96:99]
    buffer_load_dwordx4 v[180:183], v1, s[4:7], s22 offen offset:2048 sc1
    v_mfma_f32_16x16x32_bf16 v[96:99], a[68:71], a[240:243], v[96:99]
    buffer_load_dwordx4 v[188:191], v1, s[4:7], s22 offen offset:3072 sc1
    v_mfma_f32_16x16x32_bf16 v[100:103], a[68:71], a[244:247], v[100:103]
    v_mov_b32 v249, 0
L_pad12:
    s_cbranch_execz L_warm_ret
    v_mfma_f32_16x16x32_bf16 v[100:103], a[64:67], a[228:231], v[100:103]
    s_bitcmp0_b32 s10, 0
    s_cbranch_scc0 L_x3a
    s_lshl_b32 s22, s76, 12
    s_add_u32 s22, s22, 46137344
    buffer_load_dwordx4 v[196:199], v1, s[4:7], s22 offen offset:0 sc1
    buffer_load_dwordx4 v[212:215], v1, s[4:7], s22 offen offset:2048 sc1
    buffer_load_dwordx4 v[204:207], v1, s[4:7], s22 offen offset:1024 sc1
    buffer_load_dwordx4 v[220:223], v1, s[4:7], s22 offen offset:3072 sc1
    s_branch L_x3b
L_x3a:
    buffer_atomic_add v249, v28, s[4:7], s77 offen offset:384 sc0 sc1
L_x3b:
    v_mfma_f32_16x16x32_bf16 v[104:107], a[64:67], a[232:235], v[104:107]
    v_mfma_f32_16x16x32_bf16 v[104:107], a[68:71], a[248:251], v[104:107]
    v_mfma_f32_16x16x32_bf16 v[108:111], a[68:71], a[252:255], v[108:111]
    v_mfma_f32_16x16x32_bf16 v[108:111], a[64:67], a[236:239], v[108:111]
    s_waitcnt lgkmcnt(0)
    v_mfma_f32_16x16x32_bf16 v[124:127], a[72:75], a[236:239], v[124:127]
    v_mfma_f32_16x16x32_bf16 v[124:127], a[76:79], a[252:255], v[124:127]
    v_mfma_f32_16x16x32_bf16 v[120:123], a[76:79], a[248:251], v[120:123]
    v_mfma_f32_16x16x32_bf16 v[120:123], a[72:75], a[232:235], v[120:123]
    v_mfma_f32_16x16x32_bf16 v[116:119], a[72:75], a[228:231], v[116:119]
    v_mfma_f32_16x16x32_bf16 v[116:119], a[76:79], a[244:247], v[116:119]
    v_mfma_f32_16x16x32_bf16 v[112:115], a[76:79], a[240:243], v[112:115]
    v_mfma_f32_16x16x32_bf16 v[112:115], a[72:75], a[224:227], v[112:115]
    v_mfma_f32_16x16x32_bf16 v[96:99], v[232:235], a[0:3], v[96:99]
    v_mfma_f32_16x16x32_bf16 v[100:103], v[232:235], a[4:7], v[100:103]
    v_mfma_f32_16x16x32_bf16 v[104:107], v[232:235], a[8:11], v[104:107]
    v_mfma_f32_16x16x32_bf16 v[108:111], v[232:235], a[12:15], v[108:111]
    v_mfma_f32_16x16x32_bf16 v[112:115], v[236:239], a[0:3], v[112:115]
    v_mfma_f32_16x16x32_bf16 v[116:119], v[236:239], a[4:7], v[116:119]
    v_mfma_f32_16x16x32_bf16 v[120:123], v[236:239], a[8:11], v[120:123]
    v_mfma_f32_16x16x32_bf16 v[124:127], v[236:239], a[12:15], v[124:127]
    v_mfma_f32_16x16x32_bf16 v[96:99], v[240:243], a[16:19], v[96:99]
    v_mfma_f32_16x16x32_bf16 v[100:103], v[240:243], a[20:23], v[100:103]
    v_mfma_f32_16x16x32_bf16 v[104:107], v[240:243], a[24:27], v[104:107]
    v_mfma_f32_16x16x32_bf16 v[108:111], v[240:243], a[28:31], v[108:111]
    v_mfma_f32_16x16x32_bf16 v[112:115], v[244:247], a[16:19], v[112:115]
    v_mfma_f32_16x16x32_bf16 v[116:119], v[244:247], a[20:23], v[116:119]
    v_mfma_f32_16x16x32_bf16 v[120:123], v[244:247], a[24:27], v[120:123]
    v_mfma_f32_16x16x32_bf16 v[124:127], v[244:247], a[28:31], v[124:127]
    s_nop 7
    s_waitcnt vmcnt(8)
    v_lshlrev_b32 v224, 16, v132
    v_and_b32 v225, 0xffff0000, v132
    v_lshlrev_b32 v226, 16, v133
    v_and_b32 v227, 0xffff0000, v133
    v_lshlrev_b32 v228, 16, v134
    v_and_b32 v229, 0xffff0000, v134
    v_lshlrev_b32 v230, 16, v135
    v_and_b32 v231, 0xffff0000, v135
    v_pk_add_f32 v[96:97], v[96:97], v[224:225]
    v_pk_add_f32 v[98:99], v[98:99], v[226:227]
    v_pk_add_f32 v[100:101], v[100:101], v[228:229]
    v_pk_add_f32 v[102:103], v[102:103], v[230:231]
    s_waitcnt vmcnt(7)
    v_lshlrev_b32 v224, 16, v140
    v_and_b32 v225, 0xffff0000, v140
    v_lshlrev_b32 v226, 16, v141
    v_and_b32 v227, 0xffff0000, v141
    v_lshlrev_b32 v228, 16, v142
    v_and_b32 v229, 0xffff0000, v142
    v_lshlrev_b32 v230, 16, v143
    v_and_b32 v231, 0xffff0000, v143
    v_pk_add_f32 v[104:105], v[104:105], v[224:225]
    v_pk_add_f32 v[106:107], v[106:107], v[226:227]
    v_pk_add_f32 v[108:109], v[108:109], v[228:229]
    v_pk_add_f32 v[110:111], v[110:111], v[230:231]
    s_waitcnt vmcnt(6)
    v_lshlrev_b32 v224, 16, v148
    v_and_b32 v225, 0xffff0000, v148
    v_lshlrev_b32 v226, 16, v149
    v_and_b32 v227, 0xffff0000, v149
    v_lshlrev_b32 v228, 16, v150
    v_and_b32 v229, 0xffff0000, v150
    v_lshlrev_b32 v230, 16, v151
    v_and_b32 v231, 0xffff0000, v151
    v_pk_add_f32 v[112:113], v[112:113], v[224:225]
    v_pk_add_f32 v[114:115], v[114:115], v[226:227]
    v_pk_add_f32 v[116:117], v[116:117], v[228:229]
    v_pk_add_f32 v[118:119], v[118:119], v[230:231]
    s_waitcnt vmcnt(5)
    v_lshlrev_b32 v224, 16, v156
    v_and_b32 v225, 0xffff0000, v156
    v_lshlrev_b32 v226, 16, v157
    v_and_b32 v227, 0xffff0000, v157
    v_lshlrev_b32 v228, 16, v158
    v_and_b32 v229, 0xffff0000, v158
    v_lshlrev_b32 v230, 16, v159
    v_and_b32 v231, 0xffff0000, v159
    v_pk_add_f32 v[120:121], v[120:121], v[224:225]
    v_pk_add_f32 v[122:123], v[122:123], v[226:227]
    v_pk_add_f32 v[124:125], v[124:125], v[228:229]
    v_pk_add_f32 v[126:127], v[126:127], v[230:231]
    s_bitcmp0_b32 s10, 0
    s_cbranch_scc1 L_x3c
    s_waitcnt vmcnt(0)
    v_cmp_ne_u32 vcc, 1, v249
    s_and_b64 vcc, vcc, 1
    s_cbranch_vccnz L_far10
L_back10:
    s_lshl_b32 s22, s76, 12
    s_add_u32 s22, s22, 46137344
    buffer_load_dwordx4 v[196:199], v1, s[4:7], s22 offen offset:0 sc1
    buffer_load_dwordx4 v[212:215], v1, s[4:7], s22 offen offset:2048 sc1
    buffer_load_dwordx4 v[204:207], v1, s[4:7], s22 offen offset:1024 sc1
    buffer_load_dwordx4 v[220:223], v1, s[4:7], s22 offen offset:3072 sc1
L_x3c:
    s_waitcnt vmcnt(4)
    v_lshlrev_b32 v224, 16, v164
    v_and_b32 v225, 0xffff0000, v164
    v_lshlrev_b32 v226, 16, v165
    v_and_b32 v227, 0xffff0000, v165
    v_lshlrev_b32 v228, 16, v166
    v_and_b32 v229, 0xffff0000, v166
    v_lshlrev_b32 v230, 16, v167
    v_and_b32 v231, 0xffff0000, v167
    v_pk_add_f32 v[96:97], v[96:97], v[224:225]
    v_pk_add_f32 v[98:99], v[98:99], v[226:227]
    v_pk_add_f32 v[100:101], v[100:101], v[228:229]
    v_pk_add_f32 v[102:103], v[102:103], v[230:231]
    v_lshlrev_b32 v224, 16, v172
    v_and_b32 v225, 0xffff0000, v172
    v_lshlrev_b32 v226, 16, v173
    v_and_b32 v227, 0xffff0000, v173
    v_lshlrev_b32 v228, 16, v174
    v_and_b32 v229, 0xffff0000, v174
    v_lshlrev_b32 v230, 16, v175
    v_and_b32 v231, 0xffff0000, v175
    v_pk_add_f32 v[104:105], v[104:105], v[224:225]
    v_pk_add_f32 v[106:107], v[106:107], v[226:227]
    v_pk_add_f32 v[108:109], v[108:109], v[228:229]
    v_pk_add_f32 v[110:111], v[110:111], v[230:231]
    v_lshlrev_b32 v224, 16, v180
    v_and_b32 v225, 0xffff0000, v180
    v_lshlrev_b32 v226, 16, v181
    v_and_b32 v227, 0xffff0000, v181
    v_lshlrev_b32 v228, 16, v182
    v_and_b32 v229, 0xffff0000, v182
    v_lshlrev_b32 v230, 16, v183
    v_and_b32 v231, 0xffff0000, v183
    v_pk_add_f32 v[112:113], v[112:113], v[224:225]
    v_pk_add_f32 v[114:115], v[114:115], v[226:227]
    v_pk_add_f32 v[116:117], v[116:117], v[228:229]
    v_pk_add_f32 v[118:119], v[118:119], v[230:231]
    v_lshlrev_b32 v224, 16, v188
    v_and_b32 v225, 0xffff0000, v188
    v_lshlrev_b32 v226, 16, v189
    v_and_b32 v227, 0xffff0000, v189
    v_lshlrev_b32 v228, 16, v190
    v_and_b32 v229, 0xffff0000, v190
    v_lshlrev_b32 v230, 16, v191
    v_and_b32 v231, 0xffff0000, v191
    v_pk_add_f32 v[120:121], v[120:121], v[224:225]
    v_pk_add_f32 v[122:123], v[122:123], v[226:227]
    v_pk_add_f32 v[124:125], v[124:125], v[228:229]
    v_pk_add_f32 v[126:127], v[126:127], v[230:231]
    s_waitcnt vmcnt(3)
    v_lshlrev_b32 v224, 16, v196
    v_and_b32 v225, 0xffff0000, v196
    v_lshlrev_b32 v226, 16, v197
    v_and_b32 v227, 0xffff0000, v197
    v_lshlrev_b32 v228, 16, v198
    v_and_b32 v229, 0xffff0000, v198
    v_lshlrev_b32 v230, 16, v199
    v_and_b32 v231, 0xffff0000, v199
    v_pk_add_f32 v[96:97], v[96:97], v[224:225]
    v_pk_add_f32 v[98:99], v[98:99], v[226:227]
    v_pk_add_f32 v[100:101], v[100:101], v[228:229]
    v_pk_add_f32 v[102:103], v[102:103], v[230:231]
    s_waitcnt vmcnt(2)
    v_lshlrev_b32 v224, 16, v212
    v_and_b32 v225, 0xffff0000, v212
    v_lshlrev_b32 v226, 16, v213
    v_and_b32 v227, 0xffff0000, v213
    v_lshlrev_b32 v228, 16, v214
    v_and_b32 v229, 0xffff0000, v214
    v_lshlrev_b32 v230, 16, v215
    v_and_b32 v231, 0xffff0000, v215
    v_pk_add_f32 v[112:113], v[112:113], v[224:225]
    v_pk_add_f32 v[114:115], v[114:115], v[226:227]
    v_pk_add_f32 v[116:117], v[116:117], v[228:229]
    v_pk_add_f32 v[118:119], v[118:119], v[230:231]
    ds_write_b128 v6, v[96:99] offset:0
    ds_write_b128 v7, v[112:115] offset:0
    ds_write_b128 v6, v[100:103] offset:2048
    ds_write_b128 v7, v[116:119] offset:2048
    ds_read_b128 v[96:99], v8 offset:0
    ds_read_b128 v[112:115], v8 offset:1024
    ds_read_b128 v[100:103], v8 offset:2048
    ds_read_b128 v[116:119], v8 offset:3072
    s_waitcnt vmcnt(1)
    v_lshlrev_b32 v224, 16, v204
    v_and_b32 v225, 0xffff0000, v204
    v_lshlrev_b32 v226, 16, v205
    v_and_b32 v227, 0xffff0000, v205
    v_lshlrev_b32 v228, 16, v206
    v_and_b32 v229, 0xffff0000, v206
    v_lshlrev_b32 v230, 16, v207
    v_and_b32 v231, 0xffff0000, v207
    v_pk_add_f32 v[104:105], v[104:105], v[224:225]
    v_pk_add_f32 v[106:107], v[106:107], v[226:227]
    v_pk_add_f32 v[108:109], v[108:109], v[228:229]
    v_pk_add_f32 v[110:111], v[110:111], v[230:231]
    s_waitcnt lgkmcnt(3)
    buffer_store_dwordx4 v[96:99], v24, s[36:39], s20 offen sc1
    s_waitcnt lgkmcnt(2)
    buffer_store_dwordx4 v[112:115], v25, s[36:39], s20 offen sc1
    s_add_u32 s20, s20, 16384
    s_waitcnt lgkmcnt(1)
    buffer_store_dwordx4 v[100:103], v24, s[36:39], s20 offen sc1
    s_waitcnt lgkmcnt(0)
    buffer_store_dwordx4 v[116:119], v25, s[36:39], s20 offen sc1
    s_add_u32 s20, s20, 16384
    s_waitcnt vmcnt(4)
    v_lshlrev_b32 v224, 16, v220
    v_and_b32 v225, 0xffff0000, v220
    v_lshlrev_b32 v226, 16, v221
    v_and_b32 v227, 0xffff0000, v221
    v_lshlrev_b32 v228, 16, v222
    v_and_b32 v229, 0xffff0000, v222
    v_lshlrev_b32 v230, 16, v223
    v_and_b32 v231, 0xffff0000, v223
    v_pk_add_f32 v[120:121], v[120:121], v[224:225]
    v_pk_add_f32 v[122:123], v[122:123], v[226:227]
    v_pk_add_f32 v[124:125], v[124:125], v[228:229]
    v_pk_add_f32 v[126:127], v[126:127], v[230:231]
    ds_write_b128 v6, v[104:107] offset:4096
    ds_write_b128 v7, v[120:123] offset:4096
    ds_write_b128 v6, v[108:111] offset:6144
    ds_write_b128 v7, v[124:127] offset:6144
    ds_read_b128 v[104:107], v8 offset:4096
    ds_read_b128 v[120:123], v8 offset:5120
    ds_read_b128 v[108:111], v8 offset:6144
    ds_read_b128 v[124:127], v8 offset:7168
    s_waitcnt lgkmcnt(3)
    buffer_store_dwordx4 v[104:107], v24, s[36:39], s20 offen sc1
    s_waitcnt lgkmcnt(2)
    buffer_store_dwordx4 v[120:123], v25, s[36:39], s20 offen sc1
    s_add_u32 s20, s20, 16384
    s_waitcnt lgkmcnt(1)
    buffer_store_dwordx4 v[108:111], v24, s[36:39], s20 offen sc1
    s_waitcnt lgkmcnt(0)
    buffer_store_dwordx4 v[124:127], v25, s[36:39], s20 offen sc1
    s_add_u32 s20, s20, 16384
    s_endpgm
L_far1:
    s_mov_b32 s71, 2097152
L_fp1:
    buffer_load_dword v31, v29, s[40:43], 0 offen sc1
    s_sub_u32 s71, s71, 1
    s_waitcnt vmcnt(0)
    s_cbranch_scc1 L_back1
    v_cmp_ne_u32 vcc, 1, v31
    s_cbranch_vccnz L_fp1
    s_branch L_back1
L_far3:
    s_mov_b32 s71, 2097152
L_fp3:
    buffer_load_dword v22, v26, s[4:7], 0 offen sc1
    s_sub_u32 s71, s71, 1
    s_waitcnt vmcnt(0)
    s_cbranch_scc1 L_back3
    v_cmp_ne_u32 vcc, 1, v22
    s_cbranch_vccnz L_fp3
    s_branch L_back3
L_far4:
    s_mov_b32 s71, 2097152
L_fp4:
    v_mov_b32 v31, 0
    buffer_atomic_add v31, v30, s[4:7], s74 offen offset:0 sc0 sc1
    s_sub_u32 s71, s71, 1
    s_waitcnt vmcnt(0)
    s_cbranch_scc1 L_back4
    v_cmp_ne_u32 vcc, 1, v31
    s_and_b64 vcc, vcc, 0xff
    s_cbranch_vccnz L_fp4
    s_branch L_back4
L_far5:
    s_mov_b32 s71, 2097152
L_fp5:
    buffer_load_dwordx4 v[240:243], v18, s[44:47], 0 offen offset:256 sc1
    buffer_load_dwordx4 v[244:247], v18, s[44:47], 0 offen offset:1280 sc1
    s_sub_u32 s71, s71, 1
    s_waitcnt vmcnt(0)
    s_cbranch_scc1 L_back5
    v_or3_b32 v19, v240, v241, v242
    v_or3_b32 v19, v19, v243, v244
    v_or3_b32 v19, v19, v245, v246
    v_or_b32 v19, v19, v247
    v_and_b32 v19, 1, v19
    v_cmp_ne_u32 vcc, 0, v19
    s_cbranch_vccnz L_fp5
    s_branch L_back5
L_far6:
    s_mov_b32 s71, 2097152
L_fp6:
    v_mov_b32 v31, 0
    buffer_atomic_add v31, v30, s[4:7], s74 offen offset:128 sc0 sc1
    s_sub_u32 s71, s71, 1
    s_waitcnt vmcnt(0)
    s_cbranch_scc1 L_back6
    v_cmp_ne_u32 vcc, 1, v31
    s_and_b64 vcc, vcc, 0xff
    s_cbranch_vccnz L_fp6
    s_branch L_back6
L_far7:
    s_mov_b32 s71, 2097152
L_fp7:
    v_mov_b32 v31, 0
    buffer_atomic_add v31, v30, s[4:7], s74 offen offset:256 sc0 sc1
    s_sub_u32 s71, s71, 1
    s_waitcnt vmcnt(0)
    s_cbranch_scc1 L_back7
    v_cmp_ne_u32 vcc, 1, v31
    s_and_b64 vcc, vcc, 0xff
    s_cbranch_vccnz L_fp7
    s_branch L_back7
L_far8:
    s_mov_b32 s71, 2097152
L_fp8:
    v_mov_b32 v31, 0
    buffer_atomic_add v31, v30, s[4:7], s74 offen offset:384 sc0 sc1
    s_sub_u32 s71, s71, 1
    s_waitcnt vmcnt(0)
    s_cbranch_scc1 L_back8
    v_cmp_ne_u32 vcc, 1, v31
    s_and_b64 vcc, vcc, 0xff
    s_cbranch_vccnz L_fp8
    s_branch L_back8
L_far9:
    s_mov_b32 s71, 2097152
L_fp9:
    v_mov_b32 v248, 0
    buffer_atomic_add v248, v29, s[4:7], s77 offen offset:128 sc0 sc1
    s_sub_u32 s71, s71, 1
    s_waitcnt vmcnt(0)
    s_cbranch_scc1 L_back9
    v_cmp_ne_u32 vcc, 1, v248
    s_mov_b32 s10, vcc_hi
    s_and_b64 vcc, vcc, 0x10001
    s_cbranch_vccnz L_fp9
    s_branch L_back9
L_far10:
    s_mov_b32 s71, 2097152
L_fp10:
    v_mov_b32 v249, 0
    buffer_atomic_add v249, v28, s[4:7], s77 offen offset:384 sc0 sc1
    s_sub_u32 s71, s71, 1
    s_waitcnt vmcnt(0)
    s_cbranch_scc1 L_back10
    v_cmp_ne_u32 vcc, 1, v249
    s_and_b64 vcc, vcc, 1
    s_cbranch_vccnz L_fp10
    s_branch L_back10
L_done:
    s_endpgm
.section .rodata,"a"
.p2align 6
.amdhsa_kernel parallel_sum__ssm_conv_s5__swiglu_ffn__prompt_kernel
  .amdhsa_next_free_vgpr 512
  .amdhsa_next_free_sgpr 102
  .amdhsa_accum_offset 256
  .amdhsa_group_segment_fixed_size 0
  .amdhsa_kernarg_size 128
  .amdhsa_user_sgpr_count 2
  .amdhsa_user_sgpr_kernarg_segment_ptr 1
  .amdhsa_system_sgpr_workgroup_id_x 1
  .amdhsa_float_denorm_mode_32 3
.end_amdhsa_kernel
```
